```python
import torch

def _softmax(x, axis=-1):
    return torch.softmax(x, dim=axis)
def _gelu(x):
    return torch.nn.functional.gelu(x, approximate="tanh")
def _silu(x):
    return torch.nn.functional.silu(x)
def _sigmoid(x):
    return torch.sigmoid(x)
def _layernorm(x, axis=-1, eps=1e-5):
    m = x.mean(dim=axis, keepdim=True)
    v = x.var(dim=axis, keepdim=True, unbiased=False)
    return (x - m) / torch.sqrt(v + eps)
def _scatter_add(tgt, idx, src, axis=0):
    return tgt.clone().index_add_(axis, idx, src)
def _segment_sum(src, seg, n):
    out = torch.zeros((n,) + src.shape[1:], dtype=src.dtype)
    return out.index_add_(0, seg, src)
def _pad(x, pw):
    flat = tuple(v for pair in reversed(pw) for v in pair)
    return torch.nn.functional.pad(x, flat)

kernel_name = 'standalone__gqa_block_cached__near_ridge'

def setup_inputs():

    _w = (lambda a: (lambda t: t.to(torch.bfloat16) if t.is_floating_point() else t)(torch.as_tensor(a)))
    B, Sq, D = 16, 240, 640
    Hq, Hkv, Sk, Dh = 32, 32, 1024, 128
    assert Hq % Hkv == 0, (Hq, Hkv)
    return {
        "x": _w((lambda *s: torch.randn(*s, dtype=torch.bfloat16) * 0.8)(B, Sq, D)),
        "k_cache": _w((lambda *s: torch.randn(*s, dtype=torch.bfloat16) * 0.8)(B, Hkv, Sk, Dh)),
        "v_cache": _w((lambda *s: torch.randn(*s, dtype=torch.bfloat16) * 0.05)(B, Hkv, Sk, Dh)),
        "wq": _w((lambda *s: torch.randn(*s, dtype=torch.bfloat16) * 0.8)(D, Hq * Dh) * (D ** -0.5)),
        "wo": _w((lambda *s: torch.randn(*s, dtype=torch.bfloat16) * 0.05)(Hq * Dh, D) * ((Hq * Dh) ** -0.5)),
    }

def reference(x, k_cache, v_cache, wq, wo):
    B, Sq, D = x.shape
    Hq, Dh = 32, 128
    Hkv = k_cache.shape[1]
    rep = Hq // Hkv
    q = (lambda x, *d: x.permute(*d))((x @ wq).reshape(B, Sq, Hq, Dh), 0, 2, 1, 3)
    k = (lambda x, n, axis: torch.repeat_interleave(x, n, dim=axis))(k_cache, rep, axis=1)
    v = (lambda x, n, axis: torch.repeat_interleave(x, n, dim=axis))(v_cache, rep, axis=1)
    scores = torch.einsum("bhqd,bhkd->bhqk", q, k) * (Dh ** -0.5)
    p = _softmax(scores, axis=-1)
    o = torch.einsum("bhqk,bhkd->bhqd", p, v)
    return (lambda x, *d: x.permute(*d))(o, 0, 2, 1, 3).reshape(B, Sq, Hq * Dh) @ wo
```

```asm
; @launch grid=(256,1,1) block=(256,1,1) lds=163840
.amdgcn_target "amdgcn-amd-amdhsa--gfx950"
.text
.globl standalone__gqa_block_cached__near_ridge_kernel
.p2align 8
.type standalone__gqa_block_cached__near_ridge_kernel,@function
standalone__gqa_block_cached__near_ridge_kernel:
  s_cmp_ge_u32 s2, 256
  s_cbranch_scc1 L_end
  s_load_dwordx8 s[36:43], s[0:1], 0
  s_load_dwordx8 s[44:51], s[0:1], 32
  s_getpc_b64 s[98:99]
L_pc:
  v_lshlrev_b32 v236, 7, v0
  v_min_u32 v236, L_head-L_pc, v236
  global_load_dword v253, v236, s[98:99]
  v_lshrrev_b32 v235, 6, v0
  v_and_b32 v231, 63, v0
  v_readfirstlane_b32 s24, v235
  s_and_b32 s3, s2, 7
  s_lshr_b32 s25, s2, 3
  s_lshr_b32 s58, s3, 2
  s_and_b32 s82, s3, 3
  s_lshr_b32 s56, s25, 2
  s_lshl3_add_u32 s58, s58, s56
  s_and_b32 s25, s25, 3
  s_lshl2_add_u32 s25, s82, s25
  v_and_b32 v233, 15, v231
  v_lshrrev_b32 v234, 4, v231
  v_lshrrev_b32 v235, 5, v231
  v_and_b32 v236, 31, v231
  v_lshlrev_b32 v237, 2, v235
  v_xor_b32 v237, v237, v236
  v_lshlrev_b32 v237, 4, v237
  v_lshl_add_u32 v198, v235, 13, v237
  v_xor_b32 v237, 128, v198
  v_add_u32 v199, 15360, v237
  v_add_u32 v200, 30720, v198
  v_add_u32 v201, 46080, v237
  v_lshrrev_b32 v235, 3, v231
  v_mul_u32_u24 v235, 1280, v235
  v_and_b32 v236, 7, v231
  v_xor_b32 v237, v234, v236
  v_lshl_add_u32 v202, v237, 4, v235
  v_xor_b32 v237, 64, v202
  v_add_u32 v203, 9216, v237
  v_add_u32 v204, 18432, v202
  v_add_u32 v205, 27648, v237
  s_lshl_b32 s32, s24, 12
  s_lshl_b32 s33, s24, 16
  s_lshr_b32 s3, s82, 1
  s_lshl1_add_u32 s3, s24, s3
  s_mul_i32 s34, s3, 40960
  s_xor_b32 s3, s3, 1
  s_mul_i32 s35, s3, 40960
  s_lshl_b32 s52, s24, 13
  s_add_u32 s52, s52, 98304
  s_mul_i32 s55, s58, 307200
  s_lshl_b32 s3, s25, 9
  s_waitcnt lgkmcnt(0)
  s_add_u32 s8, s42, s3
  s_addc_u32 s9, s43, 0
  s_sub_u32 s10, 5242880, s3
  s_mov_b32 s11, 0x20000
  s_add_u32 s4, s36, s55
  s_addc_u32 s5, s37, 0
  s_mov_b32 s6, 307200
  s_mov_b32 s7, 0x20000
  s_add_u32 m0, s32, 16384
  s_nop 0
  buffer_load_dwordx4 v198, s[8:11], s33 offen offset:0 lds
  buffer_load_dwordx4 v199, s[8:11], s33 offen offset:1024 lds
  buffer_load_dwordx4 v200, s[8:11], s33 offen offset:2048 lds
  buffer_load_dwordx4 v201, s[8:11], s33 offen offset:3072 lds
  s_add_u32 s33, s33, 262144
  s_add_u32 m0, s52, 0
  s_nop 0
  buffer_load_dwordx4 v202, s[4:7], s34 offen offset:0 lds
  buffer_load_dwordx4 v203, s[4:7], s34 offen offset:1024 lds
  buffer_load_dwordx4 v204, s[4:7], s34 offen offset:2048 lds
  buffer_load_dwordx4 v205, s[4:7], s34 offen offset:3072 lds
  s_add_u32 s34, s34, 128
  s_add_u32 m0, s52, 4096
  s_nop 0
  buffer_load_dwordx4 v202, s[4:7], s35 offen offset:0 lds
  buffer_load_dwordx4 v203, s[4:7], s35 offen offset:1024 lds
  buffer_load_dwordx4 v204, s[4:7], s35 offen offset:2048 lds
  buffer_load_dwordx4 v205, s[4:7], s35 offen offset:3072 lds
  s_add_u32 s35, s35, 128
  s_add_u32 m0, s32, 32768
  s_nop 0
  buffer_load_dwordx4 v198, s[8:11], s33 offen offset:0 lds
  buffer_load_dwordx4 v199, s[8:11], s33 offen offset:1024 lds
  buffer_load_dwordx4 v200, s[8:11], s33 offen offset:2048 lds
  buffer_load_dwordx4 v201, s[8:11], s33 offen offset:3072 lds
  s_add_u32 s33, s33, 262144
  v_mov_b32 v244, 0
  v_mov_b32 v245, 0
  v_mov_b32 v246, 0
  v_mov_b32 v247, 0
  s_lshl_b32 s3, s58, 4
  s_add_u32 s3, s3, s25
  s_lshl_b32 s3, s3, 19
  s_add_u32 s12, s38, s3
  s_addc_u32 s13, s39, 0
  s_mov_b32 s14, 524288
  s_mov_b32 s15, 0x20000
  s_add_u32 s16, s40, s3
  s_addc_u32 s17, s41, 0
  s_mov_b32 s18, 540672
  s_mov_b32 s19, 0x20000
  v_mfma_f32_32x32x16_bf16 v[0:15], v[244:247], v[244:247], 0
  s_sub_u32 s16, s16, 16384
  s_subb_u32 s17, s17, 0
  s_mul_i32 s3, s58, 1966080
  s_add_u32 s20, s50, s3
  s_addc_u32 s21, s51, 0
  s_mov_b32 s22, 1966080
  s_mov_b32 s23, 0x20000
  v_mfma_f32_32x32x16_bf16 v[16:31], v[244:247], v[244:247], 0
  s_mov_b32 s26, 0x3e0293ee
  s_mov_b32 s27, 0x3e0293ee
  s_mov_b32 s57, 0x53800000
  v_lshrrev_b32 v237, 2, v233
  v_and_b32 v238, 3, v233
  v_xor_b32 v235, v238, v234
  v_and_b32 v235, 2, v235
  v_mfma_f32_32x32x16_bf16 v[32:47], v[244:247], v[244:247], 0
  v_cmp_eq_u32 vcc, 0, v235
  v_mov_b32 v236, 0x3f803f80
  v_and_b32 v235, 1, v238
  v_cndmask_b32 v248, 0, v236, vcc
  v_mul_u32_u24 v235, 0xaaaa, v235
  v_add_u32 v235, 0x4444, v235
  v_lshl_add_u32 v252, v235, 16, v235
  v_mfma_f32_32x32x16_bf16 v[48:63], v[244:247], v[244:247], 0
  v_mov_b32 v249, v248
  v_mov_b32 v250, v248
  v_mov_b32 v251, v248
  v_lshl_add_u32 v235, v234, 3, v237
  v_lshlrev_b32 v235, 9, v235
  v_lshl_add_u32 v235, v238, 4, v235
  v_lshl_add_u32 v235, v237, 6, v235
  v_mfma_f32_32x32x16_bf16 v[64:79], v[244:247], v[244:247], 0
  v_add_u32 v192, 16384, v235
  v_xor_b32 v193, 64, v192
  v_xor_b32 v194, 128, v192
  v_xor_b32 v195, 192, v192
  s_and_b32 s3, s82, 1
  s_lshl_b32 s3, s3, 11
  s_add_u32 s3, s3, s52
  v_mfma_f32_32x32x16_bf16 v[80:95], v[244:247], v[244:247], 0
  v_lshlrev_b32 v235, 7, v233
  v_add_u32 v235, s3, v235
  v_lshrrev_b32 v236, 1, v233
  v_xor_b32 v236, v234, v236
  v_lshl_add_u32 v196, v236, 4, v235
  v_xor_b32 v236, v234, v233
  v_lshlrev_b32 v236, 4, v236
  v_mfma_f32_32x32x16_bf16 v[96:111], v[244:247], v[244:247], 0
  v_lshl_add_u32 v212, v233, 8, v236
  v_xor_b32 v213, 64, v212
  v_xor_b32 v214, 128, v212
  v_xor_b32 v215, 192, v212
  s_lshl_b32 s3, s24, 6
  v_lshl_add_u32 v224, v234, 8, v236
  v_xor_b32 v224, s3, v224
  v_mfma_f32_32x32x16_bf16 v[112:127], v[244:247], v[244:247], 0
  s_and_b32 s3, s24, 1
  s_lshl_b32 s3, s3, 7
  v_lshlrev_b32 v236, 1, v234
  v_xor_b32 v236, v236, v233
  v_lshlrev_b32 v236, 4, v236
  v_lshl_add_u32 v225, v234, 8, v236
  v_xor_b32 v225, s3, v225
  v_mfma_f32_32x32x16_bf16 a[64:79], v[244:247], v[244:247], 0
  s_lshl_b32 s30, s24, 10
  s_add_u32 s31, s30, 16384
  v_lshl_add_u32 v235, v234, 2, v237
  v_and_b32 v236, 7, v235
  v_lshlrev_b32 v235, 8, v235
  v_lshl_add_u32 v235, v238, 3, v235
  v_lshl_add_u32 v235, v236, 5, v235
  v_mfma_f32_32x32x16_bf16 a[80:95], v[244:247], v[244:247], 0
  v_add_u32 v216, 65536, v235
  v_xor_b32 v217, 32, v216
  v_xor_b32 v218, 64, v216
  v_xor_b32 v219, 96, v216
  v_xor_b32 v220, 128, v216
  v_xor_b32 v221, 160, v216
  v_xor_b32 v222, 192, v216
  v_mfma_f32_32x32x16_bf16 a[96:111], v[244:247], v[244:247], 0
  v_xor_b32 v223, 224, v216
  s_lshl_b32 s3, s24, 19
  v_lshlrev_b32 v235, 4, v231
  v_add_u32 v230, s3, v235
  s_mov_b32 s29, 0
  s_mov_b32 s54, 0
  s_mov_b32 s59, 0
  v_mfma_f32_32x32x16_bf16 a[112:127], v[244:247], v[244:247], 0
  s_mov_b32 s0, 0
  s_lshl_b32 s53, s25, 12
  s_xor_b32 s3, s82, 0
  s_lshl_b32 s3, s3, 17
  s_add_u32 s76, s3, s53
  s_xor_b32 s3, s82, 1
  s_lshl_b32 s3, s3, 17
  v_mfma_f32_32x32x16_bf16 a[192:207], v[244:247], v[244:247], 0
  s_add_u32 s77, s3, s53
  s_xor_b32 s3, s82, 2
  s_lshl_b32 s3, s3, 17
  s_add_u32 s78, s3, s53
  s_xor_b32 s3, s82, 3
  s_lshl_b32 s3, s3, 17
  s_add_u32 s79, s3, s53
  v_mfma_f32_32x32x16_bf16 a[208:223], v[244:247], v[244:247], 0
  s_and_b32 s55, s25, 3
  s_mul_i32 s56, s55, 320
  s_add_u32 s64, s44, s56
  s_addc_u32 s65, s45, 0
  s_sub_u32 s66, 5242880, s56
  s_mov_b32 s67, 0x20000
  s_mul_i32 s3, s58, 307200
  v_mfma_f32_32x32x16_bf16 a[224:239], v[244:247], v[244:247], 0
  s_add_u32 s3, s3, s56
  s_add_u32 s68, s46, s3
  s_addc_u32 s69, s47, 0
  s_sub_u32 s70, 307200, s56
  s_mov_b32 s71, 0x20000
  s_add_u32 s72, s48, 0
  s_addc_u32 s73, s49, 0
  v_mfma_f32_32x32x16_bf16 a[240:255], v[244:247], v[244:247], 0
  s_mov_b32 s74, 256
  s_mov_b32 s75, 0x20000
  s_lshl_b32 s80, s25, 2
  s_lshl_b32 s81, s58, 4
  s_lshl2_add_u32 s3, s58, s55
  s_lshl_b32 s3, s3, 18
  s_add_u32 s3, s3, 0x2000000
  s_add_u32 s60, s50, s3
  s_addc_u32 s61, s51, 0
  s_mov_b32 s62, 262144
  s_mov_b32 s63, 0x20000
  s_lshl_b32 s3, s58, 20
  s_add_u32 s3, s3, 33570048
  s_add_u32 s36, s50, s3
  s_addc_u32 s37, s51, 0
  s_mov_b32 s38, 128
  s_mov_b32 s39, 0x20000
  s_mul_i32 s100, s24, 5120
  s_mul_i32 s40, s2, 20480
  s_add_u32 s40, s40, s100
  s_max_u32 s40, s40, s56
  s_sub_u32 s40, s40, s56
  s_lshl_b32 s3, s25, 4
  s_add_u32 s3, s3, s24
  s_mul_i32 s101, s3, 20480
  s_add_u32 m0, s52, 32768
  s_nop 0
  buffer_load_dwordx4 v202, s[4:7], s34 offen offset:0 lds
  buffer_load_dwordx4 v203, s[4:7], s34 offen offset:1024 lds
  buffer_load_dwordx4 v204, s[4:7], s34 offen offset:2048 lds
  buffer_load_dwordx4 v205, s[4:7], s34 offen offset:3072 lds
  s_add_u32 s34, s34, 128
  s_add_u32 m0, s32, 49152
  s_nop 0
  buffer_load_dwordx4 v198, s[8:11], s33 offen offset:0 lds
  buffer_load_dwordx4 v199, s[8:11], s33 offen offset:1024 lds
  buffer_load_dwordx4 v200, s[8:11], s33 offen offset:2048 lds
  buffer_load_dwordx4 v201, s[8:11], s33 offen offset:3072 lds
  s_add_u32 s33, s33, 262144
  s_lshl_b32 s1, s82, 2
  s_add_u32 s1, s1, s24
  s_lshl_b32 s1, s1, 14
  s_add_u32 s1, s1, 15360
  v_lshlrev_b32 v232, 4, v231
  s_mov_b64 exec, 0xffffff
  buffer_store_dwordx4 v[244:247], v232, s[60:63], s1 offen offset:0 sc1
  s_mov_b64 exec, -1
  s_mul_i32 s55, s24, 1408
  s_add_u32 s55, s55, L_qtail-L_pc
  v_min_u32 v235, 10, v231
  v_lshl_add_u32 v235, v235, 7, s55
  s_waitcnt vmcnt(13)
  s_barrier
  v_xor_b32 v240, 0, v196
  v_xor_b32 v241, 2048, v196
  v_xor_b32 v242, 4096, v196
  v_xor_b32 v243, 6144, v196
  v_xor_b32 v244, 64, v196
  v_xor_b32 v245, 2112, v196
  v_xor_b32 v246, 4160, v196
  v_xor_b32 v247, 6208, v196
  ds_read_b64_tr_b16 a[32:33], v192 offset:0
  ds_read_b64_tr_b16 a[34:35], v192 offset:2048
  ds_read_b64_tr_b16 a[36:37], v192 offset:8
  ds_read_b64_tr_b16 a[38:39], v192 offset:2056
  ds_read_b64_tr_b16 a[40:41], v193 offset:0
  ds_read_b64_tr_b16 a[42:43], v193 offset:2048
  ds_read_b64_tr_b16 a[44:45], v193 offset:8
  ds_read_b64_tr_b16 a[46:47], v193 offset:2056
  ds_read_b64_tr_b16 a[48:49], v194 offset:0
  ds_read_b64_tr_b16 a[50:51], v194 offset:2048
  ds_read_b64_tr_b16 a[52:53], v194 offset:8
  ds_read_b64_tr_b16 a[54:55], v194 offset:2056
  ds_read_b128 v[128:131], v240 offset:0
  ds_read_b128 v[132:135], v241 offset:0
  ds_read_b128 v[144:147], v244 offset:0
  ds_read_b128 v[148:151], v245 offset:0
  ds_read_b128 v[136:139], v242 offset:0
  ds_read_b128 v[140:143], v243 offset:0
  ds_read_b128 v[152:155], v246 offset:0
  ds_read_b128 v[156:159], v247 offset:0
  s_mov_b32 s28, 4
  s_waitcnt lgkmcnt(0)
.p2align 6
L_qloop:
  s_waitcnt lgkmcnt(14)
  v_mfma_f32_16x16x32_bf16 v[0:3], a[32:35], v[128:131], v[0:3]
  ds_read_b64_tr_b16 a[56:57], v195 offset:0
  v_mfma_f32_16x16x32_bf16 v[4:7], a[32:35], v[132:135], v[4:7]
  s_waitcnt lgkmcnt(5)
  v_mfma_f32_16x16x32_bf16 v[8:11], a[32:35], v[136:139], v[8:11]
  s_add_u32 m0, s52, 36864
  ds_read_b64_tr_b16 a[58:59], v195 offset:2048
  v_mfma_f32_16x16x32_bf16 v[12:15], a[32:35], v[140:143], v[12:15]
  buffer_load_dwordx4 v202, s[4:7], s35 offen offset:0 lds
  v_mfma_f32_16x16x32_bf16 v[28:31], a[36:39], v[140:143], v[28:31]
  ds_read_b64_tr_b16 a[60:61], v195 offset:8
  v_mfma_f32_16x16x32_bf16 v[24:27], a[36:39], v[136:139], v[24:27]
  buffer_load_dwordx4 v203, s[4:7], s35 offen offset:1024 lds
  v_mfma_f32_16x16x32_bf16 v[20:23], a[36:39], v[132:135], v[20:23]
  ds_read_b64_tr_b16 a[62:63], v195 offset:2056
  v_mfma_f32_16x16x32_bf16 v[16:19], a[36:39], v[128:131], v[16:19]
  buffer_load_dwordx4 v204, s[4:7], s35 offen offset:2048 lds
  v_mfma_f32_16x16x32_bf16 v[32:35], a[40:43], v[128:131], v[32:35]
  ds_read_b64_tr_b16 a[32:33], v192 offset:256
  v_mfma_f32_16x16x32_bf16 v[36:39], a[40:43], v[132:135], v[36:39]
  buffer_load_dwordx4 v205, s[4:7], s35 offen offset:3072 lds
  v_mfma_f32_16x16x32_bf16 v[40:43], a[40:43], v[136:139], v[40:43]
  s_add_u32 s35, s35, 128
  ds_read_b64_tr_b16 a[34:35], v192 offset:2304
  v_mfma_f32_16x16x32_bf16 v[44:47], a[40:43], v[140:143], v[44:47]
  v_mfma_f32_16x16x32_bf16 v[60:63], a[44:47], v[140:143], v[60:63]
  s_add_u32 m0, s32, 65536
  ds_read_b64_tr_b16 a[36:37], v192 offset:264
  v_mfma_f32_16x16x32_bf16 v[56:59], a[44:47], v[136:139], v[56:59]
  buffer_load_dwordx4 v198, s[8:11], s33 offen offset:0 lds
  v_mfma_f32_16x16x32_bf16 v[52:55], a[44:47], v[132:135], v[52:55]
  ds_read_b64_tr_b16 a[38:39], v192 offset:2312
  v_mfma_f32_16x16x32_bf16 v[48:51], a[44:47], v[128:131], v[48:51]
  s_waitcnt lgkmcnt(10)
  v_mfma_f32_16x16x32_bf16 v[64:67], a[48:51], v[128:131], v[64:67]
  ds_read_b64_tr_b16 a[40:41], v193 offset:256
  v_mfma_f32_16x16x32_bf16 v[68:71], a[48:51], v[132:135], v[68:71]
  v_mfma_f32_16x16x32_bf16 v[72:75], a[48:51], v[136:139], v[72:75]
  ds_read_b64_tr_b16 a[42:43], v193 offset:2304
  v_mfma_f32_16x16x32_bf16 v[76:79], a[48:51], v[140:143], v[76:79]
  s_waitcnt lgkmcnt(10)
  buffer_load_dwordx4 v199, s[8:11], s33 offen offset:1024 lds
  v_mfma_f32_16x16x32_bf16 v[92:95], a[52:55], v[140:143], v[92:95]
  ds_read_b64_tr_b16 a[44:45], v193 offset:264
  v_mfma_f32_16x16x32_bf16 v[88:91], a[52:55], v[136:139], v[88:91]
  v_mfma_f32_16x16x32_bf16 v[84:87], a[52:55], v[132:135], v[84:87]
  ds_read_b64_tr_b16 a[46:47], v193 offset:2312
  v_mfma_f32_16x16x32_bf16 v[80:83], a[52:55], v[128:131], v[80:83]
  s_waitcnt lgkmcnt(10)
  v_mfma_f32_16x16x32_bf16 v[96:99], a[56:59], v[128:131], v[96:99]
  ds_read_b64_tr_b16 a[48:49], v194 offset:256
  v_mfma_f32_16x16x32_bf16 v[100:103], a[56:59], v[132:135], v[100:103]
  buffer_load_dwordx4 v200, s[8:11], s33 offen offset:2048 lds
  v_mfma_f32_16x16x32_bf16 v[104:107], a[56:59], v[136:139], v[104:107]
  ds_read_b64_tr_b16 a[50:51], v194 offset:2304
  v_mfma_f32_16x16x32_bf16 v[108:111], a[56:59], v[140:143], v[108:111]
  s_waitcnt lgkmcnt(10)
  v_mfma_f32_16x16x32_bf16 v[124:127], a[60:63], v[140:143], v[124:127]
  ds_read_b64_tr_b16 a[52:53], v194 offset:264
  v_mfma_f32_16x16x32_bf16 v[120:123], a[60:63], v[136:139], v[120:123]
  v_mfma_f32_16x16x32_bf16 v[116:119], a[60:63], v[132:135], v[116:119]
  ds_read_b64_tr_b16 a[54:55], v194 offset:2312
  v_mfma_f32_16x16x32_bf16 v[112:115], a[60:63], v[128:131], v[112:115]
  s_waitcnt lgkmcnt(10)
  buffer_load_dwordx4 v201, s[8:11], s33 offen offset:3072 lds
  v_mfma_f32_16x16x32_bf16 a[64:67], a[32:35], v[128:131], a[64:67]
  s_add_u32 s33, s33, 262144
  ds_read_b64_tr_b16 a[56:57], v195 offset:256
  v_mfma_f32_16x16x32_bf16 a[68:71], a[32:35], v[132:135], a[68:71]
  s_pack_ll_b32_b16 m0, s30, 0
  v_mfma_f32_16x16x32_bf16 a[72:75], a[32:35], v[136:139], a[72:75]
  ds_read_b64_tr_b16 a[58:59], v195 offset:2304
  v_mfma_f32_16x16x32_bf16 a[76:79], a[32:35], v[140:143], a[76:79]
  s_waitcnt lgkmcnt(10)
  v_mfma_f32_16x16x32_bf16 a[92:95], a[36:39], v[140:143], a[92:95]
  ds_read_b64_tr_b16 a[60:61], v195 offset:264
  v_mfma_f32_16x16x32_bf16 a[88:91], a[36:39], v[136:139], a[88:91]
  v_mfma_f32_16x16x32_bf16 a[84:87], a[36:39], v[132:135], a[84:87]
  ds_read_b64_tr_b16 a[62:63], v195 offset:2312
  v_mfma_f32_16x16x32_bf16 a[80:83], a[36:39], v[128:131], a[80:83]
  s_waitcnt lgkmcnt(10)
  buffer_load_dwordx4 v224, s[12:15], s30 offen offset:0 nt lds
  v_mfma_f32_16x16x32_bf16 a[96:99], a[40:43], v[128:131], a[96:99]
  s_addk_i32 s30, 0x1000
  v_mfma_f32_16x16x32_bf16 a[100:103], a[40:43], v[132:135], a[100:103]
  v_mfma_f32_16x16x32_bf16 a[104:107], a[40:43], v[136:139], a[104:107]
  v_mfma_f32_16x16x32_bf16 a[108:111], a[40:43], v[140:143], a[108:111]
  s_waitcnt lgkmcnt(8)
  v_mfma_f32_16x16x32_bf16 a[124:127], a[44:47], v[140:143], a[124:127]
  s_waitcnt vmcnt(18) lgkmcnt(0)
  v_mfma_f32_16x16x32_bf16 a[120:123], a[44:47], v[136:139], a[120:123]
  s_barrier
  v_mfma_f32_16x16x32_bf16 a[116:119], a[44:47], v[132:135], a[116:119]
  ds_read_b64_tr_b16 a[32:33], v192 offset:16384
  v_mfma_f32_16x16x32_bf16 a[112:115], a[44:47], v[128:131], a[112:115]
  ds_read_b64_tr_b16 a[34:35], v192 offset:18432
  v_mfma_f32_16x16x32_bf16 a[192:195], a[48:51], v[128:131], a[192:195]
  ds_read_b64_tr_b16 a[36:37], v192 offset:16392
  v_mfma_f32_16x16x32_bf16 a[196:199], a[48:51], v[132:135], a[196:199]
  ds_read_b64_tr_b16 a[38:39], v192 offset:18440
  v_mfma_f32_16x16x32_bf16 a[200:203], a[48:51], v[136:139], a[200:203]
  ds_read_b64_tr_b16 a[40:41], v193 offset:16384
  v_mfma_f32_16x16x32_bf16 a[204:207], a[48:51], v[140:143], a[204:207]
  ds_read_b64_tr_b16 a[42:43], v193 offset:18432
  v_mfma_f32_16x16x32_bf16 a[220:223], a[52:55], v[140:143], a[220:223]
  v_mfma_f32_16x16x32_bf16 a[216:219], a[52:55], v[136:139], a[216:219]
  s_waitcnt vmcnt(14)
  ds_read_b64_tr_b16 a[44:45], v193 offset:16392
  v_mfma_f32_16x16x32_bf16 a[212:215], a[52:55], v[132:135], a[212:215]
  ds_read_b128 v[160:163], v240 offset:32768
  v_mfma_f32_16x16x32_bf16 a[208:211], a[52:55], v[128:131], a[208:211]
  ds_read_b128 v[164:167], v241 offset:32768
  v_mfma_f32_16x16x32_bf16 a[224:227], a[56:59], v[128:131], a[224:227]
  ds_read_b128 v[176:179], v244 offset:32768
  v_mfma_f32_16x16x32_bf16 a[228:231], a[56:59], v[132:135], a[228:231]
  ds_read_b128 v[180:183], v245 offset:32768
  v_mfma_f32_16x16x32_bf16 a[232:235], a[56:59], v[136:139], a[232:235]
  ds_read_b64_tr_b16 a[46:47], v193 offset:18440
  v_mfma_f32_16x16x32_bf16 a[236:239], a[56:59], v[140:143], a[236:239]
  ds_read_b64_tr_b16 a[48:49], v194 offset:16384
  v_mfma_f32_16x16x32_bf16 a[252:255], a[60:63], v[140:143], a[252:255]
  ds_read_b64_tr_b16 a[50:51], v194 offset:18432
  v_mfma_f32_16x16x32_bf16 a[248:251], a[60:63], v[136:139], a[248:251]
  ds_read_b64_tr_b16 a[52:53], v194 offset:16392
  v_mfma_f32_16x16x32_bf16 a[244:247], a[60:63], v[132:135], a[244:247]
  ds_read_b64_tr_b16 a[54:55], v194 offset:18440
  v_mfma_f32_16x16x32_bf16 a[240:243], a[60:63], v[128:131], a[240:243]
  s_waitcnt lgkmcnt(14)
  v_mfma_f32_16x16x32_bf16 v[0:3], a[32:35], v[144:147], v[0:3]
  ds_read_b64_tr_b16 a[56:57], v195 offset:16384
  v_mfma_f32_16x16x32_bf16 v[4:7], a[32:35], v[148:151], v[4:7]
  s_waitcnt lgkmcnt(5)
  v_mfma_f32_16x16x32_bf16 v[8:11], a[32:35], v[152:155], v[8:11]
  s_add_u32 m0, s52, 32768
  ds_read_b64_tr_b16 a[58:59], v195 offset:18432
  v_mfma_f32_16x16x32_bf16 v[12:15], a[32:35], v[156:159], v[12:15]
  buffer_load_dwordx4 v202, s[4:7], s34 offen offset:0 lds
  v_mfma_f32_16x16x32_bf16 v[28:31], a[36:39], v[156:159], v[28:31]
  ds_read_b64_tr_b16 a[60:61], v195 offset:16392
  v_mfma_f32_16x16x32_bf16 v[24:27], a[36:39], v[152:155], v[24:27]
  buffer_load_dwordx4 v203, s[4:7], s34 offen offset:1024 lds
  v_mfma_f32_16x16x32_bf16 v[20:23], a[36:39], v[148:151], v[20:23]
  ds_read_b64_tr_b16 a[62:63], v195 offset:18440
  v_mfma_f32_16x16x32_bf16 v[16:19], a[36:39], v[144:147], v[16:19]
  buffer_load_dwordx4 v204, s[4:7], s34 offen offset:2048 lds
  v_mfma_f32_16x16x32_bf16 v[32:35], a[40:43], v[144:147], v[32:35]
  ds_read_b64_tr_b16 a[32:33], v192 offset:16640
  v_mfma_f32_16x16x32_bf16 v[36:39], a[40:43], v[148:151], v[36:39]
  buffer_load_dwordx4 v205, s[4:7], s34 offen offset:3072 lds
  v_mfma_f32_16x16x32_bf16 v[40:43], a[40:43], v[152:155], v[40:43]
  s_add_u32 s34, s34, 128
  ds_read_b64_tr_b16 a[34:35], v192 offset:18688
  v_mfma_f32_16x16x32_bf16 v[44:47], a[40:43], v[156:159], v[44:47]
  v_mfma_f32_16x16x32_bf16 v[60:63], a[44:47], v[156:159], v[60:63]
  s_add_u32 m0, s32, 16384
  ds_read_b64_tr_b16 a[36:37], v192 offset:16648
  v_mfma_f32_16x16x32_bf16 v[56:59], a[44:47], v[152:155], v[56:59]
  buffer_load_dwordx4 v198, s[8:11], s33 offen offset:0 lds
  v_mfma_f32_16x16x32_bf16 v[52:55], a[44:47], v[148:151], v[52:55]
  ds_read_b64_tr_b16 a[38:39], v192 offset:18696
  v_mfma_f32_16x16x32_bf16 v[48:51], a[44:47], v[144:147], v[48:51]
  s_waitcnt lgkmcnt(10)
  v_mfma_f32_16x16x32_bf16 v[64:67], a[48:51], v[144:147], v[64:67]
  ds_read_b64_tr_b16 a[40:41], v193 offset:16640
  v_mfma_f32_16x16x32_bf16 v[68:71], a[48:51], v[148:151], v[68:71]
  v_mfma_f32_16x16x32_bf16 v[72:75], a[48:51], v[152:155], v[72:75]
  ds_read_b64_tr_b16 a[42:43], v193 offset:18688
  v_mfma_f32_16x16x32_bf16 v[76:79], a[48:51], v[156:159], v[76:79]
  s_waitcnt lgkmcnt(10)
  buffer_load_dwordx4 v199, s[8:11], s33 offen offset:1024 lds
  v_mfma_f32_16x16x32_bf16 v[92:95], a[52:55], v[156:159], v[92:95]
  ds_read_b64_tr_b16 a[44:45], v193 offset:16648
  v_mfma_f32_16x16x32_bf16 v[88:91], a[52:55], v[152:155], v[88:91]
  v_mfma_f32_16x16x32_bf16 v[84:87], a[52:55], v[148:151], v[84:87]
  ds_read_b64_tr_b16 a[46:47], v193 offset:18696
  v_mfma_f32_16x16x32_bf16 v[80:83], a[52:55], v[144:147], v[80:83]
  s_waitcnt lgkmcnt(10)
  v_mfma_f32_16x16x32_bf16 v[96:99], a[56:59], v[144:147], v[96:99]
  ds_read_b64_tr_b16 a[48:49], v194 offset:16640
  v_mfma_f32_16x16x32_bf16 v[100:103], a[56:59], v[148:151], v[100:103]
  buffer_load_dwordx4 v200, s[8:11], s33 offen offset:2048 lds
  v_mfma_f32_16x16x32_bf16 v[104:107], a[56:59], v[152:155], v[104:107]
  ds_read_b64_tr_b16 a[50:51], v194 offset:18688
  v_mfma_f32_16x16x32_bf16 v[108:111], a[56:59], v[156:159], v[108:111]
  s_waitcnt lgkmcnt(10)
  v_mfma_f32_16x16x32_bf16 v[124:127], a[60:63], v[156:159], v[124:127]
  ds_read_b64_tr_b16 a[52:53], v194 offset:16648
  v_mfma_f32_16x16x32_bf16 v[120:123], a[60:63], v[152:155], v[120:123]
  v_mfma_f32_16x16x32_bf16 v[116:119], a[60:63], v[148:151], v[116:119]
  ds_read_b64_tr_b16 a[54:55], v194 offset:18696
  v_mfma_f32_16x16x32_bf16 v[112:115], a[60:63], v[144:147], v[112:115]
  s_waitcnt lgkmcnt(10)
  buffer_load_dwordx4 v201, s[8:11], s33 offen offset:3072 lds
  v_mfma_f32_16x16x32_bf16 a[64:67], a[32:35], v[144:147], a[64:67]
  s_add_u32 s33, s33, 262144
  ds_read_b64_tr_b16 a[56:57], v195 offset:16640
  v_mfma_f32_16x16x32_bf16 a[68:71], a[32:35], v[148:151], a[68:71]
  s_pack_ll_b32_b16 m0, s31, 1
  v_mfma_f32_16x16x32_bf16 a[72:75], a[32:35], v[152:155], a[72:75]
  ds_read_b64_tr_b16 a[58:59], v195 offset:18688
  v_mfma_f32_16x16x32_bf16 a[76:79], a[32:35], v[156:159], a[76:79]
  s_waitcnt lgkmcnt(10)
  v_mfma_f32_16x16x32_bf16 a[92:95], a[36:39], v[156:159], a[92:95]
  ds_read_b64_tr_b16 a[60:61], v195 offset:16648
  v_mfma_f32_16x16x32_bf16 a[88:91], a[36:39], v[152:155], a[88:91]
  v_mfma_f32_16x16x32_bf16 a[84:87], a[36:39], v[148:151], a[84:87]
  ds_read_b64_tr_b16 a[62:63], v195 offset:18696
  v_mfma_f32_16x16x32_bf16 a[80:83], a[36:39], v[144:147], a[80:83]
  s_waitcnt lgkmcnt(10)
  buffer_load_dwordx4 v225, s[16:19], s31 offen offset:0 nt lds
  v_mfma_f32_16x16x32_bf16 a[96:99], a[40:43], v[144:147], a[96:99]
  s_addk_i32 s31, 0x1000
  v_mfma_f32_16x16x32_bf16 a[100:103], a[40:43], v[148:151], a[100:103]
  v_mfma_f32_16x16x32_bf16 a[104:107], a[40:43], v[152:155], a[104:107]
  v_mfma_f32_16x16x32_bf16 a[108:111], a[40:43], v[156:159], a[108:111]
  s_waitcnt lgkmcnt(8)
  v_mfma_f32_16x16x32_bf16 a[124:127], a[44:47], v[156:159], a[124:127]
  s_waitcnt vmcnt(19) lgkmcnt(0)
  v_mfma_f32_16x16x32_bf16 a[120:123], a[44:47], v[152:155], a[120:123]
  s_barrier
  v_mfma_f32_16x16x32_bf16 a[116:119], a[44:47], v[148:151], a[116:119]
  ds_read_b64_tr_b16 a[32:33], v192 offset:32768
  v_mfma_f32_16x16x32_bf16 a[112:115], a[44:47], v[144:147], a[112:115]
  ds_read_b64_tr_b16 a[34:35], v192 offset:34816
  v_mfma_f32_16x16x32_bf16 a[192:195], a[48:51], v[144:147], a[192:195]
  ds_read_b64_tr_b16 a[36:37], v192 offset:32776
  v_mfma_f32_16x16x32_bf16 a[196:199], a[48:51], v[148:151], a[196:199]
  ds_read_b64_tr_b16 a[38:39], v192 offset:34824
  v_mfma_f32_16x16x32_bf16 a[200:203], a[48:51], v[152:155], a[200:203]
  ds_read_b64_tr_b16 a[40:41], v193 offset:32768
  v_mfma_f32_16x16x32_bf16 a[204:207], a[48:51], v[156:159], a[204:207]
  ds_read_b64_tr_b16 a[42:43], v193 offset:34816
  v_mfma_f32_16x16x32_bf16 a[220:223], a[52:55], v[156:159], a[220:223]
  v_mfma_f32_16x16x32_bf16 a[216:219], a[52:55], v[152:155], a[216:219]
  s_waitcnt vmcnt(14)
  ds_read_b64_tr_b16 a[44:45], v193 offset:32776
  v_mfma_f32_16x16x32_bf16 a[212:215], a[52:55], v[148:151], a[212:215]
  ds_read_b128 v[168:171], v242 offset:32768
  v_mfma_f32_16x16x32_bf16 a[208:211], a[52:55], v[144:147], a[208:211]
  ds_read_b128 v[172:175], v243 offset:32768
  v_mfma_f32_16x16x32_bf16 a[224:227], a[56:59], v[144:147], a[224:227]
  ds_read_b128 v[184:187], v246 offset:32768
  v_mfma_f32_16x16x32_bf16 a[228:231], a[56:59], v[148:151], a[228:231]
  ds_read_b128 v[188:191], v247 offset:32768
  v_mfma_f32_16x16x32_bf16 a[232:235], a[56:59], v[152:155], a[232:235]
  ds_read_b64_tr_b16 a[46:47], v193 offset:34824
  v_mfma_f32_16x16x32_bf16 a[236:239], a[56:59], v[156:159], a[236:239]
  ds_read_b64_tr_b16 a[48:49], v194 offset:32768
  v_mfma_f32_16x16x32_bf16 a[252:255], a[60:63], v[156:159], a[252:255]
  ds_read_b64_tr_b16 a[50:51], v194 offset:34816
  v_mfma_f32_16x16x32_bf16 a[248:251], a[60:63], v[152:155], a[248:251]
  ds_read_b64_tr_b16 a[52:53], v194 offset:32776
  v_mfma_f32_16x16x32_bf16 a[244:247], a[60:63], v[148:151], a[244:247]
  ds_read_b64_tr_b16 a[54:55], v194 offset:34824
  v_mfma_f32_16x16x32_bf16 a[240:243], a[60:63], v[144:147], a[240:243]
  s_waitcnt lgkmcnt(14)
  v_mfma_f32_16x16x32_bf16 v[0:3], a[32:35], v[160:163], v[0:3]
  ds_read_b64_tr_b16 a[56:57], v195 offset:32768
  v_mfma_f32_16x16x32_bf16 v[4:7], a[32:35], v[164:167], v[4:7]
  s_waitcnt lgkmcnt(5)
  v_mfma_f32_16x16x32_bf16 v[8:11], a[32:35], v[168:171], v[8:11]
  s_add_u32 m0, s52, 36864
  ds_read_b64_tr_b16 a[58:59], v195 offset:34816
  v_mfma_f32_16x16x32_bf16 v[12:15], a[32:35], v[172:175], v[12:15]
  buffer_load_dwordx4 v202, s[4:7], s35 offen offset:0 lds
  v_mfma_f32_16x16x32_bf16 v[28:31], a[36:39], v[172:175], v[28:31]
  ds_read_b64_tr_b16 a[60:61], v195 offset:32776
  v_mfma_f32_16x16x32_bf16 v[24:27], a[36:39], v[168:171], v[24:27]
  buffer_load_dwordx4 v203, s[4:7], s35 offen offset:1024 lds
  v_mfma_f32_16x16x32_bf16 v[20:23], a[36:39], v[164:167], v[20:23]
  ds_read_b64_tr_b16 a[62:63], v195 offset:34824
  v_mfma_f32_16x16x32_bf16 v[16:19], a[36:39], v[160:163], v[16:19]
  buffer_load_dwordx4 v204, s[4:7], s35 offen offset:2048 lds
  v_mfma_f32_16x16x32_bf16 v[32:35], a[40:43], v[160:163], v[32:35]
  ds_read_b64_tr_b16 a[32:33], v192 offset:33024
  v_mfma_f32_16x16x32_bf16 v[36:39], a[40:43], v[164:167], v[36:39]
  buffer_load_dwordx4 v205, s[4:7], s35 offen offset:3072 lds
  v_mfma_f32_16x16x32_bf16 v[40:43], a[40:43], v[168:171], v[40:43]
  s_add_u32 s35, s35, 128
  ds_read_b64_tr_b16 a[34:35], v192 offset:35072
  v_mfma_f32_16x16x32_bf16 v[44:47], a[40:43], v[172:175], v[44:47]
  v_mfma_f32_16x16x32_bf16 v[60:63], a[44:47], v[172:175], v[60:63]
  s_add_u32 m0, s32, 32768
  ds_read_b64_tr_b16 a[36:37], v192 offset:33032
  v_mfma_f32_16x16x32_bf16 v[56:59], a[44:47], v[168:171], v[56:59]
  buffer_load_dwordx4 v198, s[8:11], s33 offen offset:0 lds
  v_mfma_f32_16x16x32_bf16 v[52:55], a[44:47], v[164:167], v[52:55]
  ds_read_b64_tr_b16 a[38:39], v192 offset:35080
  v_mfma_f32_16x16x32_bf16 v[48:51], a[44:47], v[160:163], v[48:51]
  s_waitcnt lgkmcnt(10)
  v_mfma_f32_16x16x32_bf16 v[64:67], a[48:51], v[160:163], v[64:67]
  ds_read_b64_tr_b16 a[40:41], v193 offset:33024
  v_mfma_f32_16x16x32_bf16 v[68:71], a[48:51], v[164:167], v[68:71]
  buffer_load_dwordx4 v199, s[8:11], s33 offen offset:1024 lds
  v_mfma_f32_16x16x32_bf16 v[72:75], a[48:51], v[168:171], v[72:75]
  ds_read_b64_tr_b16 a[42:43], v193 offset:35072
  v_mfma_f32_16x16x32_bf16 v[76:79], a[48:51], v[172:175], v[76:79]
  s_waitcnt lgkmcnt(10)
  v_mfma_f32_16x16x32_bf16 v[92:95], a[52:55], v[172:175], v[92:95]
  ds_read_b64_tr_b16 a[44:45], v193 offset:33032
  v_mfma_f32_16x16x32_bf16 v[88:91], a[52:55], v[168:171], v[88:91]
  v_mfma_f32_16x16x32_bf16 v[84:87], a[52:55], v[164:167], v[84:87]
  ds_read_b64_tr_b16 a[46:47], v193 offset:35080
  v_mfma_f32_16x16x32_bf16 v[80:83], a[52:55], v[160:163], v[80:83]
  s_waitcnt lgkmcnt(10)
  buffer_load_dwordx4 v200, s[8:11], s33 offen offset:2048 lds
  v_mfma_f32_16x16x32_bf16 v[96:99], a[56:59], v[160:163], v[96:99]
  ds_read_b64_tr_b16 a[48:49], v194 offset:33024
  v_mfma_f32_16x16x32_bf16 v[100:103], a[56:59], v[164:167], v[100:103]
  v_mfma_f32_16x16x32_bf16 v[104:107], a[56:59], v[168:171], v[104:107]
  ds_read_b64_tr_b16 a[50:51], v194 offset:35072
  v_mfma_f32_16x16x32_bf16 v[108:111], a[56:59], v[172:175], v[108:111]
  s_waitcnt lgkmcnt(10)
  buffer_load_dwordx4 v201, s[8:11], s33 offen offset:3072 lds
  v_mfma_f32_16x16x32_bf16 v[124:127], a[60:63], v[172:175], v[124:127]
  s_add_u32 s33, s33, 262144
  ds_read_b64_tr_b16 a[52:53], v194 offset:33032
  v_mfma_f32_16x16x32_bf16 v[120:123], a[60:63], v[168:171], v[120:123]
  s_pack_ll_b32_b16 m0, s31, 1
  v_mfma_f32_16x16x32_bf16 v[116:119], a[60:63], v[164:167], v[116:119]
  ds_read_b64_tr_b16 a[54:55], v194 offset:35080
  v_mfma_f32_16x16x32_bf16 v[112:115], a[60:63], v[160:163], v[112:115]
  s_waitcnt lgkmcnt(10)
  v_mfma_f32_16x16x32_bf16 a[64:67], a[32:35], v[160:163], a[64:67]
  ds_read_b64_tr_b16 a[56:57], v195 offset:33024
  v_mfma_f32_16x16x32_bf16 a[68:71], a[32:35], v[164:167], a[68:71]
  buffer_load_dwordx4 v225, s[16:19], s31 offen offset:0 nt lds
  v_mfma_f32_16x16x32_bf16 a[72:75], a[32:35], v[168:171], a[72:75]
  s_addk_i32 s31, 0x1000
  ds_read_b64_tr_b16 a[58:59], v195 offset:35072
  v_mfma_f32_16x16x32_bf16 a[76:79], a[32:35], v[172:175], a[76:79]
  s_waitcnt lgkmcnt(10)
  v_mfma_f32_16x16x32_bf16 a[92:95], a[36:39], v[172:175], a[92:95]
  ds_read_b64_tr_b16 a[60:61], v195 offset:33032
  v_mfma_f32_16x16x32_bf16 a[88:91], a[36:39], v[168:171], a[88:91]
  v_mfma_f32_16x16x32_bf16 a[84:87], a[36:39], v[164:167], a[84:87]
  ds_read_b64_tr_b16 a[62:63], v195 offset:35080
  v_mfma_f32_16x16x32_bf16 a[80:83], a[36:39], v[160:163], a[80:83]
  s_waitcnt lgkmcnt(10)
  global_load_dword v253, v235, s[98:99]
  v_mfma_f32_16x16x32_bf16 a[96:99], a[40:43], v[160:163], a[96:99]
  v_mfma_f32_16x16x32_bf16 a[100:103], a[40:43], v[164:167], a[100:103]
  v_mfma_f32_16x16x32_bf16 a[104:107], a[40:43], v[168:171], a[104:107]
  v_mfma_f32_16x16x32_bf16 a[108:111], a[40:43], v[172:175], a[108:111]
  s_waitcnt lgkmcnt(8)
  v_mfma_f32_16x16x32_bf16 a[124:127], a[44:47], v[172:175], a[124:127]
  s_waitcnt vmcnt(20) lgkmcnt(0)
  v_mfma_f32_16x16x32_bf16 a[120:123], a[44:47], v[168:171], a[120:123]
  s_barrier
  v_mfma_f32_16x16x32_bf16 a[116:119], a[44:47], v[164:167], a[116:119]
  ds_read_b64_tr_b16 a[32:33], v192 offset:49152
  v_mfma_f32_16x16x32_bf16 a[112:115], a[44:47], v[160:163], a[112:115]
  ds_read_b64_tr_b16 a[34:35], v192 offset:51200
  v_mfma_f32_16x16x32_bf16 a[192:195], a[48:51], v[160:163], a[192:195]
  ds_read_b64_tr_b16 a[36:37], v192 offset:49160
  v_mfma_f32_16x16x32_bf16 a[196:199], a[48:51], v[164:167], a[196:199]
  ds_read_b64_tr_b16 a[38:39], v192 offset:51208
  v_mfma_f32_16x16x32_bf16 a[200:203], a[48:51], v[168:171], a[200:203]
  ds_read_b64_tr_b16 a[40:41], v193 offset:49152
  v_mfma_f32_16x16x32_bf16 a[204:207], a[48:51], v[172:175], a[204:207]
  ds_read_b64_tr_b16 a[42:43], v193 offset:51200
  v_mfma_f32_16x16x32_bf16 a[220:223], a[52:55], v[172:175], a[220:223]
  v_mfma_f32_16x16x32_bf16 a[216:219], a[52:55], v[168:171], a[216:219]
  s_waitcnt vmcnt(15)
  ds_read_b64_tr_b16 a[44:45], v193 offset:49160
  v_mfma_f32_16x16x32_bf16 a[212:215], a[52:55], v[164:167], a[212:215]
  ds_read_b128 v[128:131], v240 offset:32768
  v_mfma_f32_16x16x32_bf16 a[208:211], a[52:55], v[160:163], a[208:211]
  ds_read_b128 v[132:135], v241 offset:32768
  v_mfma_f32_16x16x32_bf16 a[224:227], a[56:59], v[160:163], a[224:227]
  ds_read_b128 v[144:147], v244 offset:32768
  v_mfma_f32_16x16x32_bf16 a[228:231], a[56:59], v[164:167], a[228:231]
  ds_read_b128 v[148:151], v245 offset:32768
  v_mfma_f32_16x16x32_bf16 a[232:235], a[56:59], v[168:171], a[232:235]
  ds_read_b64_tr_b16 a[46:47], v193 offset:51208
  v_mfma_f32_16x16x32_bf16 a[236:239], a[56:59], v[172:175], a[236:239]
  ds_read_b64_tr_b16 a[48:49], v194 offset:49152
  v_mfma_f32_16x16x32_bf16 a[252:255], a[60:63], v[172:175], a[252:255]
  ds_read_b64_tr_b16 a[50:51], v194 offset:51200
  v_mfma_f32_16x16x32_bf16 a[248:251], a[60:63], v[168:171], a[248:251]
  ds_read_b64_tr_b16 a[52:53], v194 offset:49160
  v_mfma_f32_16x16x32_bf16 a[244:247], a[60:63], v[164:167], a[244:247]
  ds_read_b64_tr_b16 a[54:55], v194 offset:51208
  v_mfma_f32_16x16x32_bf16 a[240:243], a[60:63], v[160:163], a[240:243]
  s_waitcnt lgkmcnt(14)
  v_mfma_f32_16x16x32_bf16 v[0:3], a[32:35], v[176:179], v[0:3]
  ds_read_b64_tr_b16 a[56:57], v195 offset:49152
  v_mfma_f32_16x16x32_bf16 v[4:7], a[32:35], v[180:183], v[4:7]
  s_waitcnt lgkmcnt(5)
  v_mfma_f32_16x16x32_bf16 v[8:11], a[32:35], v[184:187], v[8:11]
  s_add_u32 m0, s52, 32768
  ds_read_b64_tr_b16 a[58:59], v195 offset:51200
  v_mfma_f32_16x16x32_bf16 v[12:15], a[32:35], v[188:191], v[12:15]
  buffer_load_dwordx4 v202, s[4:7], s34 offen offset:0 lds
  v_mfma_f32_16x16x32_bf16 v[28:31], a[36:39], v[188:191], v[28:31]
  ds_read_b64_tr_b16 a[60:61], v195 offset:49160
  v_mfma_f32_16x16x32_bf16 v[24:27], a[36:39], v[184:187], v[24:27]
  buffer_load_dwordx4 v203, s[4:7], s34 offen offset:1024 lds
  v_mfma_f32_16x16x32_bf16 v[20:23], a[36:39], v[180:183], v[20:23]
  ds_read_b64_tr_b16 a[62:63], v195 offset:51208
  v_mfma_f32_16x16x32_bf16 v[16:19], a[36:39], v[176:179], v[16:19]
  buffer_load_dwordx4 v204, s[4:7], s34 offen offset:2048 lds
  v_mfma_f32_16x16x32_bf16 v[32:35], a[40:43], v[176:179], v[32:35]
  ds_read_b64_tr_b16 a[32:33], v192 offset:49408
  v_mfma_f32_16x16x32_bf16 v[36:39], a[40:43], v[180:183], v[36:39]
  buffer_load_dwordx4 v205, s[4:7], s34 offen offset:3072 lds
  v_mfma_f32_16x16x32_bf16 v[40:43], a[40:43], v[184:187], v[40:43]
  s_add_u32 s34, s34, 128
  ds_read_b64_tr_b16 a[34:35], v192 offset:51456
  v_mfma_f32_16x16x32_bf16 v[44:47], a[40:43], v[188:191], v[44:47]
  v_mfma_f32_16x16x32_bf16 v[60:63], a[44:47], v[188:191], v[60:63]
  s_add_u32 m0, s32, 49152
  ds_read_b64_tr_b16 a[36:37], v192 offset:49416
  v_mfma_f32_16x16x32_bf16 v[56:59], a[44:47], v[184:187], v[56:59]
  buffer_load_dwordx4 v198, s[8:11], s33 offen offset:0 lds
  v_mfma_f32_16x16x32_bf16 v[52:55], a[44:47], v[180:183], v[52:55]
  ds_read_b64_tr_b16 a[38:39], v192 offset:51464
  v_mfma_f32_16x16x32_bf16 v[48:51], a[44:47], v[176:179], v[48:51]
  s_waitcnt lgkmcnt(10)
  v_mfma_f32_16x16x32_bf16 v[64:67], a[48:51], v[176:179], v[64:67]
  ds_read_b64_tr_b16 a[40:41], v193 offset:49408
  v_mfma_f32_16x16x32_bf16 v[68:71], a[48:51], v[180:183], v[68:71]
  v_mfma_f32_16x16x32_bf16 v[72:75], a[48:51], v[184:187], v[72:75]
  ds_read_b64_tr_b16 a[42:43], v193 offset:51456
  v_mfma_f32_16x16x32_bf16 v[76:79], a[48:51], v[188:191], v[76:79]
  s_waitcnt lgkmcnt(10)
  buffer_load_dwordx4 v199, s[8:11], s33 offen offset:1024 lds
  v_mfma_f32_16x16x32_bf16 v[92:95], a[52:55], v[188:191], v[92:95]
  ds_read_b64_tr_b16 a[44:45], v193 offset:49416
  v_mfma_f32_16x16x32_bf16 v[88:91], a[52:55], v[184:187], v[88:91]
  v_mfma_f32_16x16x32_bf16 v[84:87], a[52:55], v[180:183], v[84:87]
  ds_read_b64_tr_b16 a[46:47], v193 offset:51464
  v_mfma_f32_16x16x32_bf16 v[80:83], a[52:55], v[176:179], v[80:83]
  s_waitcnt lgkmcnt(10)
  v_mfma_f32_16x16x32_bf16 v[96:99], a[56:59], v[176:179], v[96:99]
  ds_read_b64_tr_b16 a[48:49], v194 offset:49408
  v_mfma_f32_16x16x32_bf16 v[100:103], a[56:59], v[180:183], v[100:103]
  buffer_load_dwordx4 v200, s[8:11], s33 offen offset:2048 lds
  v_mfma_f32_16x16x32_bf16 v[104:107], a[56:59], v[184:187], v[104:107]
  ds_read_b64_tr_b16 a[50:51], v194 offset:51456
  v_mfma_f32_16x16x32_bf16 v[108:111], a[56:59], v[188:191], v[108:111]
  s_waitcnt lgkmcnt(10)
  v_mfma_f32_16x16x32_bf16 v[124:127], a[60:63], v[188:191], v[124:127]
  ds_read_b64_tr_b16 a[52:53], v194 offset:49416
  v_mfma_f32_16x16x32_bf16 v[120:123], a[60:63], v[184:187], v[120:123]
  v_mfma_f32_16x16x32_bf16 v[116:119], a[60:63], v[180:183], v[116:119]
  ds_read_b64_tr_b16 a[54:55], v194 offset:51464
  v_mfma_f32_16x16x32_bf16 v[112:115], a[60:63], v[176:179], v[112:115]
  s_waitcnt lgkmcnt(10)
  buffer_load_dwordx4 v201, s[8:11], s33 offen offset:3072 lds
  v_mfma_f32_16x16x32_bf16 a[64:67], a[32:35], v[176:179], a[64:67]
  s_add_u32 s33, s33, 262144
  ds_read_b64_tr_b16 a[56:57], v195 offset:49408
  v_mfma_f32_16x16x32_bf16 a[68:71], a[32:35], v[180:183], a[68:71]
  s_pack_ll_b32_b16 m0, s31, 1
  v_mfma_f32_16x16x32_bf16 a[72:75], a[32:35], v[184:187], a[72:75]
  ds_read_b64_tr_b16 a[58:59], v195 offset:51456
  v_mfma_f32_16x16x32_bf16 a[76:79], a[32:35], v[188:191], a[76:79]
  s_waitcnt lgkmcnt(10)
  v_mfma_f32_16x16x32_bf16 a[92:95], a[36:39], v[188:191], a[92:95]
  ds_read_b64_tr_b16 a[60:61], v195 offset:49416
  v_mfma_f32_16x16x32_bf16 a[88:91], a[36:39], v[184:187], a[88:91]
  v_mfma_f32_16x16x32_bf16 a[84:87], a[36:39], v[180:183], a[84:87]
  ds_read_b64_tr_b16 a[62:63], v195 offset:51464
  v_mfma_f32_16x16x32_bf16 a[80:83], a[36:39], v[176:179], a[80:83]
  s_waitcnt lgkmcnt(10)
  buffer_load_dwordx4 v225, s[16:19], s31 offen offset:0 nt lds
  v_mfma_f32_16x16x32_bf16 a[96:99], a[40:43], v[176:179], a[96:99]
  s_addk_i32 s31, 0x1000
  v_mfma_f32_16x16x32_bf16 a[100:103], a[40:43], v[180:183], a[100:103]
  v_mfma_f32_16x16x32_bf16 a[104:107], a[40:43], v[184:187], a[104:107]
  v_mfma_f32_16x16x32_bf16 a[108:111], a[40:43], v[188:191], a[108:111]
  s_waitcnt lgkmcnt(8)
  v_mfma_f32_16x16x32_bf16 a[124:127], a[44:47], v[188:191], a[124:127]
  s_waitcnt vmcnt(20) lgkmcnt(0)
  v_mfma_f32_16x16x32_bf16 a[120:123], a[44:47], v[184:187], a[120:123]
  s_barrier
  v_mfma_f32_16x16x32_bf16 a[116:119], a[44:47], v[180:183], a[116:119]
  ds_read_b64_tr_b16 a[32:33], v192 offset:0
  v_mfma_f32_16x16x32_bf16 a[112:115], a[44:47], v[176:179], a[112:115]
  ds_read_b64_tr_b16 a[34:35], v192 offset:2048
  v_mfma_f32_16x16x32_bf16 a[192:195], a[48:51], v[176:179], a[192:195]
  ds_read_b64_tr_b16 a[36:37], v192 offset:8
  v_mfma_f32_16x16x32_bf16 a[196:199], a[48:51], v[180:183], a[196:199]
  ds_read_b64_tr_b16 a[38:39], v192 offset:2056
  v_mfma_f32_16x16x32_bf16 a[200:203], a[48:51], v[184:187], a[200:203]
  ds_read_b64_tr_b16 a[40:41], v193 offset:0
  v_mfma_f32_16x16x32_bf16 a[204:207], a[48:51], v[188:191], a[204:207]
  ds_read_b64_tr_b16 a[42:43], v193 offset:2048
  v_mfma_f32_16x16x32_bf16 a[220:223], a[52:55], v[188:191], a[220:223]
  v_mfma_f32_16x16x32_bf16 a[216:219], a[52:55], v[184:187], a[216:219]
  s_waitcnt vmcnt(15)
  ds_read_b64_tr_b16 a[44:45], v193 offset:8
  v_mfma_f32_16x16x32_bf16 a[212:215], a[52:55], v[180:183], a[212:215]
  ds_read_b128 v[136:139], v242 offset:32768
  v_mfma_f32_16x16x32_bf16 a[208:211], a[52:55], v[176:179], a[208:211]
  ds_read_b128 v[140:143], v243 offset:32768
  v_mfma_f32_16x16x32_bf16 a[224:227], a[56:59], v[176:179], a[224:227]
  ds_read_b128 v[152:155], v246 offset:32768
  v_mfma_f32_16x16x32_bf16 a[228:231], a[56:59], v[180:183], a[228:231]
  ds_read_b128 v[156:159], v247 offset:32768
  v_mfma_f32_16x16x32_bf16 a[232:235], a[56:59], v[184:187], a[232:235]
  ds_read_b64_tr_b16 a[46:47], v193 offset:2056
  v_mfma_f32_16x16x32_bf16 a[236:239], a[56:59], v[188:191], a[236:239]
  ds_read_b64_tr_b16 a[48:49], v194 offset:0
  v_mfma_f32_16x16x32_bf16 a[252:255], a[60:63], v[188:191], a[252:255]
  ds_read_b64_tr_b16 a[50:51], v194 offset:2048
  v_mfma_f32_16x16x32_bf16 a[248:251], a[60:63], v[184:187], a[248:251]
  ds_read_b64_tr_b16 a[52:53], v194 offset:8
  v_mfma_f32_16x16x32_bf16 a[244:247], a[60:63], v[180:183], a[244:247]
  ds_read_b64_tr_b16 a[54:55], v194 offset:2056
  v_mfma_f32_16x16x32_bf16 a[240:243], a[60:63], v[176:179], a[240:243]
  s_sub_u32 s28, s28, 1
  s_cmp_lg_u32 s28, 0
  s_cbranch_scc1 L_qloop
L_qtail:
  s_lshl_b32 s55, s24, 12
  s_add_u32 s55, s55, L_head-L_pc-1024
  v_and_b32 v233, 31, v231
  v_lshl_add_u32 v233, v233, 7, s55
  s_waitcnt lgkmcnt(14)
  v_mfma_f32_16x16x32_bf16 v[0:3], a[32:35], v[128:131], v[0:3]
  ds_read_b64_tr_b16 a[56:57], v195 offset:0
  v_mfma_f32_16x16x32_bf16 v[4:7], a[32:35], v[132:135], v[4:7]
  s_waitcnt lgkmcnt(5)
  v_mfma_f32_16x16x32_bf16 v[8:11], a[32:35], v[136:139], v[8:11]
  s_add_u32 m0, s52, 36864
  ds_read_b64_tr_b16 a[58:59], v195 offset:2048
  v_mfma_f32_16x16x32_bf16 v[12:15], a[32:35], v[140:143], v[12:15]
  buffer_load_dwordx4 v202, s[4:7], s35 offen offset:0 lds
  v_mfma_f32_16x16x32_bf16 v[28:31], a[36:39], v[140:143], v[28:31]
  ds_read_b64_tr_b16 a[60:61], v195 offset:8
  v_mfma_f32_16x16x32_bf16 v[24:27], a[36:39], v[136:139], v[24:27]
  buffer_load_dwordx4 v203, s[4:7], s35 offen offset:1024 lds
  v_mfma_f32_16x16x32_bf16 v[20:23], a[36:39], v[132:135], v[20:23]
  ds_read_b64_tr_b16 a[62:63], v195 offset:2056
  v_mfma_f32_16x16x32_bf16 v[16:19], a[36:39], v[128:131], v[16:19]
  buffer_load_dwordx4 v204, s[4:7], s35 offen offset:2048 lds
  v_mfma_f32_16x16x32_bf16 v[32:35], a[40:43], v[128:131], v[32:35]
  ds_read_b64_tr_b16 a[32:33], v192 offset:256
  v_mfma_f32_16x16x32_bf16 v[36:39], a[40:43], v[132:135], v[36:39]
  buffer_load_dwordx4 v205, s[4:7], s35 offen offset:3072 lds
  v_mfma_f32_16x16x32_bf16 v[40:43], a[40:43], v[136:139], v[40:43]
  s_add_u32 s35, s35, 128
  ds_read_b64_tr_b16 a[34:35], v192 offset:2304
  v_mfma_f32_16x16x32_bf16 v[44:47], a[40:43], v[140:143], v[44:47]
  v_mfma_f32_16x16x32_bf16 v[60:63], a[44:47], v[140:143], v[60:63]
  s_add_u32 m0, s32, 65536
  ds_read_b64_tr_b16 a[36:37], v192 offset:264
  v_mfma_f32_16x16x32_bf16 v[56:59], a[44:47], v[136:139], v[56:59]
  buffer_load_dwordx4 v198, s[8:11], s33 offen offset:0 lds
  v_mfma_f32_16x16x32_bf16 v[52:55], a[44:47], v[132:135], v[52:55]
  ds_read_b64_tr_b16 a[38:39], v192 offset:2312
  v_mfma_f32_16x16x32_bf16 v[48:51], a[44:47], v[128:131], v[48:51]
  s_waitcnt lgkmcnt(10)
  v_mfma_f32_16x16x32_bf16 v[64:67], a[48:51], v[128:131], v[64:67]
  ds_read_b64_tr_b16 a[40:41], v193 offset:256
  v_mfma_f32_16x16x32_bf16 v[68:71], a[48:51], v[132:135], v[68:71]
  v_mfma_f32_16x16x32_bf16 v[72:75], a[48:51], v[136:139], v[72:75]
  ds_read_b64_tr_b16 a[42:43], v193 offset:2304
  v_mfma_f32_16x16x32_bf16 v[76:79], a[48:51], v[140:143], v[76:79]
  s_waitcnt lgkmcnt(10)
  buffer_load_dwordx4 v199, s[8:11], s33 offen offset:1024 lds
  v_mfma_f32_16x16x32_bf16 v[92:95], a[52:55], v[140:143], v[92:95]
  ds_read_b64_tr_b16 a[44:45], v193 offset:264
  v_mfma_f32_16x16x32_bf16 v[88:91], a[52:55], v[136:139], v[88:91]
  v_mfma_f32_16x16x32_bf16 v[84:87], a[52:55], v[132:135], v[84:87]
  ds_read_b64_tr_b16 a[46:47], v193 offset:2312
  v_mfma_f32_16x16x32_bf16 v[80:83], a[52:55], v[128:131], v[80:83]
  s_waitcnt lgkmcnt(10)
  v_mfma_f32_16x16x32_bf16 v[96:99], a[56:59], v[128:131], v[96:99]
  ds_read_b64_tr_b16 a[48:49], v194 offset:256
  v_mfma_f32_16x16x32_bf16 v[100:103], a[56:59], v[132:135], v[100:103]
  buffer_load_dwordx4 v200, s[8:11], s33 offen offset:2048 lds
  v_mfma_f32_16x16x32_bf16 v[104:107], a[56:59], v[136:139], v[104:107]
  ds_read_b64_tr_b16 a[50:51], v194 offset:2304
  v_mfma_f32_16x16x32_bf16 v[108:111], a[56:59], v[140:143], v[108:111]
  s_waitcnt lgkmcnt(10)
  v_mfma_f32_16x16x32_bf16 v[124:127], a[60:63], v[140:143], v[124:127]
  ds_read_b64_tr_b16 a[52:53], v194 offset:264
  v_mfma_f32_16x16x32_bf16 v[120:123], a[60:63], v[136:139], v[120:123]
  v_mfma_f32_16x16x32_bf16 v[116:119], a[60:63], v[132:135], v[116:119]
  ds_read_b64_tr_b16 a[54:55], v194 offset:2312
  v_mfma_f32_16x16x32_bf16 v[112:115], a[60:63], v[128:131], v[112:115]
  s_waitcnt lgkmcnt(10)
  buffer_load_dwordx4 v201, s[8:11], s33 offen offset:3072 lds
  v_mfma_f32_16x16x32_bf16 a[64:67], a[32:35], v[128:131], a[64:67]
  s_add_u32 s33, s33, 262144
  ds_read_b64_tr_b16 a[56:57], v195 offset:256
  v_mfma_f32_16x16x32_bf16 a[68:71], a[32:35], v[132:135], a[68:71]
  v_mfma_f32_16x16x32_bf16 a[72:75], a[32:35], v[136:139], a[72:75]
  ds_read_b64_tr_b16 a[58:59], v195 offset:2304
  v_mfma_f32_16x16x32_bf16 a[76:79], a[32:35], v[140:143], a[76:79]
  s_waitcnt lgkmcnt(10)
  v_mfma_f32_16x16x32_bf16 a[92:95], a[36:39], v[140:143], a[92:95]
  ds_read_b64_tr_b16 a[60:61], v195 offset:264
  v_mfma_f32_16x16x32_bf16 a[88:91], a[36:39], v[136:139], a[88:91]
  v_mfma_f32_16x16x32_bf16 a[84:87], a[36:39], v[132:135], a[84:87]
  ds_read_b64_tr_b16 a[62:63], v195 offset:2312
  v_mfma_f32_16x16x32_bf16 a[80:83], a[36:39], v[128:131], a[80:83]
  s_waitcnt lgkmcnt(10)
  global_load_dword v253, v233, s[98:99]
  v_mfma_f32_16x16x32_bf16 a[96:99], a[40:43], v[128:131], a[96:99]
  v_mfma_f32_16x16x32_bf16 a[100:103], a[40:43], v[132:135], a[100:103]
  v_mfma_f32_16x16x32_bf16 a[104:107], a[40:43], v[136:139], a[104:107]
  v_mfma_f32_16x16x32_bf16 a[108:111], a[40:43], v[140:143], a[108:111]
  s_waitcnt lgkmcnt(8)
  v_mfma_f32_16x16x32_bf16 a[124:127], a[44:47], v[140:143], a[124:127]
  s_waitcnt vmcnt(20) lgkmcnt(0)
  v_mfma_f32_16x16x32_bf16 a[120:123], a[44:47], v[136:139], a[120:123]
  s_barrier
  v_mfma_f32_16x16x32_bf16 a[116:119], a[44:47], v[132:135], a[116:119]
  ds_read_b64_tr_b16 a[32:33], v192 offset:16384
  v_mfma_f32_16x16x32_bf16 a[112:115], a[44:47], v[128:131], a[112:115]
  ds_read_b64_tr_b16 a[34:35], v192 offset:18432
  v_mfma_f32_16x16x32_bf16 a[192:195], a[48:51], v[128:131], a[192:195]
  ds_read_b64_tr_b16 a[36:37], v192 offset:16392
  v_mfma_f32_16x16x32_bf16 a[196:199], a[48:51], v[132:135], a[196:199]
  ds_read_b64_tr_b16 a[38:39], v192 offset:18440
  v_mfma_f32_16x16x32_bf16 a[200:203], a[48:51], v[136:139], a[200:203]
  ds_read_b64_tr_b16 a[40:41], v193 offset:16384
  v_mfma_f32_16x16x32_bf16 a[204:207], a[48:51], v[140:143], a[204:207]
  ds_read_b64_tr_b16 a[42:43], v193 offset:18432
  v_mfma_f32_16x16x32_bf16 a[220:223], a[52:55], v[140:143], a[220:223]
  v_mfma_f32_16x16x32_bf16 a[216:219], a[52:55], v[136:139], a[216:219]
  s_waitcnt vmcnt(14)
  ds_read_b64_tr_b16 a[44:45], v193 offset:16392
  v_mfma_f32_16x16x32_bf16 a[212:215], a[52:55], v[132:135], a[212:215]
  ds_read_b128 v[160:163], v240 offset:32768
  v_mfma_f32_16x16x32_bf16 a[208:211], a[52:55], v[128:131], a[208:211]
  ds_read_b128 v[164:167], v241 offset:32768
  v_mfma_f32_16x16x32_bf16 a[224:227], a[56:59], v[128:131], a[224:227]
  ds_read_b128 v[176:179], v244 offset:32768
  v_mfma_f32_16x16x32_bf16 a[228:231], a[56:59], v[132:135], a[228:231]
  ds_read_b128 v[180:183], v245 offset:32768
  v_mfma_f32_16x16x32_bf16 a[232:235], a[56:59], v[136:139], a[232:235]
  ds_read_b64_tr_b16 a[46:47], v193 offset:18440
  v_mfma_f32_16x16x32_bf16 a[236:239], a[56:59], v[140:143], a[236:239]
  ds_read_b64_tr_b16 a[48:49], v194 offset:16384
  v_mfma_f32_16x16x32_bf16 a[252:255], a[60:63], v[140:143], a[252:255]
  ds_read_b64_tr_b16 a[50:51], v194 offset:18432
  v_mfma_f32_16x16x32_bf16 a[248:251], a[60:63], v[136:139], a[248:251]
  ds_read_b64_tr_b16 a[52:53], v194 offset:16392
  v_mfma_f32_16x16x32_bf16 a[244:247], a[60:63], v[132:135], a[244:247]
  ds_read_b64_tr_b16 a[54:55], v194 offset:18440
  v_mfma_f32_16x16x32_bf16 a[240:243], a[60:63], v[128:131], a[240:243]
  s_waitcnt lgkmcnt(14)
  v_mfma_f32_16x16x32_bf16 v[0:3], a[32:35], v[144:147], v[0:3]
  ds_read_b64_tr_b16 a[56:57], v195 offset:16384
  v_mfma_f32_16x16x32_bf16 v[4:7], a[32:35], v[148:151], v[4:7]
  v_mfma_f32_16x16x32_bf16 v[8:11], a[32:35], v[152:155], v[8:11]
  s_pack_ll_b32_b16 m0, s30, 0
  ds_read_b64_tr_b16 a[58:59], v195 offset:18432
  v_mfma_f32_16x16x32_bf16 v[12:15], a[32:35], v[156:159], v[12:15]
  s_waitcnt lgkmcnt(14)
  buffer_load_dwordx4 v224, s[12:15], s30 offen offset:0 nt lds
  v_mfma_f32_16x16x32_bf16 v[28:31], a[36:39], v[156:159], v[28:31]
  s_addk_i32 s30, 0x1000
  ds_read_b64_tr_b16 a[60:61], v195 offset:16392
  v_mfma_f32_16x16x32_bf16 v[24:27], a[36:39], v[152:155], v[24:27]
  s_pack_ll_b32_b16 m0, s30, 0
  v_mfma_f32_16x16x32_bf16 v[20:23], a[36:39], v[148:151], v[20:23]
  ds_read_b64_tr_b16 a[62:63], v195 offset:18440
  v_mfma_f32_16x16x32_bf16 v[16:19], a[36:39], v[144:147], v[16:19]
  s_waitcnt lgkmcnt(14)
  v_mfma_f32_16x16x32_bf16 v[32:35], a[40:43], v[144:147], v[32:35]
  ds_read_b64_tr_b16 a[32:33], v192 offset:16640
  v_mfma_f32_16x16x32_bf16 v[36:39], a[40:43], v[148:151], v[36:39]
  v_mfma_f32_16x16x32_bf16 v[40:43], a[40:43], v[152:155], v[40:43]
  ds_read_b64_tr_b16 a[34:35], v192 offset:18688
  v_mfma_f32_16x16x32_bf16 v[44:47], a[40:43], v[156:159], v[44:47]
  s_waitcnt lgkmcnt(10)
  v_mfma_f32_16x16x32_bf16 v[60:63], a[44:47], v[156:159], v[60:63]
  ds_read_b64_tr_b16 a[36:37], v192 offset:16648
  v_mfma_f32_16x16x32_bf16 v[56:59], a[44:47], v[152:155], v[56:59]
  v_mfma_f32_16x16x32_bf16 v[52:55], a[44:47], v[148:151], v[52:55]
  ds_read_b64_tr_b16 a[38:39], v192 offset:18696
  v_mfma_f32_16x16x32_bf16 v[48:51], a[44:47], v[144:147], v[48:51]
  s_waitcnt lgkmcnt(10)
  buffer_load_dwordx4 v224, s[12:15], s30 offen offset:0 nt lds
  v_mfma_f32_16x16x32_bf16 v[64:67], a[48:51], v[144:147], v[64:67]
  s_addk_i32 s30, 0x1000
  ds_read_b64_tr_b16 a[40:41], v193 offset:16640
  v_mfma_f32_16x16x32_bf16 v[68:71], a[48:51], v[148:151], v[68:71]
  s_pack_ll_b32_b16 m0, s30, 0
  v_mfma_f32_16x16x32_bf16 v[72:75], a[48:51], v[152:155], v[72:75]
  ds_read_b64_tr_b16 a[42:43], v193 offset:18688
  v_mfma_f32_16x16x32_bf16 v[76:79], a[48:51], v[156:159], v[76:79]
  s_waitcnt lgkmcnt(10)
  v_mfma_f32_16x16x32_bf16 v[92:95], a[52:55], v[156:159], v[92:95]
  ds_read_b64_tr_b16 a[44:45], v193 offset:16648
  v_mfma_f32_16x16x32_bf16 v[88:91], a[52:55], v[152:155], v[88:91]
  v_mfma_f32_16x16x32_bf16 v[84:87], a[52:55], v[148:151], v[84:87]
  ds_read_b64_tr_b16 a[46:47], v193 offset:18696
  v_mfma_f32_16x16x32_bf16 v[80:83], a[52:55], v[144:147], v[80:83]
  s_waitcnt lgkmcnt(10)
  v_mfma_f32_16x16x32_bf16 v[96:99], a[56:59], v[144:147], v[96:99]
  ds_read_b64_tr_b16 a[48:49], v194 offset:16640
  v_mfma_f32_16x16x32_bf16 v[100:103], a[56:59], v[148:151], v[100:103]
  v_mfma_f32_16x16x32_bf16 v[104:107], a[56:59], v[152:155], v[104:107]
  ds_read_b64_tr_b16 a[50:51], v194 offset:18688
  v_mfma_f32_16x16x32_bf16 v[108:111], a[56:59], v[156:159], v[108:111]
  s_waitcnt lgkmcnt(10)
  buffer_load_dwordx4 v224, s[12:15], s30 offen offset:0 nt lds
  v_mfma_f32_16x16x32_bf16 v[124:127], a[60:63], v[156:159], v[124:127]
  s_addk_i32 s30, 0x1000
  ds_read_b64_tr_b16 a[52:53], v194 offset:16648
  v_mfma_f32_16x16x32_bf16 v[120:123], a[60:63], v[152:155], v[120:123]
  s_pack_ll_b32_b16 m0, s30, 0
  v_mfma_f32_16x16x32_bf16 v[116:119], a[60:63], v[148:151], v[116:119]
  ds_read_b64_tr_b16 a[54:55], v194 offset:18696
  v_mfma_f32_16x16x32_bf16 v[112:115], a[60:63], v[144:147], v[112:115]
  s_waitcnt lgkmcnt(10)
  v_mfma_f32_16x16x32_bf16 a[64:67], a[32:35], v[144:147], a[64:67]
  ds_read_b64_tr_b16 a[56:57], v195 offset:16640
  v_mfma_f32_16x16x32_bf16 a[68:71], a[32:35], v[148:151], a[68:71]
  v_mfma_f32_16x16x32_bf16 a[72:75], a[32:35], v[152:155], a[72:75]
  ds_read_b64_tr_b16 a[58:59], v195 offset:18688
  v_mfma_f32_16x16x32_bf16 a[76:79], a[32:35], v[156:159], a[76:79]
  s_waitcnt lgkmcnt(10)
  v_mfma_f32_16x16x32_bf16 a[92:95], a[36:39], v[156:159], a[92:95]
  ds_read_b64_tr_b16 a[60:61], v195 offset:16648
  v_mfma_f32_16x16x32_bf16 a[88:91], a[36:39], v[152:155], a[88:91]
  v_mfma_f32_16x16x32_bf16 a[84:87], a[36:39], v[148:151], a[84:87]
  ds_read_b64_tr_b16 a[62:63], v195 offset:18696
  v_mfma_f32_16x16x32_bf16 a[80:83], a[36:39], v[144:147], a[80:83]
  s_waitcnt lgkmcnt(10)
  buffer_load_dwordx4 v224, s[12:15], s30 offen offset:0 nt lds
  v_mfma_f32_16x16x32_bf16 a[96:99], a[40:43], v[144:147], a[96:99]
  s_addk_i32 s30, 0x1000
  v_mfma_f32_16x16x32_bf16 a[100:103], a[40:43], v[148:151], a[100:103]
  v_mfma_f32_16x16x32_bf16 a[104:107], a[40:43], v[152:155], a[104:107]
  v_mfma_f32_16x16x32_bf16 a[108:111], a[40:43], v[156:159], a[108:111]
  s_waitcnt lgkmcnt(8)
  v_mfma_f32_16x16x32_bf16 a[124:127], a[44:47], v[156:159], a[124:127]
  s_waitcnt vmcnt(14) lgkmcnt(0)
  v_mfma_f32_16x16x32_bf16 a[120:123], a[44:47], v[152:155], a[120:123]
  s_barrier
  v_mfma_f32_16x16x32_bf16 a[116:119], a[44:47], v[148:151], a[116:119]
  ds_read_b64_tr_b16 a[32:33], v192 offset:32768
  v_mfma_f32_16x16x32_bf16 a[112:115], a[44:47], v[144:147], a[112:115]
  ds_read_b64_tr_b16 a[34:35], v192 offset:34816
  v_mfma_f32_16x16x32_bf16 a[192:195], a[48:51], v[144:147], a[192:195]
  ds_read_b64_tr_b16 a[36:37], v192 offset:32776
  v_mfma_f32_16x16x32_bf16 a[196:199], a[48:51], v[148:151], a[196:199]
  ds_read_b64_tr_b16 a[38:39], v192 offset:34824
  v_mfma_f32_16x16x32_bf16 a[200:203], a[48:51], v[152:155], a[200:203]
  ds_read_b64_tr_b16 a[40:41], v193 offset:32768
  v_mfma_f32_16x16x32_bf16 a[204:207], a[48:51], v[156:159], a[204:207]
  ds_read_b64_tr_b16 a[42:43], v193 offset:34816
  v_mfma_f32_16x16x32_bf16 a[220:223], a[52:55], v[156:159], a[220:223]
  v_mfma_f32_16x16x32_bf16 a[216:219], a[52:55], v[152:155], a[216:219]
  s_waitcnt vmcnt(9)
  ds_read_b64_tr_b16 a[44:45], v193 offset:32776
  v_mfma_f32_16x16x32_bf16 a[212:215], a[52:55], v[148:151], a[212:215]
  ds_read_b128 v[168:171], v242 offset:32768
  v_mfma_f32_16x16x32_bf16 a[208:211], a[52:55], v[144:147], a[208:211]
  ds_read_b128 v[172:175], v243 offset:32768
  v_mfma_f32_16x16x32_bf16 a[224:227], a[56:59], v[144:147], a[224:227]
  ds_read_b128 v[184:187], v246 offset:32768
  v_mfma_f32_16x16x32_bf16 a[228:231], a[56:59], v[148:151], a[228:231]
  ds_read_b128 v[188:191], v247 offset:32768
  v_mfma_f32_16x16x32_bf16 a[232:235], a[56:59], v[152:155], a[232:235]
  ds_read_b64_tr_b16 a[46:47], v193 offset:34824
  v_mfma_f32_16x16x32_bf16 a[236:239], a[56:59], v[156:159], a[236:239]
  ds_read_b64_tr_b16 a[48:49], v194 offset:32768
  v_mfma_f32_16x16x32_bf16 a[252:255], a[60:63], v[156:159], a[252:255]
  ds_read_b64_tr_b16 a[50:51], v194 offset:34816
  v_mfma_f32_16x16x32_bf16 a[248:251], a[60:63], v[152:155], a[248:251]
  ds_read_b64_tr_b16 a[52:53], v194 offset:32776
  v_mfma_f32_16x16x32_bf16 a[244:247], a[60:63], v[148:151], a[244:247]
  ds_read_b64_tr_b16 a[54:55], v194 offset:34824
  v_mfma_f32_16x16x32_bf16 a[240:243], a[60:63], v[144:147], a[240:243]
  s_waitcnt lgkmcnt(14)
  v_mfma_f32_16x16x32_bf16 v[0:3], a[32:35], v[160:163], v[0:3]
  ds_read_b64_tr_b16 a[56:57], v195 offset:32768
  v_mfma_f32_16x16x32_bf16 v[4:7], a[32:35], v[164:167], v[4:7]
  s_waitcnt lgkmcnt(9)
  v_mfma_f32_16x16x32_bf16 v[8:11], a[32:35], v[168:171], v[8:11]
  s_waitcnt lgkmcnt(8)
  s_pack_ll_b32_b16 m0, s30, 0
  ds_read_b64_tr_b16 a[58:59], v195 offset:34816
  v_mfma_f32_16x16x32_bf16 v[12:15], a[32:35], v[172:175], v[12:15]
  buffer_load_dwordx4 v224, s[12:15], s30 offen offset:0 nt lds
  v_mfma_f32_16x16x32_bf16 v[28:31], a[36:39], v[172:175], v[28:31]
  s_addk_i32 s30, 0x1000
  ds_read_b64_tr_b16 a[60:61], v195 offset:32776
  v_mfma_f32_16x16x32_bf16 v[24:27], a[36:39], v[168:171], v[24:27]
  s_pack_ll_b32_b16 m0, s30, 0
  v_mfma_f32_16x16x32_bf16 v[20:23], a[36:39], v[164:167], v[20:23]
  ds_read_b64_tr_b16 a[62:63], v195 offset:34824
  v_mfma_f32_16x16x32_bf16 v[16:19], a[36:39], v[160:163], v[16:19]
  v_mfma_f32_16x16x32_bf16 v[32:35], a[40:43], v[160:163], v[32:35]
  ds_read_b64_tr_b16 a[32:33], v192 offset:33024
  v_mfma_f32_16x16x32_bf16 v[36:39], a[40:43], v[164:167], v[36:39]
  v_mfma_f32_16x16x32_bf16 v[40:43], a[40:43], v[168:171], v[40:43]
  ds_read_b64_tr_b16 a[34:35], v192 offset:35072
  v_mfma_f32_16x16x32_bf16 v[44:47], a[40:43], v[172:175], v[44:47]
  s_waitcnt lgkmcnt(10)
  v_mfma_f32_16x16x32_bf16 v[60:63], a[44:47], v[172:175], v[60:63]
  ds_read_b64_tr_b16 a[36:37], v192 offset:33032
  v_mfma_f32_16x16x32_bf16 v[56:59], a[44:47], v[168:171], v[56:59]
  v_mfma_f32_16x16x32_bf16 v[52:55], a[44:47], v[164:167], v[52:55]
  ds_read_b64_tr_b16 a[38:39], v192 offset:35080
  v_mfma_f32_16x16x32_bf16 v[48:51], a[44:47], v[160:163], v[48:51]
  s_waitcnt lgkmcnt(10)
  buffer_load_dwordx4 v224, s[12:15], s30 offen offset:0 nt lds
  v_mfma_f32_16x16x32_bf16 v[64:67], a[48:51], v[160:163], v[64:67]
  s_addk_i32 s30, 0x1000
  ds_read_b64_tr_b16 a[40:41], v193 offset:33024
  v_mfma_f32_16x16x32_bf16 v[68:71], a[48:51], v[164:167], v[68:71]
  s_pack_ll_b32_b16 m0, s30, 0
  v_mfma_f32_16x16x32_bf16 v[72:75], a[48:51], v[168:171], v[72:75]
  ds_read_b64_tr_b16 a[42:43], v193 offset:35072
  v_mfma_f32_16x16x32_bf16 v[76:79], a[48:51], v[172:175], v[76:79]
  s_waitcnt lgkmcnt(10)
  v_mfma_f32_16x16x32_bf16 v[92:95], a[52:55], v[172:175], v[92:95]
  ds_read_b64_tr_b16 a[44:45], v193 offset:33032
  v_mfma_f32_16x16x32_bf16 v[88:91], a[52:55], v[168:171], v[88:91]
  v_mfma_f32_16x16x32_bf16 v[84:87], a[52:55], v[164:167], v[84:87]
  ds_read_b64_tr_b16 a[46:47], v193 offset:35080
  v_mfma_f32_16x16x32_bf16 v[80:83], a[52:55], v[160:163], v[80:83]
  s_waitcnt lgkmcnt(10)
  v_mfma_f32_16x16x32_bf16 v[96:99], a[56:59], v[160:163], v[96:99]
  ds_read_b64_tr_b16 a[48:49], v194 offset:33024
  v_mfma_f32_16x16x32_bf16 v[100:103], a[56:59], v[164:167], v[100:103]
  v_mfma_f32_16x16x32_bf16 v[104:107], a[56:59], v[168:171], v[104:107]
  ds_read_b64_tr_b16 a[50:51], v194 offset:35072
  v_mfma_f32_16x16x32_bf16 v[108:111], a[56:59], v[172:175], v[108:111]
  s_waitcnt lgkmcnt(10)
  buffer_load_dwordx4 v224, s[12:15], s30 offen offset:0 nt lds
  v_mfma_f32_16x16x32_bf16 v[124:127], a[60:63], v[172:175], v[124:127]
  s_addk_i32 s30, 0x1000
  ds_read_b64_tr_b16 a[52:53], v194 offset:33032
  v_mfma_f32_16x16x32_bf16 v[120:123], a[60:63], v[168:171], v[120:123]
  s_pack_ll_b32_b16 m0, s30, 0
  v_mfma_f32_16x16x32_bf16 v[116:119], a[60:63], v[164:167], v[116:119]
  ds_read_b64_tr_b16 a[54:55], v194 offset:35080
  v_mfma_f32_16x16x32_bf16 v[112:115], a[60:63], v[160:163], v[112:115]
  s_waitcnt lgkmcnt(10)
  v_mfma_f32_16x16x32_bf16 a[64:67], a[32:35], v[160:163], a[64:67]
  ds_read_b64_tr_b16 a[56:57], v195 offset:33024
  v_mfma_f32_16x16x32_bf16 a[68:71], a[32:35], v[164:167], a[68:71]
  v_mfma_f32_16x16x32_bf16 a[72:75], a[32:35], v[168:171], a[72:75]
  ds_read_b64_tr_b16 a[58:59], v195 offset:35072
  v_mfma_f32_16x16x32_bf16 a[76:79], a[32:35], v[172:175], a[76:79]
  s_waitcnt lgkmcnt(10)
  v_mfma_f32_16x16x32_bf16 a[92:95], a[36:39], v[172:175], a[92:95]
  ds_read_b64_tr_b16 a[60:61], v195 offset:33032
  v_mfma_f32_16x16x32_bf16 a[88:91], a[36:39], v[168:171], a[88:91]
  v_mfma_f32_16x16x32_bf16 a[84:87], a[36:39], v[164:167], a[84:87]
  ds_read_b64_tr_b16 a[62:63], v195 offset:35080
  v_mfma_f32_16x16x32_bf16 a[80:83], a[36:39], v[160:163], a[80:83]
  s_waitcnt lgkmcnt(10)
  buffer_load_dwordx4 v224, s[12:15], s30 offen offset:0 nt lds
  v_mfma_f32_16x16x32_bf16 a[96:99], a[40:43], v[160:163], a[96:99]
  s_addk_i32 s30, 0x1000
  v_mfma_f32_16x16x32_bf16 a[100:103], a[40:43], v[164:167], a[100:103]
  v_mfma_f32_16x16x32_bf16 a[104:107], a[40:43], v[168:171], a[104:107]
  v_mfma_f32_16x16x32_bf16 a[108:111], a[40:43], v[172:175], a[108:111]
  s_waitcnt lgkmcnt(8)
  v_mfma_f32_16x16x32_bf16 a[124:127], a[44:47], v[172:175], a[124:127]
  s_waitcnt vmcnt(9) lgkmcnt(0)
  v_mfma_f32_16x16x32_bf16 a[120:123], a[44:47], v[168:171], a[120:123]
  s_barrier
  v_mfma_f32_16x16x32_bf16 a[116:119], a[44:47], v[164:167], a[116:119]
  ds_read_b64_tr_b16 a[32:33], v192 offset:49152
  v_mfma_f32_16x16x32_bf16 a[112:115], a[44:47], v[160:163], a[112:115]
  ds_read_b64_tr_b16 a[34:35], v192 offset:51200
  v_mfma_f32_16x16x32_bf16 a[192:195], a[48:51], v[160:163], a[192:195]
  ds_read_b64_tr_b16 a[36:37], v192 offset:49160
  v_mfma_f32_16x16x32_bf16 a[196:199], a[48:51], v[164:167], a[196:199]
  ds_read_b64_tr_b16 a[38:39], v192 offset:51208
  v_mfma_f32_16x16x32_bf16 a[200:203], a[48:51], v[168:171], a[200:203]
  ds_read_b64_tr_b16 a[40:41], v193 offset:49152
  v_mfma_f32_16x16x32_bf16 a[204:207], a[48:51], v[172:175], a[204:207]
  ds_read_b64_tr_b16 a[42:43], v193 offset:51200
  v_mfma_f32_16x16x32_bf16 a[220:223], a[52:55], v[172:175], a[220:223]
  v_mfma_f32_16x16x32_bf16 a[216:219], a[52:55], v[168:171], a[216:219]
  ds_read_b64_tr_b16 a[44:45], v193 offset:49160
  v_mfma_f32_16x16x32_bf16 a[212:215], a[52:55], v[164:167], a[212:215]
  v_mfma_f32_16x16x32_bf16 a[208:211], a[52:55], v[160:163], a[208:211]
  v_mfma_f32_16x16x32_bf16 a[224:227], a[56:59], v[160:163], a[224:227]
  v_mfma_f32_16x16x32_bf16 a[228:231], a[56:59], v[164:167], a[228:231]
  v_mfma_f32_16x16x32_bf16 a[232:235], a[56:59], v[168:171], a[232:235]
  ds_read_b64_tr_b16 a[46:47], v193 offset:51208
  v_mfma_f32_16x16x32_bf16 a[236:239], a[56:59], v[172:175], a[236:239]
  ds_read_b64_tr_b16 a[48:49], v194 offset:49152
  v_mfma_f32_16x16x32_bf16 a[252:255], a[60:63], v[172:175], a[252:255]
  ds_read_b64_tr_b16 a[50:51], v194 offset:51200
  v_mfma_f32_16x16x32_bf16 a[248:251], a[60:63], v[168:171], a[248:251]
  ds_read_b64_tr_b16 a[52:53], v194 offset:49160
  v_mfma_f32_16x16x32_bf16 a[244:247], a[60:63], v[164:167], a[244:247]
  ds_read_b64_tr_b16 a[54:55], v194 offset:51208
  v_mfma_f32_16x16x32_bf16 a[240:243], a[60:63], v[160:163], a[240:243]
  s_waitcnt lgkmcnt(10)
  v_mfma_f32_16x16x32_bf16 v[0:3], a[32:35], v[176:179], v[0:3]
  ds_read_b64_tr_b16 a[56:57], v195 offset:49152
  v_mfma_f32_16x16x32_bf16 v[4:7], a[32:35], v[180:183], v[4:7]
  v_mfma_f32_16x16x32_bf16 v[8:11], a[32:35], v[184:187], v[8:11]
  s_pack_ll_b32_b16 m0, s30, 0
  ds_read_b64_tr_b16 a[58:59], v195 offset:51200
  v_mfma_f32_16x16x32_bf16 v[12:15], a[32:35], v[188:191], v[12:15]
  s_waitcnt lgkmcnt(10)
  buffer_load_dwordx4 v224, s[12:15], s30 offen offset:0 nt lds
  v_mfma_f32_16x16x32_bf16 v[28:31], a[36:39], v[188:191], v[28:31]
  s_addk_i32 s30, 0x1000
  ds_read_b64_tr_b16 a[60:61], v195 offset:49160
  v_mfma_f32_16x16x32_bf16 v[24:27], a[36:39], v[184:187], v[24:27]
  s_pack_ll_b32_b16 m0, s30, 0
  v_mfma_f32_16x16x32_bf16 v[20:23], a[36:39], v[180:183], v[20:23]
  ds_read_b64_tr_b16 a[62:63], v195 offset:51208
  v_mfma_f32_16x16x32_bf16 v[16:19], a[36:39], v[176:179], v[16:19]
  s_waitcnt lgkmcnt(10)
  v_mfma_f32_16x16x32_bf16 v[32:35], a[40:43], v[176:179], v[32:35]
  ds_read_b64_tr_b16 a[32:33], v192 offset:49408
  v_mfma_f32_16x16x32_bf16 v[36:39], a[40:43], v[180:183], v[36:39]
  v_mfma_f32_16x16x32_bf16 v[40:43], a[40:43], v[184:187], v[40:43]
  ds_read_b64_tr_b16 a[34:35], v192 offset:51456
  v_mfma_f32_16x16x32_bf16 v[44:47], a[40:43], v[188:191], v[44:47]
  s_waitcnt lgkmcnt(10)
  v_mfma_f32_16x16x32_bf16 v[60:63], a[44:47], v[188:191], v[60:63]
  ds_read_b64_tr_b16 a[36:37], v192 offset:49416
  v_mfma_f32_16x16x32_bf16 v[56:59], a[44:47], v[184:187], v[56:59]
  v_mfma_f32_16x16x32_bf16 v[52:55], a[44:47], v[180:183], v[52:55]
  ds_read_b64_tr_b16 a[38:39], v192 offset:51464
  v_mfma_f32_16x16x32_bf16 v[48:51], a[44:47], v[176:179], v[48:51]
  s_waitcnt lgkmcnt(10)
  buffer_load_dwordx4 v224, s[12:15], s30 offen offset:0 nt lds
  v_mfma_f32_16x16x32_bf16 v[64:67], a[48:51], v[176:179], v[64:67]
  s_addk_i32 s30, 0x1000
  ds_read_b64_tr_b16 a[40:41], v193 offset:49408
  v_mfma_f32_16x16x32_bf16 v[68:71], a[48:51], v[180:183], v[68:71]
  s_pack_ll_b32_b16 m0, s30, 0
  v_mul_f32 v0, s26, v0
  v_mul_f32 v1, s26, v1
  v_mfma_f32_16x16x32_bf16 v[72:75], a[48:51], v[184:187], v[72:75]
  ds_read_b64_tr_b16 a[42:43], v193 offset:51456
  v_mfma_f32_16x16x32_bf16 v[76:79], a[48:51], v[188:191], v[76:79]
  s_waitcnt lgkmcnt(10)
  v_mul_f32 v2, s26, v2
  v_mul_f32 v3, s26, v3
  v_mfma_f32_16x16x32_bf16 v[92:95], a[52:55], v[188:191], v[92:95]
  ds_read_b64_tr_b16 a[44:45], v193 offset:49416
  v_mfma_f32_16x16x32_bf16 v[88:91], a[52:55], v[184:187], v[88:91]
  v_mul_f32 v16, s26, v16
  v_mul_f32 v17, s26, v17
  v_mfma_f32_16x16x32_bf16 v[84:87], a[52:55], v[180:183], v[84:87]
  ds_read_b64_tr_b16 a[46:47], v193 offset:51464
  v_mfma_f32_16x16x32_bf16 v[80:83], a[52:55], v[176:179], v[80:83]
  s_waitcnt lgkmcnt(10)
  v_mul_f32 v18, s26, v18
  v_mul_f32 v19, s26, v19
  v_mfma_f32_16x16x32_bf16 v[96:99], a[56:59], v[176:179], v[96:99]
  ds_read_b64_tr_b16 a[48:49], v194 offset:49408
  v_mfma_f32_16x16x32_bf16 v[100:103], a[56:59], v[180:183], v[100:103]
  v_cvt_pk_bf16_f32 v128, v0, v1
  v_cvt_pk_bf16_f32 v129, v2, v3
  v_mfma_f32_16x16x32_bf16 v[104:107], a[56:59], v[184:187], v[104:107]
  ds_read_b64_tr_b16 a[50:51], v194 offset:51456
  v_mfma_f32_16x16x32_bf16 v[108:111], a[56:59], v[188:191], v[108:111]
  s_waitcnt lgkmcnt(10)
  buffer_load_dwordx4 v224, s[12:15], s30 offen offset:0 nt lds
  v_cvt_pk_bf16_f32 v130, v16, v17
  v_cvt_pk_bf16_f32 v131, v18, v19
  v_mfma_f32_16x16x32_bf16 v[124:127], a[60:63], v[188:191], v[124:127]
  s_addk_i32 s30, 0x1000
  ds_read_b64_tr_b16 a[52:53], v194 offset:49416
  v_mfma_f32_16x16x32_bf16 v[120:123], a[60:63], v[184:187], v[120:123]
  s_pack_ll_b32_b16 m0, s30, 0
  v_accvgpr_write_b32 a128, v128
  v_accvgpr_write_b32 a129, v129
  v_mfma_f32_16x16x32_bf16 v[116:119], a[60:63], v[180:183], v[116:119]
  ds_read_b64_tr_b16 a[54:55], v194 offset:51464
  v_mfma_f32_16x16x32_bf16 v[112:115], a[60:63], v[176:179], v[112:115]
  s_waitcnt lgkmcnt(10)
  v_accvgpr_write_b32 a130, v130
  v_accvgpr_write_b32 a131, v131
  v_mfma_f32_16x16x32_bf16 a[64:67], a[32:35], v[176:179], a[64:67]
  ds_read_b64_tr_b16 a[56:57], v195 offset:49408
  v_mfma_f32_16x16x32_bf16 a[68:71], a[32:35], v[180:183], a[68:71]
  v_mul_f32 v4, s26, v4
  v_mul_f32 v5, s26, v5
  v_mfma_f32_16x16x32_bf16 a[72:75], a[32:35], v[184:187], a[72:75]
  ds_read_b64_tr_b16 a[58:59], v195 offset:51456
  v_mfma_f32_16x16x32_bf16 a[76:79], a[32:35], v[188:191], a[76:79]
  s_waitcnt lgkmcnt(10)
  v_mul_f32 v6, s26, v6
  v_mul_f32 v7, s26, v7
  v_mfma_f32_16x16x32_bf16 a[92:95], a[36:39], v[188:191], a[92:95]
  ds_read_b64_tr_b16 a[60:61], v195 offset:49416
  v_mfma_f32_16x16x32_bf16 a[88:91], a[36:39], v[184:187], a[88:91]
  v_mul_f32 v20, s26, v20
  v_mul_f32 v21, s26, v21
  v_mfma_f32_16x16x32_bf16 a[84:87], a[36:39], v[180:183], a[84:87]
  ds_read_b64_tr_b16 a[62:63], v195 offset:51464
  v_mfma_f32_16x16x32_bf16 a[80:83], a[36:39], v[176:179], a[80:83]
  s_waitcnt lgkmcnt(10)
  buffer_load_dwordx4 v224, s[12:15], s30 offen offset:0 nt lds
  v_mul_f32 v22, s26, v22
  v_mul_f32 v23, s26, v23
  v_mfma_f32_16x16x32_bf16 a[96:99], a[40:43], v[176:179], a[96:99]
  s_addk_i32 s30, 0x1000
  v_cvt_pk_bf16_f32 v132, v4, v5
  v_cvt_pk_bf16_f32 v133, v6, v7
  v_mfma_f32_16x16x32_bf16 a[100:103], a[40:43], v[180:183], a[100:103]
  v_cvt_pk_bf16_f32 v134, v20, v21
  v_cvt_pk_bf16_f32 v135, v22, v23
  v_mfma_f32_16x16x32_bf16 a[104:107], a[40:43], v[184:187], a[104:107]
  v_accvgpr_write_b32 a144, v132
  v_accvgpr_write_b32 a145, v133
  v_mfma_f32_16x16x32_bf16 a[108:111], a[40:43], v[188:191], a[108:111]
  s_waitcnt lgkmcnt(8)
  v_accvgpr_write_b32 a146, v134
  v_accvgpr_write_b32 a147, v135
  v_mfma_f32_16x16x32_bf16 a[124:127], a[44:47], v[188:191], a[124:127]
  s_waitcnt vmcnt(49) lgkmcnt(0)
  v_mul_f32 v8, s26, v8
  v_mul_f32 v9, s26, v9
  v_mfma_f32_16x16x32_bf16 a[120:123], a[44:47], v[184:187], a[120:123]
  s_barrier
  v_mul_f32 v10, s26, v10
  v_mul_f32 v11, s26, v11
  v_mfma_f32_16x16x32_bf16 a[116:119], a[44:47], v[180:183], a[116:119]
  ds_read_b128 a[0:3], v212 offset:0
  ds_read_b128 a[4:7], v213 offset:0
  v_mfma_f32_16x16x32_bf16 a[112:115], a[44:47], v[176:179], a[112:115]
  v_mul_f32 v24, s26, v24
  v_mul_f32 v25, s26, v25
  v_mfma_f32_16x16x32_bf16 a[192:195], a[48:51], v[176:179], a[192:195]
  v_mul_f32 v26, s26, v26
  v_mul_f32 v27, s26, v27
  v_mfma_f32_16x16x32_bf16 a[196:199], a[48:51], v[180:183], a[196:199]
  v_cvt_pk_bf16_f32 v136, v8, v9
  v_cvt_pk_bf16_f32 v137, v10, v11
  v_mfma_f32_16x16x32_bf16 a[200:203], a[48:51], v[184:187], a[200:203]
  ds_read_b128 a[8:11], v214 offset:0
  ds_read_b128 a[12:15], v215 offset:0
  v_mfma_f32_16x16x32_bf16 a[204:207], a[48:51], v[188:191], a[204:207]
  v_cvt_pk_bf16_f32 v138, v24, v25
  v_cvt_pk_bf16_f32 v139, v26, v27
  v_mfma_f32_16x16x32_bf16 a[220:223], a[52:55], v[188:191], a[220:223]
  v_accvgpr_write_b32 a160, v136
  v_accvgpr_write_b32 a161, v137
  v_mfma_f32_16x16x32_bf16 a[216:219], a[52:55], v[184:187], a[216:219]
  v_accvgpr_write_b32 a162, v138
  v_accvgpr_write_b32 a163, v139
  v_mfma_f32_16x16x32_bf16 a[212:215], a[52:55], v[180:183], a[212:215]
  ds_read_b128 a[16:19], v212 offset:4096
  ds_read_b128 a[20:23], v213 offset:4096
  v_mfma_f32_16x16x32_bf16 a[208:211], a[52:55], v[176:179], a[208:211]
  v_mul_f32 v12, s26, v12
  v_mul_f32 v13, s26, v13
  v_mfma_f32_16x16x32_bf16 a[224:227], a[56:59], v[176:179], a[224:227]
  v_mul_f32 v14, s26, v14
  v_mul_f32 v15, s26, v15
  v_mfma_f32_16x16x32_bf16 a[228:231], a[56:59], v[180:183], a[228:231]
  v_mul_f32 v28, s26, v28
  v_mul_f32 v29, s26, v29
  v_mfma_f32_16x16x32_bf16 a[232:235], a[56:59], v[184:187], a[232:235]
  ds_read_b128 a[24:27], v214 offset:4096
  ds_read_b128 a[28:31], v215 offset:4096
  v_mfma_f32_16x16x32_bf16 a[236:239], a[56:59], v[188:191], a[236:239]
  v_mul_f32 v30, s26, v30
  v_mul_f32 v31, s26, v31
  v_mfma_f32_16x16x32_bf16 a[252:255], a[60:63], v[188:191], a[252:255]
  v_cvt_pk_bf16_f32 v140, v12, v13
  v_cvt_pk_bf16_f32 v141, v14, v15
  v_mfma_f32_16x16x32_bf16 a[248:251], a[60:63], v[184:187], a[248:251]
  v_cvt_pk_bf16_f32 v142, v28, v29
  v_cvt_pk_bf16_f32 v143, v30, v31
  v_mfma_f32_16x16x32_bf16 a[244:247], a[60:63], v[180:183], a[244:247]
  v_accvgpr_write_b32 a176, v140
  v_accvgpr_write_b32 a177, v141
  v_mfma_f32_16x16x32_bf16 a[240:243], a[60:63], v[176:179], a[240:243]
  v_accvgpr_write_b32 a178, v142
  v_accvgpr_write_b32 a179, v143
  v_mul_f32 v32, s26, v32
  v_mul_f32 v33, s26, v33
  v_mul_f32 v34, s26, v34
  v_mul_f32 v35, s26, v35
  v_mul_f32 v48, s26, v48
  v_mul_f32 v49, s26, v49
  v_mul_f32 v50, s26, v50
  v_mul_f32 v51, s26, v51
  v_cvt_pk_bf16_f32 v128, v32, v33
  v_cvt_pk_bf16_f32 v129, v34, v35
  v_cvt_pk_bf16_f32 v130, v48, v49
  v_cvt_pk_bf16_f32 v131, v50, v51
  v_accvgpr_write_b32 a132, v128
  v_accvgpr_write_b32 a133, v129
  v_accvgpr_write_b32 a134, v130
  v_accvgpr_write_b32 a135, v131
  v_pk_mul_f32 v[36:37], v[36:37], s[26:27]
  v_pk_mul_f32 v[38:39], v[38:39], s[26:27]
  v_pk_mul_f32 v[52:53], v[52:53], s[26:27]
  v_pk_mul_f32 v[54:55], v[54:55], s[26:27]
  v_cvt_pk_bf16_f32 v144, v36, v37
  v_cvt_pk_bf16_f32 v145, v38, v39
  v_cvt_pk_bf16_f32 v146, v52, v53
  v_cvt_pk_bf16_f32 v147, v54, v55
  v_accvgpr_write_b32 a148, v144
  v_accvgpr_write_b32 a149, v145
  v_accvgpr_write_b32 a150, v146
  v_accvgpr_write_b32 a151, v147
  v_pk_mul_f32 v[40:41], v[40:41], s[26:27]
  v_pk_mul_f32 v[42:43], v[42:43], s[26:27]
  v_pk_mul_f32 v[56:57], v[56:57], s[26:27]
  v_pk_mul_f32 v[58:59], v[58:59], s[26:27]
  v_cvt_pk_bf16_f32 v148, v40, v41
  v_cvt_pk_bf16_f32 v149, v42, v43
  v_cvt_pk_bf16_f32 v150, v56, v57
  v_cvt_pk_bf16_f32 v151, v58, v59
  v_accvgpr_write_b32 a164, v148
  v_accvgpr_write_b32 a165, v149
  s_pack_ll_b32_b16 m0, s31, 1
  v_accvgpr_write_b32 a166, v150
  v_accvgpr_write_b32 a167, v151
  v_pk_mul_f32 v[44:45], v[44:45], s[26:27]
  v_pk_mul_f32 v[46:47], v[46:47], s[26:27]
  v_pk_mul_f32 v[60:61], v[60:61], s[26:27]
  v_pk_mul_f32 v[62:63], v[62:63], s[26:27]
  v_cvt_pk_bf16_f32 v152, v44, v45
  v_cvt_pk_bf16_f32 v153, v46, v47
  v_cvt_pk_bf16_f32 v154, v60, v61
  v_cvt_pk_bf16_f32 v155, v62, v63
  v_accvgpr_write_b32 a180, v152
  v_accvgpr_write_b32 a181, v153
  v_accvgpr_write_b32 a182, v154
  v_accvgpr_write_b32 a183, v155
  v_pk_mul_f32 v[64:65], v[64:65], s[26:27]
  v_pk_mul_f32 v[66:67], v[66:67], s[26:27]
  v_pk_mul_f32 v[80:81], v[80:81], s[26:27]
  v_pk_mul_f32 v[82:83], v[82:83], s[26:27]
  v_cvt_pk_bf16_f32 v156, v64, v65
  v_cvt_pk_bf16_f32 v157, v66, v67
  v_cvt_pk_bf16_f32 v158, v80, v81
  v_cvt_pk_bf16_f32 v159, v82, v83
  buffer_load_dwordx4 v225, s[16:19], s31 offen offset:0 nt lds
  s_addk_i32 s31, 0x1000
  s_pack_ll_b32_b16 m0, s31, 1
  v_accvgpr_write_b32 a136, v156
  v_accvgpr_write_b32 a137, v157
  v_accvgpr_write_b32 a138, v158
  v_accvgpr_write_b32 a139, v159
  v_pk_mul_f32 v[68:69], v[68:69], s[26:27]
  v_pk_mul_f32 v[70:71], v[70:71], s[26:27]
  v_pk_mul_f32 v[84:85], v[84:85], s[26:27]
  v_pk_mul_f32 v[86:87], v[86:87], s[26:27]
  v_cvt_pk_bf16_f32 v144, v68, v69
  v_cvt_pk_bf16_f32 v145, v70, v71
  v_cvt_pk_bf16_f32 v146, v84, v85
  v_cvt_pk_bf16_f32 v147, v86, v87
  v_accvgpr_write_b32 a152, v144
  v_accvgpr_write_b32 a153, v145
  v_accvgpr_write_b32 a154, v146
  v_accvgpr_write_b32 a155, v147
  v_pk_mul_f32 v[72:73], v[72:73], s[26:27]
  v_pk_mul_f32 v[74:75], v[74:75], s[26:27]
  v_pk_mul_f32 v[88:89], v[88:89], s[26:27]
  v_pk_mul_f32 v[90:91], v[90:91], s[26:27]
  v_cvt_pk_bf16_f32 v148, v72, v73
  v_cvt_pk_bf16_f32 v149, v74, v75
  buffer_load_dwordx4 v225, s[16:19], s31 offen offset:0 nt lds
  s_addk_i32 s31, 0x1000
  s_pack_ll_b32_b16 m0, s31, 1
  v_cvt_pk_bf16_f32 v150, v88, v89
  v_cvt_pk_bf16_f32 v151, v90, v91
  v_accvgpr_write_b32 a168, v148
  v_accvgpr_write_b32 a169, v149
  v_accvgpr_write_b32 a170, v150
  v_accvgpr_write_b32 a171, v151
  v_pk_mul_f32 v[76:77], v[76:77], s[26:27]
  v_pk_mul_f32 v[78:79], v[78:79], s[26:27]
  v_pk_mul_f32 v[92:93], v[92:93], s[26:27]
  v_pk_mul_f32 v[94:95], v[94:95], s[26:27]
  v_cvt_pk_bf16_f32 v152, v76, v77
  v_cvt_pk_bf16_f32 v153, v78, v79
  v_cvt_pk_bf16_f32 v154, v92, v93
  v_cvt_pk_bf16_f32 v155, v94, v95
  v_accvgpr_write_b32 a184, v152
  v_accvgpr_write_b32 a185, v153
  v_accvgpr_write_b32 a186, v154
  v_accvgpr_write_b32 a187, v155
  v_pk_mul_f32 v[96:97], v[96:97], s[26:27]
  v_pk_mul_f32 v[98:99], v[98:99], s[26:27]
  v_pk_mul_f32 v[112:113], v[112:113], s[26:27]
  v_pk_mul_f32 v[114:115], v[114:115], s[26:27]
  buffer_load_dwordx4 v225, s[16:19], s31 offen offset:0 nt lds
  s_addk_i32 s31, 0x1000
  s_pack_ll_b32_b16 m0, s31, 1
  v_cvt_pk_bf16_f32 v156, v96, v97
  v_cvt_pk_bf16_f32 v157, v98, v99
  v_cvt_pk_bf16_f32 v158, v112, v113
  v_cvt_pk_bf16_f32 v159, v114, v115
  v_accvgpr_write_b32 a140, v156
  v_accvgpr_write_b32 a141, v157
  v_accvgpr_write_b32 a142, v158
  v_accvgpr_write_b32 a143, v159
  v_pk_mul_f32 v[100:101], v[100:101], s[26:27]
  v_pk_mul_f32 v[102:103], v[102:103], s[26:27]
  v_pk_mul_f32 v[116:117], v[116:117], s[26:27]
  v_pk_mul_f32 v[118:119], v[118:119], s[26:27]
  v_cvt_pk_bf16_f32 v144, v100, v101
  v_cvt_pk_bf16_f32 v145, v102, v103
  v_cvt_pk_bf16_f32 v146, v116, v117
  v_cvt_pk_bf16_f32 v147, v118, v119
  v_accvgpr_write_b32 a156, v144
  v_accvgpr_write_b32 a157, v145
  v_accvgpr_write_b32 a158, v146
  v_accvgpr_write_b32 a159, v147
  v_pk_mul_f32 v[104:105], v[104:105], s[26:27]
  v_pk_mul_f32 v[106:107], v[106:107], s[26:27]
  buffer_load_dwordx4 v225, s[16:19], s31 offen offset:0 nt lds
  s_addk_i32 s31, 0x1000
  v_pk_mul_f32 v[120:121], v[120:121], s[26:27]
  v_pk_mul_f32 v[122:123], v[122:123], s[26:27]
  v_cvt_pk_bf16_f32 v148, v104, v105
  v_cvt_pk_bf16_f32 v149, v106, v107
  v_cvt_pk_bf16_f32 v150, v120, v121
  v_cvt_pk_bf16_f32 v151, v122, v123
  v_accvgpr_write_b32 a172, v148
  v_accvgpr_write_b32 a173, v149
  v_accvgpr_write_b32 a174, v150
  v_accvgpr_write_b32 a175, v151
  v_pk_mul_f32 v[108:109], v[108:109], s[26:27]
  v_pk_mul_f32 v[110:111], v[110:111], s[26:27]
  v_pk_mul_f32 v[124:125], v[124:125], s[26:27]
  v_pk_mul_f32 v[126:127], v[126:127], s[26:27]
  v_cvt_pk_bf16_f32 v152, v108, v109
  v_cvt_pk_bf16_f32 v153, v110, v111
  v_cvt_pk_bf16_f32 v154, v124, v125
  v_cvt_pk_bf16_f32 v155, v126, v127
  v_accvgpr_write_b32 a188, v152
  v_accvgpr_write_b32 a189, v153
  v_accvgpr_write_b32 a190, v154
  v_accvgpr_write_b32 a191, v155
L_head:
  s_waitcnt lgkmcnt(7)
  v_mfma_f32_16x16x32_bf16 v[128:131], a[0:3], a[128:131], 0
  v_mov_b32 v208, 0
  v_mov_b32 v209, 0
  v_mfma_f32_16x16x32_bf16 v[136:139], a[0:3], a[144:147], 0
  v_mov_b32 v210, 0
  v_mov_b32 v211, 0
  v_mfma_f32_16x16x32_bf16 v[144:147], a[0:3], a[160:163], 0
  v_mov_b32 v226, 0
  v_mov_b32 v227, 0
  v_mfma_f32_16x16x32_bf16 v[152:155], a[0:3], a[176:179], 0
  s_waitcnt lgkmcnt(6)
  v_mov_b32 v228, 0
  v_mov_b32 v229, 0
  v_mfma_f32_16x16x32_bf16 v[128:131], a[4:7], a[132:135], v[128:131]
  ds_read_b128 a[0:3], v212 offset:8192
  v_mov_b32 v244, 0
  v_mfma_f32_16x16x32_bf16 v[136:139], a[4:7], a[148:151], v[136:139]
  v_mov_b32 v245, 0
  v_mov_b32 v246, 0
  v_mfma_f32_16x16x32_bf16 v[144:147], a[4:7], a[164:167], v[144:147]
  v_mov_b32 v247, 0
  v_mfma_f32_16x16x32_bf16 v[152:155], a[4:7], a[180:183], v[152:155]
  s_waitcnt lgkmcnt(6)
  v_mfma_f32_16x16x32_bf16 v[128:131], a[8:11], a[136:139], v[128:131]
  ds_read_b128 a[4:7], v213 offset:8192
  v_mfma_f32_16x16x32_bf16 v[136:139], a[8:11], a[152:155], v[136:139]
  v_mfma_f32_16x16x32_bf16 v[144:147], a[8:11], a[168:171], v[144:147]
  v_mfma_f32_16x16x32_bf16 v[152:155], a[8:11], a[184:187], v[152:155]
  s_waitcnt lgkmcnt(6)
  v_mfma_f32_16x16x32_bf16 v[128:131], a[12:15], a[140:143], v[128:131]
  ds_read_b128 a[8:11], v214 offset:8192
  v_mfma_f32_16x16x32_bf16 v[136:139], a[12:15], a[156:159], v[136:139]
  v_mfma_f32_16x16x32_bf16 v[144:147], a[12:15], a[172:175], v[144:147]
  v_mfma_f32_16x16x32_bf16 v[152:155], a[12:15], a[188:191], v[152:155]
  s_waitcnt lgkmcnt(6)
  v_mfma_f32_16x16x32_bf16 v[132:135], a[16:19], a[128:131], 0
  ds_read_b128 a[12:15], v215 offset:8192
  v_mfma_f32_16x16x32_bf16 v[140:143], a[16:19], a[144:147], 0
  v_mfma_f32_16x16x32_bf16 v[148:151], a[16:19], a[160:163], 0
  v_mfma_f32_16x16x32_bf16 v[156:159], a[16:19], a[176:179], 0
  s_waitcnt lgkmcnt(6)
  v_mfma_f32_16x16x32_bf16 v[132:135], a[20:23], a[132:135], v[132:135]
  ds_read_b128 a[16:19], v212 offset:12288
  v_mfma_f32_16x16x32_bf16 v[140:143], a[20:23], a[148:151], v[140:143]
  v_mfma_f32_16x16x32_bf16 v[148:151], a[20:23], a[164:167], v[148:151]
  v_mfma_f32_16x16x32_bf16 v[156:159], a[20:23], a[180:183], v[156:159]
  s_waitcnt lgkmcnt(6)
  v_mfma_f32_16x16x32_bf16 v[132:135], a[24:27], a[136:139], v[132:135]
  ds_read_b128 a[20:23], v213 offset:12288
  v_mfma_f32_16x16x32_bf16 v[140:143], a[24:27], a[152:155], v[140:143]
  v_mfma_f32_16x16x32_bf16 v[148:151], a[24:27], a[168:171], v[148:151]
  v_mfma_f32_16x16x32_bf16 v[156:159], a[24:27], a[184:187], v[156:159]
  s_waitcnt lgkmcnt(6)
  v_mfma_f32_16x16x32_bf16 v[132:135], a[28:31], a[140:143], v[132:135]
  ds_read_b128 a[24:27], v214 offset:12288
  v_mfma_f32_16x16x32_bf16 v[140:143], a[28:31], a[156:159], v[140:143]
  v_mfma_f32_16x16x32_bf16 v[148:151], a[28:31], a[172:175], v[148:151]
  v_mfma_f32_16x16x32_bf16 v[156:159], a[28:31], a[188:191], v[156:159]
  ds_read_b128 a[28:31], v215 offset:12288
L_head2:
  v_mfma_f32_32x32x16_bf16 v[0:15], v[244:247], v[244:247], 0
  v_mfma_f32_32x32x16_bf16 v[16:31], v[244:247], v[244:247], 0
  s_cmp_lg_u32 s54, 0
  s_nop 2
  s_cbranch_scc1 L_havemax
  v_max3_f32 v232, v128, v129, v130
  v_max3_f32 v232, v232, v131, v132
  v_max3_f32 v232, v232, v133, v134
  v_max_f32 v232, v232, v135
  v_max3_f32 v233, v136, v137, v138
  v_max3_f32 v233, v233, v139, v140
  v_max3_f32 v233, v233, v141, v142
  v_max_f32 v233, v233, v143
  v_max3_f32 v234, v144, v145, v146
  v_max3_f32 v234, v234, v147, v148
  v_max3_f32 v234, v234, v149, v150
  v_max_f32 v234, v234, v151
  v_max3_f32 v235, v152, v153, v154
  v_max3_f32 v235, v235, v155, v156
  v_max3_f32 v235, v235, v157, v158
  v_max_f32 v235, v235, v159
  v_mov_b32 v236, v232
  v_mov_b32 v237, v233
  v_mov_b32 v238, v234
  v_mov_b32 v239, v235
  v_permlane32_swap_b32 v236, v232
  v_permlane32_swap_b32 v237, v233
  v_permlane32_swap_b32 v238, v234
  v_permlane32_swap_b32 v239, v235
  v_max_f32 v232, v232, v236
  v_max_f32 v233, v233, v237
  v_max_f32 v234, v234, v238
  v_max_f32 v235, v235, v239
  v_mov_b32 v236, v232
  v_mov_b32 v237, v233
  v_mov_b32 v238, v234
  v_mov_b32 v239, v235
  v_permlane16_swap_b32 v236, v232
  v_permlane16_swap_b32 v237, v233
  v_permlane16_swap_b32 v238, v234
  v_permlane16_swap_b32 v239, v235
  v_max_f32 v232, v232, v236
  v_max_f32 v233, v233, v237
  v_max_f32 v234, v234, v238
  v_max_f32 v235, v235, v239
  v_mov_b32 v236, 0x7149f2ca
  s_lshl_b32 s55, s24, 2
  s_or_b32 s55, s55, s82
  s_cmp_eq_u32 s55, 15
  s_cselect_b64 vcc, -1, 0
  v_cndmask_b32 v232, v232, v236, vcc
  s_cmp_eq_u32 s55, 14
  s_cselect_b64 vcc, -1, 0
  v_cndmask_b32 v233, v233, v236, vcc
  s_cmp_eq_u32 s55, 13
  s_cselect_b64 vcc, -1, 0
  v_cndmask_b32 v234, v234, v236, vcc
  s_cmp_eq_u32 s55, 12
  s_cselect_b64 vcc, -1, 0
  v_cndmask_b32 v235, v235, v236, vcc
  v_sub_f32 v192, 0, v232
  v_sub_f32 v193, 0, v232
  v_sub_f32 v194, 0, v232
  v_sub_f32 v195, 0, v232
  v_sub_f32 v196, 0, v233
  v_sub_f32 v197, 0, v233
  v_sub_f32 v198, 0, v233
  v_sub_f32 v199, 0, v233
  v_sub_f32 v200, 0, v234
  v_sub_f32 v201, 0, v234
  v_sub_f32 v202, 0, v234
  v_sub_f32 v203, 0, v234
  v_sub_f32 v204, 0, v235
  v_sub_f32 v205, 0, v235
  v_sub_f32 v206, 0, v235
  v_sub_f32 v207, 0, v235
L_havemax:
  v_mfma_f32_32x32x16_bf16 v[32:47], v[244:247], v[244:247], 0
  v_add_f32 v128, v128, v192
  v_add_f32 v129, v129, v192
  v_add_f32 v130, v130, v192
  v_add_f32 v131, v131, v192
  v_add_f32 v132, v132, v192
  v_mfma_f32_32x32x16_bf16 v[48:63], v[244:247], v[244:247], 0
  v_add_f32 v133, v133, v192
  v_add_f32 v134, v134, v192
  v_add_f32 v135, v135, v192
  v_add_f32 v136, v136, v196
  v_add_f32 v137, v137, v196
  v_mfma_f32_32x32x16_bf16 v[64:79], v[244:247], v[244:247], 0
  v_add_f32 v138, v138, v196
  v_add_f32 v139, v139, v196
  v_add_f32 v140, v140, v196
  v_add_f32 v141, v141, v196
  v_add_f32 v142, v142, v196
  v_mfma_f32_32x32x16_bf16 v[80:95], v[244:247], v[244:247], 0
  v_add_f32 v143, v143, v196
  v_add_f32 v144, v144, v200
  v_add_f32 v145, v145, v200
  v_add_f32 v146, v146, v200
  v_add_f32 v147, v147, v200
  v_mfma_f32_32x32x16_bf16 v[96:111], v[244:247], v[244:247], 0
  v_add_f32 v148, v148, v200
  v_add_f32 v149, v149, v200
  v_add_f32 v150, v150, v200
  v_add_f32 v151, v151, v200
  v_add_f32 v152, v152, v204
  v_mfma_f32_32x32x16_bf16 v[112:127], v[244:247], v[244:247], 0
  v_add_f32 v153, v153, v204
  v_add_f32 v154, v154, v204
  v_add_f32 v155, v155, v204
  v_add_f32 v156, v156, v204
  v_add_f32 v157, v157, v204
  v_add_f32 v158, v158, v204
  v_add_f32 v159, v159, v204
  s_waitcnt lgkmcnt(0)
  s_barrier
  v_exp_f32 v135, v135
  v_exp_f32 v134, v134
  v_exp_f32 v133, v133
  v_cvt_pk_bf16_f32 v135, v134, v135
  v_exp_f32 v132, v132
  v_exp_f32 v131, v131
  s_pack_ll_b32_b16 m0, s30, 0
  v_cvt_pk_bf16_f32 v134, v132, v133
  v_exp_f32 v130, v130
  v_exp_f32 v129, v129
  v_cvt_pk_bf16_f32 v133, v130, v131
  v_exp_f32 v128, v128
  s_nop 0
  buffer_load_dwordx4 v224, s[12:15], s30 offen offset:0 nt lds
  s_addk_i32 s30, 0x1000
  s_pack_ll_b32_b16 m0, s30, 0
  v_cvt_pk_bf16_f32 v132, v128, v129
  v_exp_f32 v136, v136
  v_exp_f32 v137, v137
  v_exp_f32 v138, v138
  v_cvt_pk_bf16_f32 v136, v136, v137
  v_exp_f32 v139, v139
  buffer_load_dwordx4 v224, s[12:15], s30 offen offset:0 nt lds
  s_addk_i32 s30, 0x1000
  v_exp_f32 v140, v140
  v_cvt_pk_bf16_f32 v137, v138, v139
  v_exp_f32 v141, v141
  v_exp_f32 v142, v142
  v_cvt_pk_bf16_f32 v138, v140, v141
  v_exp_f32 v143, v143
  s_nop 0
  v_cvt_pk_bf16_f32 v139, v142, v143
  s_waitcnt lgkmcnt(0)
  s_mov_b32 s28, 4
.p2align 6
L_aloop:
  v_mfma_f32_16x16x32_bf16 v[160:163], a[0:3], a[128:131], v[192:195]
  v_exp_f32 v151, v151
  v_mfma_f32_16x16x32_bf16 v[160:163], a[4:7], a[132:135], v[160:163]
  ds_read_b64_tr_b16 a[32:33], v216 offset:16384
  ds_read_b64_tr_b16 a[34:35], v216 offset:20480
  v_mfma_f32_16x16x32_bf16 v[160:163], a[8:11], a[136:139], v[160:163]
  v_exp_f32 v150, v150
  v_mfma_f32_16x16x32_bf16 v[160:163], a[12:15], a[140:143], v[160:163]
  ds_read_b64_tr_b16 a[36:37], v217 offset:16384
  v_cvt_pk_bf16_f32 v151, v150, v151
  v_mfma_f32_16x16x32_bf16 v[164:167], a[28:31], a[140:143], v[192:195]
  v_exp_f32 v149, v149
  v_mfma_f32_16x16x32_bf16 v[164:167], a[24:27], a[136:139], v[164:167]
  ds_read_b64_tr_b16 a[38:39], v217 offset:20480
  ds_read_b64_tr_b16 a[40:41], v218 offset:16384
  v_mfma_f32_16x16x32_bf16 v[164:167], a[20:23], a[132:135], v[164:167]
  v_exp_f32 v148, v148
  v_mfma_f32_16x16x32_bf16 v[164:167], a[16:19], a[128:131], v[164:167]
  ds_read_b64_tr_b16 a[42:43], v218 offset:20480
  v_cvt_pk_bf16_f32 v150, v148, v149
  v_mfma_f32_16x16x32_bf16 v[172:175], a[16:19], a[144:147], v[196:199]
  v_exp_f32 v147, v147
  v_mfma_f32_16x16x32_bf16 v[172:175], a[20:23], a[148:151], v[172:175]
  ds_read_b64_tr_b16 a[44:45], v219 offset:16384
  ds_read_b64_tr_b16 a[46:47], v219 offset:20480
  v_mfma_f32_16x16x32_bf16 v[172:175], a[24:27], a[152:155], v[172:175]
  v_exp_f32 v146, v146
  v_mfma_f32_16x16x32_bf16 v[172:175], a[28:31], a[156:159], v[172:175]
  ds_read_b64_tr_b16 a[48:49], v220 offset:16384
  v_cvt_pk_bf16_f32 v149, v146, v147
  v_mfma_f32_16x16x32_bf16 v[168:171], a[12:15], a[156:159], v[196:199]
  v_exp_f32 v145, v145
  v_mfma_f32_16x16x32_bf16 v[168:171], a[8:11], a[152:155], v[168:171]
  ds_read_b64_tr_b16 a[50:51], v220 offset:20480
  v_mfma_f32_16x16x32_bf16 v[168:171], a[4:7], a[148:151], v[168:171]
  v_exp_f32 v144, v144
  v_mfma_f32_16x16x32_bf16 v[168:171], a[0:3], a[144:147], v[168:171]
  ds_read_b64_tr_b16 a[52:53], v221 offset:16384
  v_cvt_pk_bf16_f32 v148, v144, v145
  v_mfma_f32_16x16x32_bf16 v[176:179], a[0:3], a[160:163], v[200:203]
  v_exp_f32 v152, v152
  v_mfma_f32_16x16x32_bf16 v[176:179], a[4:7], a[164:167], v[176:179]
  ds_read_b64_tr_b16 a[54:55], v221 offset:20480
  v_mfma_f32_16x16x32_bf16 v[176:179], a[8:11], a[168:171], v[176:179]
  v_exp_f32 v153, v153
  v_mfma_f32_16x16x32_bf16 v[176:179], a[12:15], a[172:175], v[176:179]
  ds_read_b64_tr_b16 a[56:57], v222 offset:16384
  v_cvt_pk_bf16_f32 v152, v152, v153
  v_mfma_f32_16x16x32_bf16 v[180:183], a[28:31], a[172:175], v[200:203]
  v_exp_f32 v154, v154
  v_mfma_f32_16x16x32_bf16 v[180:183], a[24:27], a[168:171], v[180:183]
  ds_read_b64_tr_b16 a[58:59], v222 offset:20480
  v_mfma_f32_16x16x32_bf16 v[180:183], a[20:23], a[164:167], v[180:183]
  v_exp_f32 v155, v155
  v_mfma_f32_16x16x32_bf16 v[180:183], a[16:19], a[160:163], v[180:183]
  ds_read_b64_tr_b16 a[60:61], v223 offset:16384
  v_cvt_pk_bf16_f32 v153, v154, v155
  v_mfma_f32_16x16x32_bf16 v[188:191], a[16:19], a[176:179], v[204:207]
  v_exp_f32 v156, v156
  v_mfma_f32_16x16x32_bf16 v[188:191], a[20:23], a[180:183], v[188:191]
  ds_read_b64_tr_b16 a[62:63], v223 offset:20480
  v_mfma_f32_16x16x32_bf16 v[188:191], a[24:27], a[184:187], v[188:191]
  v_exp_f32 v157, v157
  v_mfma_f32_16x16x32_bf16 v[188:191], a[28:31], a[188:191], v[188:191]
  v_cvt_pk_bf16_f32 v154, v156, v157
  v_mfma_f32_16x16x32_bf16 v[184:187], a[12:15], a[188:191], v[204:207]
  v_exp_f32 v158, v158
  v_mfma_f32_16x16x32_bf16 v[184:187], a[8:11], a[184:187], v[184:187]
  s_waitcnt vmcnt(16) lgkmcnt(0)
  v_smfmac_f32_16x16x64_bf16 v[208:211], v[248:251], v[132:139], v252
  s_barrier
  v_mfma_f32_16x16x32_bf16 v[184:187], a[4:7], a[180:183], v[184:187]
  v_exp_f32 v159, v159
  v_mfma_f32_16x16x32_bf16 v[184:187], a[0:3], a[176:179], v[184:187]
  v_cvt_pk_bf16_f32 v155, v158, v159
  v_mfma_f32_16x16x32_bf16 v[0:3], a[32:35], v[132:135], v[0:3]
  v_exp_f32 v167, v167
  v_mfma_f32_16x16x32_bf16 v[4:7], a[36:39], v[132:135], v[4:7]
  ds_read_b128 a[0:3], v212 offset:16384
  v_mfma_f32_16x16x32_bf16 v[8:11], a[40:43], v[132:135], v[8:11]
  v_exp_f32 v166, v166
  v_mfma_f32_16x16x32_bf16 v[12:15], a[44:47], v[132:135], v[12:15]
  ds_read_b128 a[4:7], v213 offset:16384
  v_cvt_pk_bf16_f32 v167, v166, v167
  v_mfma_f32_16x16x32_bf16 v[16:19], a[48:51], v[132:135], v[16:19]
  s_pack_ll_b32_b16 m0, s30, 0
  v_exp_f32 v165, v165
  v_mfma_f32_16x16x32_bf16 v[20:23], a[52:55], v[132:135], v[20:23]
  buffer_load_dwordx4 v224, s[12:15], s30 offen offset:0 nt lds
  v_mfma_f32_16x16x32_bf16 v[24:27], a[56:59], v[132:135], v[24:27]
  s_addk_i32 s30, 0x1000
  v_exp_f32 v164, v164
  v_mfma_f32_16x16x32_bf16 v[28:31], a[60:63], v[132:135], v[28:31]
  ds_read_b128 a[8:11], v214 offset:16384
  v_cvt_pk_bf16_f32 v166, v164, v165
  v_mfma_f32_16x16x32_bf16 v[60:63], a[60:63], v[136:139], v[60:63]
  v_exp_f32 v163, v163
  v_mfma_f32_16x16x32_bf16 v[56:59], a[56:59], v[136:139], v[56:59]
  ds_read_b128 a[12:15], v215 offset:16384
  v_mfma_f32_16x16x32_bf16 v[52:55], a[52:55], v[136:139], v[52:55]
  v_exp_f32 v162, v162
  v_mfma_f32_16x16x32_bf16 v[48:51], a[48:51], v[136:139], v[48:51]
  ds_read_b128 a[16:19], v212 offset:20480
  v_cvt_pk_bf16_f32 v165, v162, v163
  v_mfma_f32_16x16x32_bf16 v[44:47], a[44:47], v[136:139], v[44:47]
  s_pack_ll_b32_b16 m0, s31, 1
  v_exp_f32 v161, v161
  v_mfma_f32_16x16x32_bf16 v[40:43], a[40:43], v[136:139], v[40:43]
  buffer_load_dwordx4 v225, s[16:19], s31 offen offset:0 nt lds
  v_mfma_f32_16x16x32_bf16 v[36:39], a[36:39], v[136:139], v[36:39]
  s_addk_i32 s31, 0x1000
  v_exp_f32 v160, v160
  v_mfma_f32_16x16x32_bf16 v[32:35], a[32:35], v[136:139], v[32:35]
  ds_read_b128 a[20:23], v213 offset:20480
  v_cvt_pk_bf16_f32 v164, v160, v161
  v_smfmac_f32_16x16x64_bf16 v[226:229], v[248:251], v[148:155], v252
  v_mfma_f32_16x16x32_bf16 v[64:67], a[32:35], v[148:151], v[64:67]
  v_exp_f32 v168, v168
  v_mfma_f32_16x16x32_bf16 v[68:71], a[36:39], v[148:151], v[68:71]
  ds_read_b128 a[24:27], v214 offset:20480
  v_mfma_f32_16x16x32_bf16 v[72:75], a[40:43], v[148:151], v[72:75]
  v_exp_f32 v169, v169
  v_mfma_f32_16x16x32_bf16 v[76:79], a[44:47], v[148:151], v[76:79]
  ds_read_b128 a[28:31], v215 offset:20480
  v_cvt_pk_bf16_f32 v168, v168, v169
  v_mfma_f32_16x16x32_bf16 v[80:83], a[48:51], v[148:151], v[80:83]
  s_pack_ll_b32_b16 m0, s30, 0
  v_exp_f32 v170, v170
  v_mfma_f32_16x16x32_bf16 v[84:87], a[52:55], v[148:151], v[84:87]
  buffer_load_dwordx4 v224, s[12:15], s30 offen offset:0 nt lds
  v_mfma_f32_16x16x32_bf16 v[88:91], a[56:59], v[148:151], v[88:91]
  s_addk_i32 s30, 0x1000
  v_exp_f32 v171, v171
  v_mfma_f32_16x16x32_bf16 v[92:95], a[60:63], v[148:151], v[92:95]
  v_cvt_pk_bf16_f32 v169, v170, v171
  v_mfma_f32_16x16x32_bf16 v[124:127], a[60:63], v[152:155], v[124:127]
  v_exp_f32 v172, v172
  v_mfma_f32_16x16x32_bf16 v[120:123], a[56:59], v[152:155], v[120:123]
  v_mfma_f32_16x16x32_bf16 v[116:119], a[52:55], v[152:155], v[116:119]
  s_waitcnt lgkmcnt(0)
  v_exp_f32 v173, v173
  v_mfma_f32_16x16x32_bf16 v[112:115], a[48:51], v[152:155], v[112:115]
  v_cvt_pk_bf16_f32 v170, v172, v173
  v_mfma_f32_16x16x32_bf16 v[108:111], a[44:47], v[152:155], v[108:111]
  s_pack_ll_b32_b16 m0, s31, 1
  v_exp_f32 v174, v174
  v_mfma_f32_16x16x32_bf16 v[104:107], a[40:43], v[152:155], v[104:107]
  buffer_load_dwordx4 v225, s[16:19], s31 offen offset:0 nt lds
  v_mfma_f32_16x16x32_bf16 v[100:103], a[36:39], v[152:155], v[100:103]
  s_addk_i32 s31, 0x1000
  v_exp_f32 v175, v175
  v_mfma_f32_16x16x32_bf16 v[96:99], a[32:35], v[152:155], v[96:99]
  v_cvt_pk_bf16_f32 v171, v174, v175
  v_mfma_f32_16x16x32_bf16 v[128:131], a[0:3], a[128:131], v[192:195]
  v_exp_f32 v183, v183
  v_mfma_f32_16x16x32_bf16 v[128:131], a[4:7], a[132:135], v[128:131]
  ds_read_b64_tr_b16 a[32:33], v216 offset:24576
  ds_read_b64_tr_b16 a[34:35], v216 offset:28672
  v_mfma_f32_16x16x32_bf16 v[128:131], a[8:11], a[136:139], v[128:131]
  v_exp_f32 v182, v182
  v_mfma_f32_16x16x32_bf16 v[128:131], a[12:15], a[140:143], v[128:131]
  ds_read_b64_tr_b16 a[36:37], v217 offset:24576
  v_cvt_pk_bf16_f32 v183, v182, v183
  v_mfma_f32_16x16x32_bf16 v[132:135], a[28:31], a[140:143], v[192:195]
  v_exp_f32 v181, v181
  v_mfma_f32_16x16x32_bf16 v[132:135], a[24:27], a[136:139], v[132:135]
  ds_read_b64_tr_b16 a[38:39], v217 offset:28672
  ds_read_b64_tr_b16 a[40:41], v218 offset:24576
  v_mfma_f32_16x16x32_bf16 v[132:135], a[20:23], a[132:135], v[132:135]
  v_exp_f32 v180, v180
  v_mfma_f32_16x16x32_bf16 v[132:135], a[16:19], a[128:131], v[132:135]
  ds_read_b64_tr_b16 a[42:43], v218 offset:28672
  v_cvt_pk_bf16_f32 v182, v180, v181
  v_mfma_f32_16x16x32_bf16 v[140:143], a[16:19], a[144:147], v[196:199]
  v_exp_f32 v179, v179
  v_mfma_f32_16x16x32_bf16 v[140:143], a[20:23], a[148:151], v[140:143]
  ds_read_b64_tr_b16 a[44:45], v219 offset:24576
  ds_read_b64_tr_b16 a[46:47], v219 offset:28672
  v_mfma_f32_16x16x32_bf16 v[140:143], a[24:27], a[152:155], v[140:143]
  v_exp_f32 v178, v178
  v_mfma_f32_16x16x32_bf16 v[140:143], a[28:31], a[156:159], v[140:143]
  ds_read_b64_tr_b16 a[48:49], v220 offset:24576
  v_cvt_pk_bf16_f32 v181, v178, v179
  v_mfma_f32_16x16x32_bf16 v[136:139], a[12:15], a[156:159], v[196:199]
  v_exp_f32 v177, v177
  v_mfma_f32_16x16x32_bf16 v[136:139], a[8:11], a[152:155], v[136:139]
  ds_read_b64_tr_b16 a[50:51], v220 offset:28672
  v_mfma_f32_16x16x32_bf16 v[136:139], a[4:7], a[148:151], v[136:139]
  v_exp_f32 v176, v176
  v_mfma_f32_16x16x32_bf16 v[136:139], a[0:3], a[144:147], v[136:139]
  ds_read_b64_tr_b16 a[52:53], v221 offset:24576
  v_cvt_pk_bf16_f32 v180, v176, v177
  v_mfma_f32_16x16x32_bf16 v[144:147], a[0:3], a[160:163], v[200:203]
  v_exp_f32 v184, v184
  v_mfma_f32_16x16x32_bf16 v[144:147], a[4:7], a[164:167], v[144:147]
  ds_read_b64_tr_b16 a[54:55], v221 offset:28672
  v_mfma_f32_16x16x32_bf16 v[144:147], a[8:11], a[168:171], v[144:147]
  v_exp_f32 v185, v185
  v_mfma_f32_16x16x32_bf16 v[144:147], a[12:15], a[172:175], v[144:147]
  ds_read_b64_tr_b16 a[56:57], v222 offset:24576
  v_cvt_pk_bf16_f32 v184, v184, v185
  v_mfma_f32_16x16x32_bf16 v[148:151], a[28:31], a[172:175], v[200:203]
  v_exp_f32 v186, v186
  v_mfma_f32_16x16x32_bf16 v[148:151], a[24:27], a[168:171], v[148:151]
  ds_read_b64_tr_b16 a[58:59], v222 offset:28672
  v_mfma_f32_16x16x32_bf16 v[148:151], a[20:23], a[164:167], v[148:151]
  v_exp_f32 v187, v187
  v_mfma_f32_16x16x32_bf16 v[148:151], a[16:19], a[160:163], v[148:151]
  ds_read_b64_tr_b16 a[60:61], v223 offset:24576
  v_cvt_pk_bf16_f32 v185, v186, v187
  v_mfma_f32_16x16x32_bf16 v[156:159], a[16:19], a[176:179], v[204:207]
  v_exp_f32 v188, v188
  v_mfma_f32_16x16x32_bf16 v[156:159], a[20:23], a[180:183], v[156:159]
  ds_read_b64_tr_b16 a[62:63], v223 offset:28672
  v_mfma_f32_16x16x32_bf16 v[156:159], a[24:27], a[184:187], v[156:159]
  v_exp_f32 v189, v189
  v_mfma_f32_16x16x32_bf16 v[156:159], a[28:31], a[188:191], v[156:159]
  v_cvt_pk_bf16_f32 v186, v188, v189
  v_mfma_f32_16x16x32_bf16 v[152:155], a[12:15], a[188:191], v[204:207]
  v_exp_f32 v190, v190
  v_mfma_f32_16x16x32_bf16 v[152:155], a[8:11], a[184:187], v[152:155]
  s_waitcnt vmcnt(18) lgkmcnt(0)
  v_smfmac_f32_16x16x64_bf16 v[208:211], v[248:251], v[164:171], v252
  s_barrier
  v_mfma_f32_16x16x32_bf16 v[152:155], a[4:7], a[180:183], v[152:155]
  v_exp_f32 v191, v191
  v_mfma_f32_16x16x32_bf16 v[152:155], a[0:3], a[176:179], v[152:155]
  v_cvt_pk_bf16_f32 v187, v190, v191
  v_mfma_f32_16x16x32_bf16 v[0:3], a[32:35], v[164:167], v[0:3]
  v_exp_f32 v135, v135
  v_mfma_f32_16x16x32_bf16 v[4:7], a[36:39], v[164:167], v[4:7]
  ds_read_b128 a[0:3], v212 offset:24576
  v_mfma_f32_16x16x32_bf16 v[8:11], a[40:43], v[164:167], v[8:11]
  v_exp_f32 v134, v134
  v_mfma_f32_16x16x32_bf16 v[12:15], a[44:47], v[164:167], v[12:15]
  ds_read_b128 a[4:7], v213 offset:24576
  v_cvt_pk_bf16_f32 v135, v134, v135
  v_mfma_f32_16x16x32_bf16 v[16:19], a[48:51], v[164:167], v[16:19]
  s_pack_ll_b32_b16 m0, s30, 0
  v_exp_f32 v133, v133
  v_mfma_f32_16x16x32_bf16 v[20:23], a[52:55], v[164:167], v[20:23]
  buffer_load_dwordx4 v224, s[12:15], s30 offen offset:0 nt lds
  v_mfma_f32_16x16x32_bf16 v[24:27], a[56:59], v[164:167], v[24:27]
  s_addk_i32 s30, 0x1000
  v_exp_f32 v132, v132
  v_mfma_f32_16x16x32_bf16 v[28:31], a[60:63], v[164:167], v[28:31]
  ds_read_b128 a[8:11], v214 offset:24576
  v_cvt_pk_bf16_f32 v134, v132, v133
  v_mfma_f32_16x16x32_bf16 v[60:63], a[60:63], v[168:171], v[60:63]
  v_exp_f32 v131, v131
  v_mfma_f32_16x16x32_bf16 v[56:59], a[56:59], v[168:171], v[56:59]
  ds_read_b128 a[12:15], v215 offset:24576
  v_mfma_f32_16x16x32_bf16 v[52:55], a[52:55], v[168:171], v[52:55]
  v_exp_f32 v130, v130
  v_mfma_f32_16x16x32_bf16 v[48:51], a[48:51], v[168:171], v[48:51]
  ds_read_b128 a[16:19], v212 offset:28672
  v_cvt_pk_bf16_f32 v133, v130, v131
  v_mfma_f32_16x16x32_bf16 v[44:47], a[44:47], v[168:171], v[44:47]
  s_pack_ll_b32_b16 m0, s31, 1
  v_exp_f32 v129, v129
  v_mfma_f32_16x16x32_bf16 v[40:43], a[40:43], v[168:171], v[40:43]
  buffer_load_dwordx4 v225, s[16:19], s31 offen offset:0 nt lds
  v_mfma_f32_16x16x32_bf16 v[36:39], a[36:39], v[168:171], v[36:39]
  s_addk_i32 s31, 0x1000
  v_exp_f32 v128, v128
  v_mfma_f32_16x16x32_bf16 v[32:35], a[32:35], v[168:171], v[32:35]
  ds_read_b128 a[20:23], v213 offset:28672
  v_cvt_pk_bf16_f32 v132, v128, v129
  v_smfmac_f32_16x16x64_bf16 v[226:229], v[248:251], v[180:187], v252
  v_mfma_f32_16x16x32_bf16 v[64:67], a[32:35], v[180:183], v[64:67]
  v_exp_f32 v136, v136
  v_mfma_f32_16x16x32_bf16 v[68:71], a[36:39], v[180:183], v[68:71]
  ds_read_b128 a[24:27], v214 offset:28672
  v_mfma_f32_16x16x32_bf16 v[72:75], a[40:43], v[180:183], v[72:75]
  v_exp_f32 v137, v137
  v_mfma_f32_16x16x32_bf16 v[76:79], a[44:47], v[180:183], v[76:79]
  ds_read_b128 a[28:31], v215 offset:28672
  v_cvt_pk_bf16_f32 v136, v136, v137
  v_mfma_f32_16x16x32_bf16 v[80:83], a[48:51], v[180:183], v[80:83]
  s_pack_ll_b32_b16 m0, s30, 0
  v_exp_f32 v138, v138
  v_mfma_f32_16x16x32_bf16 v[84:87], a[52:55], v[180:183], v[84:87]
  buffer_load_dwordx4 v224, s[12:15], s30 offen offset:0 nt lds
  v_mfma_f32_16x16x32_bf16 v[88:91], a[56:59], v[180:183], v[88:91]
  s_addk_i32 s30, 0x1000
  v_exp_f32 v139, v139
  v_mfma_f32_16x16x32_bf16 v[92:95], a[60:63], v[180:183], v[92:95]
  v_cvt_pk_bf16_f32 v137, v138, v139
  v_mfma_f32_16x16x32_bf16 v[124:127], a[60:63], v[184:187], v[124:127]
  v_exp_f32 v140, v140
  v_mfma_f32_16x16x32_bf16 v[120:123], a[56:59], v[184:187], v[120:123]
  v_mfma_f32_16x16x32_bf16 v[116:119], a[52:55], v[184:187], v[116:119]
  s_waitcnt lgkmcnt(0)
  v_exp_f32 v141, v141
  v_mfma_f32_16x16x32_bf16 v[112:115], a[48:51], v[184:187], v[112:115]
  v_cvt_pk_bf16_f32 v138, v140, v141
  v_mfma_f32_16x16x32_bf16 v[108:111], a[44:47], v[184:187], v[108:111]
  s_pack_ll_b32_b16 m0, s31, 1
  v_exp_f32 v142, v142
  v_mfma_f32_16x16x32_bf16 v[104:107], a[40:43], v[184:187], v[104:107]
  buffer_load_dwordx4 v225, s[16:19], s31 offen offset:0 nt lds
  v_mfma_f32_16x16x32_bf16 v[100:103], a[36:39], v[184:187], v[100:103]
  s_addk_i32 s31, 0x1000
  v_exp_f32 v143, v143
  v_mfma_f32_16x16x32_bf16 v[96:99], a[32:35], v[184:187], v[96:99]
  v_cvt_pk_bf16_f32 v139, v142, v143
  v_mfma_f32_16x16x32_bf16 v[160:163], a[0:3], a[128:131], v[192:195]
  v_exp_f32 v151, v151
  v_mfma_f32_16x16x32_bf16 v[160:163], a[4:7], a[132:135], v[160:163]
  ds_read_b64_tr_b16 a[32:33], v216 offset:32768
  ds_read_b64_tr_b16 a[34:35], v216 offset:36864
  v_mfma_f32_16x16x32_bf16 v[160:163], a[8:11], a[136:139], v[160:163]
  v_exp_f32 v150, v150
  v_mfma_f32_16x16x32_bf16 v[160:163], a[12:15], a[140:143], v[160:163]
  ds_read_b64_tr_b16 a[36:37], v217 offset:32768
  v_cvt_pk_bf16_f32 v151, v150, v151
  v_mfma_f32_16x16x32_bf16 v[164:167], a[28:31], a[140:143], v[192:195]
  v_exp_f32 v149, v149
  v_mfma_f32_16x16x32_bf16 v[164:167], a[24:27], a[136:139], v[164:167]
  ds_read_b64_tr_b16 a[38:39], v217 offset:36864
  ds_read_b64_tr_b16 a[40:41], v218 offset:32768
  v_mfma_f32_16x16x32_bf16 v[164:167], a[20:23], a[132:135], v[164:167]
  v_exp_f32 v148, v148
  v_mfma_f32_16x16x32_bf16 v[164:167], a[16:19], a[128:131], v[164:167]
  ds_read_b64_tr_b16 a[42:43], v218 offset:36864
  v_cvt_pk_bf16_f32 v150, v148, v149
  v_mfma_f32_16x16x32_bf16 v[172:175], a[16:19], a[144:147], v[196:199]
  v_exp_f32 v147, v147
  v_mfma_f32_16x16x32_bf16 v[172:175], a[20:23], a[148:151], v[172:175]
  ds_read_b64_tr_b16 a[44:45], v219 offset:32768
  ds_read_b64_tr_b16 a[46:47], v219 offset:36864
  v_mfma_f32_16x16x32_bf16 v[172:175], a[24:27], a[152:155], v[172:175]
  v_exp_f32 v146, v146
  v_mfma_f32_16x16x32_bf16 v[172:175], a[28:31], a[156:159], v[172:175]
  ds_read_b64_tr_b16 a[48:49], v220 offset:32768
  v_cvt_pk_bf16_f32 v149, v146, v147
  v_mfma_f32_16x16x32_bf16 v[168:171], a[12:15], a[156:159], v[196:199]
  v_exp_f32 v145, v145
  v_mfma_f32_16x16x32_bf16 v[168:171], a[8:11], a[152:155], v[168:171]
  ds_read_b64_tr_b16 a[50:51], v220 offset:36864
  v_mfma_f32_16x16x32_bf16 v[168:171], a[4:7], a[148:151], v[168:171]
  v_exp_f32 v144, v144
  v_mfma_f32_16x16x32_bf16 v[168:171], a[0:3], a[144:147], v[168:171]
  ds_read_b64_tr_b16 a[52:53], v221 offset:32768
  v_cvt_pk_bf16_f32 v148, v144, v145
  v_mfma_f32_16x16x32_bf16 v[176:179], a[0:3], a[160:163], v[200:203]
  v_exp_f32 v152, v152
  v_mfma_f32_16x16x32_bf16 v[176:179], a[4:7], a[164:167], v[176:179]
  ds_read_b64_tr_b16 a[54:55], v221 offset:36864
  v_mfma_f32_16x16x32_bf16 v[176:179], a[8:11], a[168:171], v[176:179]
  v_exp_f32 v153, v153
  v_mfma_f32_16x16x32_bf16 v[176:179], a[12:15], a[172:175], v[176:179]
  ds_read_b64_tr_b16 a[56:57], v222 offset:32768
  v_cvt_pk_bf16_f32 v152, v152, v153
  v_mfma_f32_16x16x32_bf16 v[180:183], a[28:31], a[172:175], v[200:203]
  v_exp_f32 v154, v154
  v_mfma_f32_16x16x32_bf16 v[180:183], a[24:27], a[168:171], v[180:183]
  ds_read_b64_tr_b16 a[58:59], v222 offset:36864
  v_mfma_f32_16x16x32_bf16 v[180:183], a[20:23], a[164:167], v[180:183]
  v_exp_f32 v155, v155
  v_mfma_f32_16x16x32_bf16 v[180:183], a[16:19], a[160:163], v[180:183]
  ds_read_b64_tr_b16 a[60:61], v223 offset:32768
  v_cvt_pk_bf16_f32 v153, v154, v155
  v_mfma_f32_16x16x32_bf16 v[188:191], a[16:19], a[176:179], v[204:207]
  v_exp_f32 v156, v156
  v_mfma_f32_16x16x32_bf16 v[188:191], a[20:23], a[180:183], v[188:191]
  ds_read_b64_tr_b16 a[62:63], v223 offset:36864
  v_mfma_f32_16x16x32_bf16 v[188:191], a[24:27], a[184:187], v[188:191]
  v_exp_f32 v157, v157
  v_mfma_f32_16x16x32_bf16 v[188:191], a[28:31], a[188:191], v[188:191]
  v_cvt_pk_bf16_f32 v154, v156, v157
  v_mfma_f32_16x16x32_bf16 v[184:187], a[12:15], a[188:191], v[204:207]
  s_cmp_lg_u32 s59, 0
  v_exp_f32 v158, v158
  v_mfma_f32_16x16x32_bf16 v[184:187], a[8:11], a[184:187], v[184:187]
  s_cbranch_scc1 L_ev2
  s_waitcnt vmcnt(18) lgkmcnt(0)
L_ev2_ret:
  v_smfmac_f32_16x16x64_bf16 v[208:211], v[248:251], v[132:139], v252
  s_barrier
  v_mfma_f32_16x16x32_bf16 v[184:187], a[4:7], a[180:183], v[184:187]
  v_exp_f32 v159, v159
  v_mfma_f32_16x16x32_bf16 v[184:187], a[0:3], a[176:179], v[184:187]
  v_cvt_pk_bf16_f32 v155, v158, v159
  v_mfma_f32_16x16x32_bf16 v[0:3], a[32:35], v[132:135], v[0:3]
  v_exp_f32 v167, v167
  v_mfma_f32_16x16x32_bf16 v[4:7], a[36:39], v[132:135], v[4:7]
  ds_read_b128 a[0:3], v212 offset:32768
  v_mfma_f32_16x16x32_bf16 v[8:11], a[40:43], v[132:135], v[8:11]
  v_exp_f32 v166, v166
  v_mfma_f32_16x16x32_bf16 v[12:15], a[44:47], v[132:135], v[12:15]
  ds_read_b128 a[4:7], v213 offset:32768
  v_cvt_pk_bf16_f32 v167, v166, v167
  v_mfma_f32_16x16x32_bf16 v[16:19], a[48:51], v[132:135], v[16:19]
  s_pack_ll_b32_b16 m0, s30, 0
  v_exp_f32 v165, v165
  v_mfma_f32_16x16x32_bf16 v[20:23], a[52:55], v[132:135], v[20:23]
  buffer_load_dwordx4 v224, s[12:15], s30 offen offset:0 nt lds
  v_mfma_f32_16x16x32_bf16 v[24:27], a[56:59], v[132:135], v[24:27]
  s_addk_i32 s30, 0x1000
  v_exp_f32 v164, v164
  v_mfma_f32_16x16x32_bf16 v[28:31], a[60:63], v[132:135], v[28:31]
  ds_read_b128 a[8:11], v214 offset:32768
  v_cvt_pk_bf16_f32 v166, v164, v165
  v_mfma_f32_16x16x32_bf16 v[60:63], a[60:63], v[136:139], v[60:63]
  v_exp_f32 v163, v163
  v_mfma_f32_16x16x32_bf16 v[56:59], a[56:59], v[136:139], v[56:59]
  ds_read_b128 a[12:15], v215 offset:32768
  v_mfma_f32_16x16x32_bf16 v[52:55], a[52:55], v[136:139], v[52:55]
  v_exp_f32 v162, v162
  v_mfma_f32_16x16x32_bf16 v[48:51], a[48:51], v[136:139], v[48:51]
  ds_read_b128 a[16:19], v212 offset:36864
  v_cvt_pk_bf16_f32 v165, v162, v163
  v_mfma_f32_16x16x32_bf16 v[44:47], a[44:47], v[136:139], v[44:47]
  s_pack_ll_b32_b16 m0, s31, 1
  v_exp_f32 v161, v161
  v_mfma_f32_16x16x32_bf16 v[40:43], a[40:43], v[136:139], v[40:43]
  buffer_load_dwordx4 v225, s[16:19], s31 offen offset:0 nt lds
  v_mfma_f32_16x16x32_bf16 v[36:39], a[36:39], v[136:139], v[36:39]
  s_addk_i32 s31, 0x1000
  v_exp_f32 v160, v160
  v_mfma_f32_16x16x32_bf16 v[32:35], a[32:35], v[136:139], v[32:35]
  ds_read_b128 a[20:23], v213 offset:36864
  v_cvt_pk_bf16_f32 v164, v160, v161
  v_smfmac_f32_16x16x64_bf16 v[226:229], v[248:251], v[148:155], v252
  v_mfma_f32_16x16x32_bf16 v[64:67], a[32:35], v[148:151], v[64:67]
  v_exp_f32 v168, v168
  v_mfma_f32_16x16x32_bf16 v[68:71], a[36:39], v[148:151], v[68:71]
  ds_read_b128 a[24:27], v214 offset:36864
  v_mfma_f32_16x16x32_bf16 v[72:75], a[40:43], v[148:151], v[72:75]
  v_exp_f32 v169, v169
  v_mfma_f32_16x16x32_bf16 v[76:79], a[44:47], v[148:151], v[76:79]
  ds_read_b128 a[28:31], v215 offset:36864
  v_cvt_pk_bf16_f32 v168, v168, v169
  v_mfma_f32_16x16x32_bf16 v[80:83], a[48:51], v[148:151], v[80:83]
  s_pack_ll_b32_b16 m0, s30, 0
  v_exp_f32 v170, v170
  v_mfma_f32_16x16x32_bf16 v[84:87], a[52:55], v[148:151], v[84:87]
  buffer_load_dwordx4 v224, s[12:15], s30 offen offset:0 nt lds
  v_mfma_f32_16x16x32_bf16 v[88:91], a[56:59], v[148:151], v[88:91]
  s_addk_i32 s30, 0x1000
  v_exp_f32 v171, v171
  v_mfma_f32_16x16x32_bf16 v[92:95], a[60:63], v[148:151], v[92:95]
  v_cvt_pk_bf16_f32 v169, v170, v171
  v_mfma_f32_16x16x32_bf16 v[124:127], a[60:63], v[152:155], v[124:127]
  v_exp_f32 v172, v172
  v_mfma_f32_16x16x32_bf16 v[120:123], a[56:59], v[152:155], v[120:123]
  v_mfma_f32_16x16x32_bf16 v[116:119], a[52:55], v[152:155], v[116:119]
  s_waitcnt lgkmcnt(0)
  v_exp_f32 v173, v173
  v_mfma_f32_16x16x32_bf16 v[112:115], a[48:51], v[152:155], v[112:115]
  v_cvt_pk_bf16_f32 v170, v172, v173
  v_mfma_f32_16x16x32_bf16 v[108:111], a[44:47], v[152:155], v[108:111]
  s_pack_ll_b32_b16 m0, s31, 1
  v_exp_f32 v174, v174
  v_mfma_f32_16x16x32_bf16 v[104:107], a[40:43], v[152:155], v[104:107]
  buffer_load_dwordx4 v225, s[16:19], s31 offen offset:0 nt lds
  v_mfma_f32_16x16x32_bf16 v[100:103], a[36:39], v[152:155], v[100:103]
  s_addk_i32 s31, 0x1000
  v_exp_f32 v175, v175
  v_mfma_f32_16x16x32_bf16 v[96:99], a[32:35], v[152:155], v[96:99]
  v_cvt_pk_bf16_f32 v171, v174, v175
  v_mfma_f32_16x16x32_bf16 v[128:131], a[0:3], a[128:131], v[192:195]
  v_exp_f32 v183, v183
  v_mfma_f32_16x16x32_bf16 v[128:131], a[4:7], a[132:135], v[128:131]
  ds_read_b64_tr_b16 a[32:33], v216 offset:40960
  ds_read_b64_tr_b16 a[34:35], v216 offset:45056
  v_mfma_f32_16x16x32_bf16 v[128:131], a[8:11], a[136:139], v[128:131]
  v_exp_f32 v182, v182
  v_mfma_f32_16x16x32_bf16 v[128:131], a[12:15], a[140:143], v[128:131]
  ds_read_b64_tr_b16 a[36:37], v217 offset:40960
  v_cvt_pk_bf16_f32 v183, v182, v183
  v_mfma_f32_16x16x32_bf16 v[132:135], a[28:31], a[140:143], v[192:195]
  v_exp_f32 v181, v181
  v_mfma_f32_16x16x32_bf16 v[132:135], a[24:27], a[136:139], v[132:135]
  ds_read_b64_tr_b16 a[38:39], v217 offset:45056
  ds_read_b64_tr_b16 a[40:41], v218 offset:40960
  v_mfma_f32_16x16x32_bf16 v[132:135], a[20:23], a[132:135], v[132:135]
  v_exp_f32 v180, v180
  v_mfma_f32_16x16x32_bf16 v[132:135], a[16:19], a[128:131], v[132:135]
  ds_read_b64_tr_b16 a[42:43], v218 offset:45056
  v_cvt_pk_bf16_f32 v182, v180, v181
  v_mfma_f32_16x16x32_bf16 v[140:143], a[16:19], a[144:147], v[196:199]
  v_exp_f32 v179, v179
  v_mfma_f32_16x16x32_bf16 v[140:143], a[20:23], a[148:151], v[140:143]
  ds_read_b64_tr_b16 a[44:45], v219 offset:40960
  ds_read_b64_tr_b16 a[46:47], v219 offset:45056
  v_mfma_f32_16x16x32_bf16 v[140:143], a[24:27], a[152:155], v[140:143]
  v_exp_f32 v178, v178
  v_mfma_f32_16x16x32_bf16 v[140:143], a[28:31], a[156:159], v[140:143]
  ds_read_b64_tr_b16 a[48:49], v220 offset:40960
  v_cvt_pk_bf16_f32 v181, v178, v179
  v_mfma_f32_16x16x32_bf16 v[136:139], a[12:15], a[156:159], v[196:199]
  v_exp_f32 v177, v177
  v_mfma_f32_16x16x32_bf16 v[136:139], a[8:11], a[152:155], v[136:139]
  ds_read_b64_tr_b16 a[50:51], v220 offset:45056
  v_mfma_f32_16x16x32_bf16 v[136:139], a[4:7], a[148:151], v[136:139]
  v_exp_f32 v176, v176
  v_mfma_f32_16x16x32_bf16 v[136:139], a[0:3], a[144:147], v[136:139]
  ds_read_b64_tr_b16 a[52:53], v221 offset:40960
  v_cvt_pk_bf16_f32 v180, v176, v177
  v_mfma_f32_16x16x32_bf16 v[144:147], a[0:3], a[160:163], v[200:203]
  v_exp_f32 v184, v184
  v_mfma_f32_16x16x32_bf16 v[144:147], a[4:7], a[164:167], v[144:147]
  ds_read_b64_tr_b16 a[54:55], v221 offset:45056
  v_mfma_f32_16x16x32_bf16 v[144:147], a[8:11], a[168:171], v[144:147]
  v_exp_f32 v185, v185
  v_mfma_f32_16x16x32_bf16 v[144:147], a[12:15], a[172:175], v[144:147]
  ds_read_b64_tr_b16 a[56:57], v222 offset:40960
  v_cvt_pk_bf16_f32 v184, v184, v185
  v_mfma_f32_16x16x32_bf16 v[148:151], a[28:31], a[172:175], v[200:203]
  v_exp_f32 v186, v186
  v_mfma_f32_16x16x32_bf16 v[148:151], a[24:27], a[168:171], v[148:151]
  ds_read_b64_tr_b16 a[58:59], v222 offset:45056
  v_mfma_f32_16x16x32_bf16 v[148:151], a[20:23], a[164:167], v[148:151]
  v_exp_f32 v187, v187
  v_mfma_f32_16x16x32_bf16 v[148:151], a[16:19], a[160:163], v[148:151]
  ds_read_b64_tr_b16 a[60:61], v223 offset:40960
  v_cvt_pk_bf16_f32 v185, v186, v187
  v_mfma_f32_16x16x32_bf16 v[156:159], a[16:19], a[176:179], v[204:207]
  v_exp_f32 v188, v188
  v_mfma_f32_16x16x32_bf16 v[156:159], a[20:23], a[180:183], v[156:159]
  ds_read_b64_tr_b16 a[62:63], v223 offset:45056
  v_mfma_f32_16x16x32_bf16 v[156:159], a[24:27], a[184:187], v[156:159]
  v_exp_f32 v189, v189
  v_mfma_f32_16x16x32_bf16 v[156:159], a[28:31], a[188:191], v[156:159]
  v_cvt_pk_bf16_f32 v186, v188, v189
  v_mfma_f32_16x16x32_bf16 v[152:155], a[12:15], a[188:191], v[204:207]
  s_cmp_lg_u32 s59, 0
  v_exp_f32 v190, v190
  v_mfma_f32_16x16x32_bf16 v[152:155], a[8:11], a[184:187], v[152:155]
  s_cbranch_scc1 L_ev3
  s_waitcnt vmcnt(18) lgkmcnt(0)
L_ev3_ret:
  v_smfmac_f32_16x16x64_bf16 v[208:211], v[248:251], v[164:171], v252
  s_barrier
  v_mfma_f32_16x16x32_bf16 v[152:155], a[4:7], a[180:183], v[152:155]
  v_exp_f32 v191, v191
  v_mfma_f32_16x16x32_bf16 v[152:155], a[0:3], a[176:179], v[152:155]
  v_cvt_pk_bf16_f32 v187, v190, v191
  v_mfma_f32_16x16x32_bf16 v[0:3], a[32:35], v[164:167], v[0:3]
  v_exp_f32 v135, v135
  v_mfma_f32_16x16x32_bf16 v[4:7], a[36:39], v[164:167], v[4:7]
  ds_read_b128 a[0:3], v212 offset:40960
  v_mfma_f32_16x16x32_bf16 v[8:11], a[40:43], v[164:167], v[8:11]
  v_exp_f32 v134, v134
  v_mfma_f32_16x16x32_bf16 v[12:15], a[44:47], v[164:167], v[12:15]
  ds_read_b128 a[4:7], v213 offset:40960
  v_cvt_pk_bf16_f32 v135, v134, v135
  v_mfma_f32_16x16x32_bf16 v[16:19], a[48:51], v[164:167], v[16:19]
  s_pack_ll_b32_b16 m0, s30, 0
  v_exp_f32 v133, v133
  v_mfma_f32_16x16x32_bf16 v[20:23], a[52:55], v[164:167], v[20:23]
  buffer_load_dwordx4 v224, s[12:15], s30 offen offset:0 nt lds
  v_mfma_f32_16x16x32_bf16 v[24:27], a[56:59], v[164:167], v[24:27]
  s_addk_i32 s30, 0x1000
  v_exp_f32 v132, v132
  v_mfma_f32_16x16x32_bf16 v[28:31], a[60:63], v[164:167], v[28:31]
  ds_read_b128 a[8:11], v214 offset:40960
  v_cvt_pk_bf16_f32 v134, v132, v133
  v_mfma_f32_16x16x32_bf16 v[60:63], a[60:63], v[168:171], v[60:63]
  v_exp_f32 v131, v131
  v_mfma_f32_16x16x32_bf16 v[56:59], a[56:59], v[168:171], v[56:59]
  ds_read_b128 a[12:15], v215 offset:40960
  v_mfma_f32_16x16x32_bf16 v[52:55], a[52:55], v[168:171], v[52:55]
  v_exp_f32 v130, v130
  v_mfma_f32_16x16x32_bf16 v[48:51], a[48:51], v[168:171], v[48:51]
  ds_read_b128 a[16:19], v212 offset:45056
  v_cvt_pk_bf16_f32 v133, v130, v131
  v_mfma_f32_16x16x32_bf16 v[44:47], a[44:47], v[168:171], v[44:47]
  s_pack_ll_b32_b16 m0, s30, 0
  v_exp_f32 v129, v129
  v_mfma_f32_16x16x32_bf16 v[40:43], a[40:43], v[168:171], v[40:43]
  buffer_load_dwordx4 v224, s[12:15], s30 offen offset:0 nt lds
  v_mfma_f32_16x16x32_bf16 v[36:39], a[36:39], v[168:171], v[36:39]
  s_addk_i32 s30, 0x1000
  v_exp_f32 v128, v128
  v_mfma_f32_16x16x32_bf16 v[32:35], a[32:35], v[168:171], v[32:35]
  ds_read_b128 a[20:23], v213 offset:45056
  v_cvt_pk_bf16_f32 v132, v128, v129
  v_smfmac_f32_16x16x64_bf16 v[226:229], v[248:251], v[180:187], v252
  v_mfma_f32_16x16x32_bf16 v[64:67], a[32:35], v[180:183], v[64:67]
  v_exp_f32 v136, v136
  v_mfma_f32_16x16x32_bf16 v[68:71], a[36:39], v[180:183], v[68:71]
  ds_read_b128 a[24:27], v214 offset:45056
  v_mfma_f32_16x16x32_bf16 v[72:75], a[40:43], v[180:183], v[72:75]
  v_exp_f32 v137, v137
  v_mfma_f32_16x16x32_bf16 v[76:79], a[44:47], v[180:183], v[76:79]
  ds_read_b128 a[28:31], v215 offset:45056
  v_cvt_pk_bf16_f32 v136, v136, v137
  v_mfma_f32_16x16x32_bf16 v[80:83], a[48:51], v[180:183], v[80:83]
  s_pack_ll_b32_b16 m0, s31, 1
  v_exp_f32 v138, v138
  v_mfma_f32_16x16x32_bf16 v[84:87], a[52:55], v[180:183], v[84:87]
  buffer_load_dwordx4 v225, s[16:19], s31 offen offset:0 nt lds
  v_mfma_f32_16x16x32_bf16 v[88:91], a[56:59], v[180:183], v[88:91]
  s_addk_i32 s31, 0x1000
  v_exp_f32 v139, v139
  v_mfma_f32_16x16x32_bf16 v[92:95], a[60:63], v[180:183], v[92:95]
  v_cvt_pk_bf16_f32 v137, v138, v139
  v_mfma_f32_16x16x32_bf16 v[124:127], a[60:63], v[184:187], v[124:127]
  v_exp_f32 v140, v140
  v_mfma_f32_16x16x32_bf16 v[120:123], a[56:59], v[184:187], v[120:123]
  v_mfma_f32_16x16x32_bf16 v[116:119], a[52:55], v[184:187], v[116:119]
  s_waitcnt lgkmcnt(0)
  v_exp_f32 v141, v141
  v_mfma_f32_16x16x32_bf16 v[112:115], a[48:51], v[184:187], v[112:115]
  v_cvt_pk_bf16_f32 v138, v140, v141
  v_mfma_f32_16x16x32_bf16 v[108:111], a[44:47], v[184:187], v[108:111]
  v_exp_f32 v142, v142
  v_mfma_f32_16x16x32_bf16 v[104:107], a[40:43], v[184:187], v[104:107]
  v_mfma_f32_16x16x32_bf16 v[100:103], a[36:39], v[184:187], v[100:103]
  v_exp_f32 v143, v143
  v_mfma_f32_16x16x32_bf16 v[96:99], a[32:35], v[184:187], v[96:99]
  v_cvt_pk_bf16_f32 v139, v142, v143
  v_mfma_f32_16x16x32_bf16 v[160:163], a[0:3], a[128:131], v[192:195]
  v_exp_f32 v151, v151
  v_mfma_f32_16x16x32_bf16 v[160:163], a[4:7], a[132:135], v[160:163]
  ds_read_b64_tr_b16 a[32:33], v216 offset:49152
  ds_read_b64_tr_b16 a[34:35], v216 offset:53248
  v_mfma_f32_16x16x32_bf16 v[160:163], a[8:11], a[136:139], v[160:163]
  v_exp_f32 v150, v150
  v_mfma_f32_16x16x32_bf16 v[160:163], a[12:15], a[140:143], v[160:163]
  ds_read_b64_tr_b16 a[36:37], v217 offset:49152
  v_cvt_pk_bf16_f32 v151, v150, v151
  v_mfma_f32_16x16x32_bf16 v[164:167], a[28:31], a[140:143], v[192:195]
  v_exp_f32 v149, v149
  v_mfma_f32_16x16x32_bf16 v[164:167], a[24:27], a[136:139], v[164:167]
  ds_read_b64_tr_b16 a[38:39], v217 offset:53248
  ds_read_b64_tr_b16 a[40:41], v218 offset:49152
  v_mfma_f32_16x16x32_bf16 v[164:167], a[20:23], a[132:135], v[164:167]
  v_exp_f32 v148, v148
  v_mfma_f32_16x16x32_bf16 v[164:167], a[16:19], a[128:131], v[164:167]
  ds_read_b64_tr_b16 a[42:43], v218 offset:53248
  v_cvt_pk_bf16_f32 v150, v148, v149
  v_mfma_f32_16x16x32_bf16 v[172:175], a[16:19], a[144:147], v[196:199]
  v_exp_f32 v147, v147
  v_mfma_f32_16x16x32_bf16 v[172:175], a[20:23], a[148:151], v[172:175]
  ds_read_b64_tr_b16 a[44:45], v219 offset:49152
  ds_read_b64_tr_b16 a[46:47], v219 offset:53248
  v_mfma_f32_16x16x32_bf16 v[172:175], a[24:27], a[152:155], v[172:175]
  v_exp_f32 v146, v146
  v_mfma_f32_16x16x32_bf16 v[172:175], a[28:31], a[156:159], v[172:175]
  ds_read_b64_tr_b16 a[48:49], v220 offset:49152
  v_cvt_pk_bf16_f32 v149, v146, v147
  v_mfma_f32_16x16x32_bf16 v[168:171], a[12:15], a[156:159], v[196:199]
  v_exp_f32 v145, v145
  v_mfma_f32_16x16x32_bf16 v[168:171], a[8:11], a[152:155], v[168:171]
  ds_read_b64_tr_b16 a[50:51], v220 offset:53248
  v_mfma_f32_16x16x32_bf16 v[168:171], a[4:7], a[148:151], v[168:171]
  v_exp_f32 v144, v144
  v_mfma_f32_16x16x32_bf16 v[168:171], a[0:3], a[144:147], v[168:171]
  ds_read_b64_tr_b16 a[52:53], v221 offset:49152
  v_cvt_pk_bf16_f32 v148, v144, v145
  v_mfma_f32_16x16x32_bf16 v[176:179], a[0:3], a[160:163], v[200:203]
  v_exp_f32 v152, v152
  v_mfma_f32_16x16x32_bf16 v[176:179], a[4:7], a[164:167], v[176:179]
  ds_read_b64_tr_b16 a[54:55], v221 offset:53248
  v_mfma_f32_16x16x32_bf16 v[176:179], a[8:11], a[168:171], v[176:179]
  v_exp_f32 v153, v153
  v_mfma_f32_16x16x32_bf16 v[176:179], a[12:15], a[172:175], v[176:179]
  ds_read_b64_tr_b16 a[56:57], v222 offset:49152
  v_cvt_pk_bf16_f32 v152, v152, v153
  v_mfma_f32_16x16x32_bf16 v[180:183], a[28:31], a[172:175], v[200:203]
  v_exp_f32 v154, v154
  v_mfma_f32_16x16x32_bf16 v[180:183], a[24:27], a[168:171], v[180:183]
  ds_read_b64_tr_b16 a[58:59], v222 offset:53248
  v_mfma_f32_16x16x32_bf16 v[180:183], a[20:23], a[164:167], v[180:183]
  v_exp_f32 v155, v155
  v_mfma_f32_16x16x32_bf16 v[180:183], a[16:19], a[160:163], v[180:183]
  ds_read_b64_tr_b16 a[60:61], v223 offset:49152
  v_cvt_pk_bf16_f32 v153, v154, v155
  v_mfma_f32_16x16x32_bf16 v[188:191], a[16:19], a[176:179], v[204:207]
  v_exp_f32 v156, v156
  v_mfma_f32_16x16x32_bf16 v[188:191], a[20:23], a[180:183], v[188:191]
  ds_read_b64_tr_b16 a[62:63], v223 offset:53248
  v_mfma_f32_16x16x32_bf16 v[188:191], a[24:27], a[184:187], v[188:191]
  v_exp_f32 v157, v157
  v_mfma_f32_16x16x32_bf16 v[188:191], a[28:31], a[188:191], v[188:191]
  v_cvt_pk_bf16_f32 v154, v156, v157
  v_mfma_f32_16x16x32_bf16 v[184:187], a[12:15], a[188:191], v[204:207]
  s_cmp_lg_u32 s59, 0
  v_exp_f32 v158, v158
  v_mfma_f32_16x16x32_bf16 v[184:187], a[8:11], a[184:187], v[184:187]
  s_cbranch_scc1 L_ev4
  s_waitcnt vmcnt(17) lgkmcnt(0)
L_ev4_ret:
  v_smfmac_f32_16x16x64_bf16 v[208:211], v[248:251], v[132:139], v252
  s_barrier
  v_mfma_f32_16x16x32_bf16 v[184:187], a[4:7], a[180:183], v[184:187]
  v_exp_f32 v159, v159
  v_mfma_f32_16x16x32_bf16 v[184:187], a[0:3], a[176:179], v[184:187]
  v_cvt_pk_bf16_f32 v155, v158, v159
  v_mfma_f32_16x16x32_bf16 v[0:3], a[32:35], v[132:135], v[0:3]
  v_exp_f32 v167, v167
  v_mfma_f32_16x16x32_bf16 v[4:7], a[36:39], v[132:135], v[4:7]
  ds_read_b128 a[0:3], v212 offset:49152
  v_mfma_f32_16x16x32_bf16 v[8:11], a[40:43], v[132:135], v[8:11]
  v_exp_f32 v166, v166
  v_mfma_f32_16x16x32_bf16 v[12:15], a[44:47], v[132:135], v[12:15]
  ds_read_b128 a[4:7], v213 offset:49152
  v_cvt_pk_bf16_f32 v167, v166, v167
  v_mfma_f32_16x16x32_bf16 v[16:19], a[48:51], v[132:135], v[16:19]
  s_pack_ll_b32_b16 m0, s30, 0
  v_exp_f32 v165, v165
  v_mfma_f32_16x16x32_bf16 v[20:23], a[52:55], v[132:135], v[20:23]
  buffer_load_dwordx4 v224, s[12:15], s30 offen offset:0 nt lds
  v_mfma_f32_16x16x32_bf16 v[24:27], a[56:59], v[132:135], v[24:27]
  s_addk_i32 s30, 0x1000
  v_exp_f32 v164, v164
  v_mfma_f32_16x16x32_bf16 v[28:31], a[60:63], v[132:135], v[28:31]
  ds_read_b128 a[8:11], v214 offset:49152
  v_cvt_pk_bf16_f32 v166, v164, v165
  v_mfma_f32_16x16x32_bf16 v[60:63], a[60:63], v[136:139], v[60:63]
  v_exp_f32 v163, v163
  v_mfma_f32_16x16x32_bf16 v[56:59], a[56:59], v[136:139], v[56:59]
  ds_read_b128 a[12:15], v215 offset:49152
  v_mfma_f32_16x16x32_bf16 v[52:55], a[52:55], v[136:139], v[52:55]
  v_exp_f32 v162, v162
  v_mfma_f32_16x16x32_bf16 v[48:51], a[48:51], v[136:139], v[48:51]
  ds_read_b128 a[16:19], v212 offset:53248
  v_cvt_pk_bf16_f32 v165, v162, v163
  v_mfma_f32_16x16x32_bf16 v[44:47], a[44:47], v[136:139], v[44:47]
  s_pack_ll_b32_b16 m0, s31, 1
  v_exp_f32 v161, v161
  v_mfma_f32_16x16x32_bf16 v[40:43], a[40:43], v[136:139], v[40:43]
  buffer_load_dwordx4 v225, s[16:19], s31 offen offset:0 nt lds
  v_mfma_f32_16x16x32_bf16 v[36:39], a[36:39], v[136:139], v[36:39]
  s_addk_i32 s31, 0x1000
  v_exp_f32 v160, v160
  v_mfma_f32_16x16x32_bf16 v[32:35], a[32:35], v[136:139], v[32:35]
  ds_read_b128 a[20:23], v213 offset:53248
  v_cvt_pk_bf16_f32 v164, v160, v161
  v_smfmac_f32_16x16x64_bf16 v[226:229], v[248:251], v[148:155], v252
  v_mfma_f32_16x16x32_bf16 v[64:67], a[32:35], v[148:151], v[64:67]
  v_exp_f32 v168, v168
  v_mfma_f32_16x16x32_bf16 v[68:71], a[36:39], v[148:151], v[68:71]
  ds_read_b128 a[24:27], v214 offset:53248
  v_mfma_f32_16x16x32_bf16 v[72:75], a[40:43], v[148:151], v[72:75]
  v_exp_f32 v169, v169
  v_mfma_f32_16x16x32_bf16 v[76:79], a[44:47], v[148:151], v[76:79]
  ds_read_b128 a[28:31], v215 offset:53248
  v_cvt_pk_bf16_f32 v168, v168, v169
  v_mfma_f32_16x16x32_bf16 v[80:83], a[48:51], v[148:151], v[80:83]
  s_pack_ll_b32_b16 m0, s30, 0
  v_exp_f32 v170, v170
  v_mfma_f32_16x16x32_bf16 v[84:87], a[52:55], v[148:151], v[84:87]
  buffer_load_dwordx4 v224, s[12:15], s30 offen offset:0 nt lds
  v_mfma_f32_16x16x32_bf16 v[88:91], a[56:59], v[148:151], v[88:91]
  s_addk_i32 s30, 0x1000
  v_exp_f32 v171, v171
  v_mfma_f32_16x16x32_bf16 v[92:95], a[60:63], v[148:151], v[92:95]
  v_cvt_pk_bf16_f32 v169, v170, v171
  v_mfma_f32_16x16x32_bf16 v[124:127], a[60:63], v[152:155], v[124:127]
  v_exp_f32 v172, v172
  v_mfma_f32_16x16x32_bf16 v[120:123], a[56:59], v[152:155], v[120:123]
  v_mfma_f32_16x16x32_bf16 v[116:119], a[52:55], v[152:155], v[116:119]
  s_waitcnt lgkmcnt(0)
  v_exp_f32 v173, v173
  v_mfma_f32_16x16x32_bf16 v[112:115], a[48:51], v[152:155], v[112:115]
  v_cvt_pk_bf16_f32 v170, v172, v173
  v_mfma_f32_16x16x32_bf16 v[108:111], a[44:47], v[152:155], v[108:111]
  s_pack_ll_b32_b16 m0, s31, 1
  v_exp_f32 v174, v174
  v_mfma_f32_16x16x32_bf16 v[104:107], a[40:43], v[152:155], v[104:107]
  buffer_load_dwordx4 v225, s[16:19], s31 offen offset:0 nt lds
  v_mfma_f32_16x16x32_bf16 v[100:103], a[36:39], v[152:155], v[100:103]
  s_addk_i32 s31, 0x1000
  v_exp_f32 v175, v175
  v_mfma_f32_16x16x32_bf16 v[96:99], a[32:35], v[152:155], v[96:99]
  v_cvt_pk_bf16_f32 v171, v174, v175
  v_mfma_f32_16x16x32_bf16 v[128:131], a[0:3], a[128:131], v[192:195]
  v_exp_f32 v183, v183
  v_mfma_f32_16x16x32_bf16 v[128:131], a[4:7], a[132:135], v[128:131]
  ds_read_b64_tr_b16 a[32:33], v216 offset:57344
  ds_read_b64_tr_b16 a[34:35], v216 offset:61440
  v_mfma_f32_16x16x32_bf16 v[128:131], a[8:11], a[136:139], v[128:131]
  v_exp_f32 v182, v182
  v_mfma_f32_16x16x32_bf16 v[128:131], a[12:15], a[140:143], v[128:131]
  ds_read_b64_tr_b16 a[36:37], v217 offset:57344
  v_cvt_pk_bf16_f32 v183, v182, v183
  v_mfma_f32_16x16x32_bf16 v[132:135], a[28:31], a[140:143], v[192:195]
  v_exp_f32 v181, v181
  v_mfma_f32_16x16x32_bf16 v[132:135], a[24:27], a[136:139], v[132:135]
  ds_read_b64_tr_b16 a[38:39], v217 offset:61440
  ds_read_b64_tr_b16 a[40:41], v218 offset:57344
  v_mfma_f32_16x16x32_bf16 v[132:135], a[20:23], a[132:135], v[132:135]
  v_exp_f32 v180, v180
  v_mfma_f32_16x16x32_bf16 v[132:135], a[16:19], a[128:131], v[132:135]
  ds_read_b64_tr_b16 a[42:43], v218 offset:61440
  v_cvt_pk_bf16_f32 v182, v180, v181
  v_mfma_f32_16x16x32_bf16 v[140:143], a[16:19], a[144:147], v[196:199]
  v_exp_f32 v179, v179
  v_mfma_f32_16x16x32_bf16 v[140:143], a[20:23], a[148:151], v[140:143]
  ds_read_b64_tr_b16 a[44:45], v219 offset:57344
  ds_read_b64_tr_b16 a[46:47], v219 offset:61440
  v_mfma_f32_16x16x32_bf16 v[140:143], a[24:27], a[152:155], v[140:143]
  v_exp_f32 v178, v178
  v_mfma_f32_16x16x32_bf16 v[140:143], a[28:31], a[156:159], v[140:143]
  ds_read_b64_tr_b16 a[48:49], v220 offset:57344
  v_cvt_pk_bf16_f32 v181, v178, v179
  v_mfma_f32_16x16x32_bf16 v[136:139], a[12:15], a[156:159], v[196:199]
  v_exp_f32 v177, v177
  v_mfma_f32_16x16x32_bf16 v[136:139], a[8:11], a[152:155], v[136:139]
  ds_read_b64_tr_b16 a[50:51], v220 offset:61440
  v_mfma_f32_16x16x32_bf16 v[136:139], a[4:7], a[148:151], v[136:139]
  v_exp_f32 v176, v176
  v_mfma_f32_16x16x32_bf16 v[136:139], a[0:3], a[144:147], v[136:139]
  ds_read_b64_tr_b16 a[52:53], v221 offset:57344
  v_cvt_pk_bf16_f32 v180, v176, v177
  v_mfma_f32_16x16x32_bf16 v[144:147], a[0:3], a[160:163], v[200:203]
  v_exp_f32 v184, v184
  v_mfma_f32_16x16x32_bf16 v[144:147], a[4:7], a[164:167], v[144:147]
  ds_read_b64_tr_b16 a[54:55], v221 offset:61440
  v_mfma_f32_16x16x32_bf16 v[144:147], a[8:11], a[168:171], v[144:147]
  v_exp_f32 v185, v185
  v_mfma_f32_16x16x32_bf16 v[144:147], a[12:15], a[172:175], v[144:147]
  ds_read_b64_tr_b16 a[56:57], v222 offset:57344
  v_cvt_pk_bf16_f32 v184, v184, v185
  v_mfma_f32_16x16x32_bf16 v[148:151], a[28:31], a[172:175], v[200:203]
  v_exp_f32 v186, v186
  v_mfma_f32_16x16x32_bf16 v[148:151], a[24:27], a[168:171], v[148:151]
  ds_read_b64_tr_b16 a[58:59], v222 offset:61440
  v_mfma_f32_16x16x32_bf16 v[148:151], a[20:23], a[164:167], v[148:151]
  v_exp_f32 v187, v187
  v_mfma_f32_16x16x32_bf16 v[148:151], a[16:19], a[160:163], v[148:151]
  ds_read_b64_tr_b16 a[60:61], v223 offset:57344
  v_cvt_pk_bf16_f32 v185, v186, v187
  v_mfma_f32_16x16x32_bf16 v[156:159], a[16:19], a[176:179], v[204:207]
  v_exp_f32 v188, v188
  v_mfma_f32_16x16x32_bf16 v[156:159], a[20:23], a[180:183], v[156:159]
  ds_read_b64_tr_b16 a[62:63], v223 offset:61440
  v_mfma_f32_16x16x32_bf16 v[156:159], a[24:27], a[184:187], v[156:159]
  v_exp_f32 v189, v189
  v_mfma_f32_16x16x32_bf16 v[156:159], a[28:31], a[188:191], v[156:159]
  v_cvt_pk_bf16_f32 v186, v188, v189
  v_mfma_f32_16x16x32_bf16 v[152:155], a[12:15], a[188:191], v[204:207]
  s_cmp_lg_u32 s59, 0
  v_exp_f32 v190, v190
  v_mfma_f32_16x16x32_bf16 v[152:155], a[8:11], a[184:187], v[152:155]
  s_cbranch_scc1 L_ev5
  s_waitcnt vmcnt(17) lgkmcnt(0)
L_ev5_ret:
  v_smfmac_f32_16x16x64_bf16 v[208:211], v[248:251], v[164:171], v252
  s_barrier
  v_mfma_f32_16x16x32_bf16 v[152:155], a[4:7], a[180:183], v[152:155]
  v_exp_f32 v191, v191
  v_mfma_f32_16x16x32_bf16 v[152:155], a[0:3], a[176:179], v[152:155]
  v_cvt_pk_bf16_f32 v187, v190, v191
  v_mfma_f32_16x16x32_bf16 v[0:3], a[32:35], v[164:167], v[0:3]
  v_exp_f32 v135, v135
  v_mfma_f32_16x16x32_bf16 v[4:7], a[36:39], v[164:167], v[4:7]
  ds_read_b128 a[0:3], v212 offset:57344
  v_mfma_f32_16x16x32_bf16 v[8:11], a[40:43], v[164:167], v[8:11]
  v_exp_f32 v134, v134
  v_mfma_f32_16x16x32_bf16 v[12:15], a[44:47], v[164:167], v[12:15]
  ds_read_b128 a[4:7], v213 offset:57344
  v_cvt_pk_bf16_f32 v135, v134, v135
  v_mfma_f32_16x16x32_bf16 v[16:19], a[48:51], v[164:167], v[16:19]
  s_pack_ll_b32_b16 m0, s30, 0
  v_exp_f32 v133, v133
  v_mfma_f32_16x16x32_bf16 v[20:23], a[52:55], v[164:167], v[20:23]
  buffer_load_dwordx4 v224, s[12:15], s30 offen offset:0 nt lds
  v_mfma_f32_16x16x32_bf16 v[24:27], a[56:59], v[164:167], v[24:27]
  s_addk_i32 s30, 0x1000
  v_exp_f32 v132, v132
  v_mfma_f32_16x16x32_bf16 v[28:31], a[60:63], v[164:167], v[28:31]
  ds_read_b128 a[8:11], v214 offset:57344
  v_cvt_pk_bf16_f32 v134, v132, v133
  v_mfma_f32_16x16x32_bf16 v[60:63], a[60:63], v[168:171], v[60:63]
  v_exp_f32 v131, v131
  v_mfma_f32_16x16x32_bf16 v[56:59], a[56:59], v[168:171], v[56:59]
  ds_read_b128 a[12:15], v215 offset:57344
  v_mfma_f32_16x16x32_bf16 v[52:55], a[52:55], v[168:171], v[52:55]
  v_exp_f32 v130, v130
  v_mfma_f32_16x16x32_bf16 v[48:51], a[48:51], v[168:171], v[48:51]
  ds_read_b128 a[16:19], v212 offset:61440
  v_cvt_pk_bf16_f32 v133, v130, v131
  v_mfma_f32_16x16x32_bf16 v[44:47], a[44:47], v[168:171], v[44:47]
  s_pack_ll_b32_b16 m0, s31, 1
  v_exp_f32 v129, v129
  v_mfma_f32_16x16x32_bf16 v[40:43], a[40:43], v[168:171], v[40:43]
  buffer_load_dwordx4 v225, s[16:19], s31 offen offset:0 nt lds
  v_mfma_f32_16x16x32_bf16 v[36:39], a[36:39], v[168:171], v[36:39]
  s_addk_i32 s31, 0x1000
  v_exp_f32 v128, v128
  v_mfma_f32_16x16x32_bf16 v[32:35], a[32:35], v[168:171], v[32:35]
  ds_read_b128 a[20:23], v213 offset:61440
  v_cvt_pk_bf16_f32 v132, v128, v129
  v_smfmac_f32_16x16x64_bf16 v[226:229], v[248:251], v[180:187], v252
  v_mfma_f32_16x16x32_bf16 v[64:67], a[32:35], v[180:183], v[64:67]
  v_exp_f32 v136, v136
  v_mfma_f32_16x16x32_bf16 v[68:71], a[36:39], v[180:183], v[68:71]
  ds_read_b128 a[24:27], v214 offset:61440
  v_mfma_f32_16x16x32_bf16 v[72:75], a[40:43], v[180:183], v[72:75]
  v_exp_f32 v137, v137
  v_mfma_f32_16x16x32_bf16 v[76:79], a[44:47], v[180:183], v[76:79]
  ds_read_b128 a[28:31], v215 offset:61440
  v_cvt_pk_bf16_f32 v136, v136, v137
  v_mfma_f32_16x16x32_bf16 v[80:83], a[48:51], v[180:183], v[80:83]
  s_pack_ll_b32_b16 m0, s30, 0
  v_exp_f32 v138, v138
  v_mfma_f32_16x16x32_bf16 v[84:87], a[52:55], v[180:183], v[84:87]
  buffer_load_dwordx4 v224, s[12:15], s30 offen offset:0 nt lds
  v_mfma_f32_16x16x32_bf16 v[88:91], a[56:59], v[180:183], v[88:91]
  s_addk_i32 s30, 0x1000
  v_exp_f32 v139, v139
  v_mfma_f32_16x16x32_bf16 v[92:95], a[60:63], v[180:183], v[92:95]
  v_cvt_pk_bf16_f32 v137, v138, v139
  v_mfma_f32_16x16x32_bf16 v[124:127], a[60:63], v[184:187], v[124:127]
  v_exp_f32 v140, v140
  v_mfma_f32_16x16x32_bf16 v[120:123], a[56:59], v[184:187], v[120:123]
  v_mfma_f32_16x16x32_bf16 v[116:119], a[52:55], v[184:187], v[116:119]
  s_waitcnt lgkmcnt(0)
  v_exp_f32 v141, v141
  v_mfma_f32_16x16x32_bf16 v[112:115], a[48:51], v[184:187], v[112:115]
  v_cvt_pk_bf16_f32 v138, v140, v141
  v_mfma_f32_16x16x32_bf16 v[108:111], a[44:47], v[184:187], v[108:111]
  s_pack_ll_b32_b16 m0, s31, 1
  v_exp_f32 v142, v142
  v_mfma_f32_16x16x32_bf16 v[104:107], a[40:43], v[184:187], v[104:107]
  buffer_load_dwordx4 v225, s[16:19], s31 offen offset:0 nt lds
  v_mfma_f32_16x16x32_bf16 v[100:103], a[36:39], v[184:187], v[100:103]
  s_addk_i32 s31, 0x1000
  v_exp_f32 v143, v143
  v_mfma_f32_16x16x32_bf16 v[96:99], a[32:35], v[184:187], v[96:99]
  v_cvt_pk_bf16_f32 v139, v142, v143
  v_mfma_f32_16x16x32_bf16 v[160:163], a[0:3], a[128:131], v[192:195]
  v_exp_f32 v151, v151
  v_mfma_f32_16x16x32_bf16 v[160:163], a[4:7], a[132:135], v[160:163]
  ds_read_b64_tr_b16 a[32:33], v216 offset:0
  ds_read_b64_tr_b16 a[34:35], v216 offset:4096
  v_mfma_f32_16x16x32_bf16 v[160:163], a[8:11], a[136:139], v[160:163]
  v_exp_f32 v150, v150
  v_mfma_f32_16x16x32_bf16 v[160:163], a[12:15], a[140:143], v[160:163]
  ds_read_b64_tr_b16 a[36:37], v217 offset:0
  v_cvt_pk_bf16_f32 v151, v150, v151
  v_mfma_f32_16x16x32_bf16 v[164:167], a[28:31], a[140:143], v[192:195]
  v_exp_f32 v149, v149
  v_mfma_f32_16x16x32_bf16 v[164:167], a[24:27], a[136:139], v[164:167]
  ds_read_b64_tr_b16 a[38:39], v217 offset:4096
  ds_read_b64_tr_b16 a[40:41], v218 offset:0
  v_mfma_f32_16x16x32_bf16 v[164:167], a[20:23], a[132:135], v[164:167]
  v_exp_f32 v148, v148
  v_mfma_f32_16x16x32_bf16 v[164:167], a[16:19], a[128:131], v[164:167]
  ds_read_b64_tr_b16 a[42:43], v218 offset:4096
  v_cvt_pk_bf16_f32 v150, v148, v149
  v_mfma_f32_16x16x32_bf16 v[172:175], a[16:19], a[144:147], v[196:199]
  v_exp_f32 v147, v147
  v_mfma_f32_16x16x32_bf16 v[172:175], a[20:23], a[148:151], v[172:175]
  ds_read_b64_tr_b16 a[44:45], v219 offset:0
  ds_read_b64_tr_b16 a[46:47], v219 offset:4096
  v_mfma_f32_16x16x32_bf16 v[172:175], a[24:27], a[152:155], v[172:175]
  v_exp_f32 v146, v146
  v_mfma_f32_16x16x32_bf16 v[172:175], a[28:31], a[156:159], v[172:175]
  ds_read_b64_tr_b16 a[48:49], v220 offset:0
  v_cvt_pk_bf16_f32 v149, v146, v147
  v_mfma_f32_16x16x32_bf16 v[168:171], a[12:15], a[156:159], v[196:199]
  v_exp_f32 v145, v145
  v_mfma_f32_16x16x32_bf16 v[168:171], a[8:11], a[152:155], v[168:171]
  ds_read_b64_tr_b16 a[50:51], v220 offset:4096
  v_mfma_f32_16x16x32_bf16 v[168:171], a[4:7], a[148:151], v[168:171]
  v_exp_f32 v144, v144
  v_mfma_f32_16x16x32_bf16 v[168:171], a[0:3], a[144:147], v[168:171]
  ds_read_b64_tr_b16 a[52:53], v221 offset:0
  v_cvt_pk_bf16_f32 v148, v144, v145
  v_mfma_f32_16x16x32_bf16 v[176:179], a[0:3], a[160:163], v[200:203]
  v_exp_f32 v152, v152
  v_mfma_f32_16x16x32_bf16 v[176:179], a[4:7], a[164:167], v[176:179]
  ds_read_b64_tr_b16 a[54:55], v221 offset:4096
  v_mfma_f32_16x16x32_bf16 v[176:179], a[8:11], a[168:171], v[176:179]
  v_exp_f32 v153, v153
  v_mfma_f32_16x16x32_bf16 v[176:179], a[12:15], a[172:175], v[176:179]
  ds_read_b64_tr_b16 a[56:57], v222 offset:0
  v_cvt_pk_bf16_f32 v152, v152, v153
  v_mfma_f32_16x16x32_bf16 v[180:183], a[28:31], a[172:175], v[200:203]
  v_exp_f32 v154, v154
  v_mfma_f32_16x16x32_bf16 v[180:183], a[24:27], a[168:171], v[180:183]
  ds_read_b64_tr_b16 a[58:59], v222 offset:4096
  v_mfma_f32_16x16x32_bf16 v[180:183], a[20:23], a[164:167], v[180:183]
  v_exp_f32 v155, v155
  v_mfma_f32_16x16x32_bf16 v[180:183], a[16:19], a[160:163], v[180:183]
  ds_read_b64_tr_b16 a[60:61], v223 offset:0
  v_cvt_pk_bf16_f32 v153, v154, v155
  v_mfma_f32_16x16x32_bf16 v[188:191], a[16:19], a[176:179], v[204:207]
  v_exp_f32 v156, v156
  v_mfma_f32_16x16x32_bf16 v[188:191], a[20:23], a[180:183], v[188:191]
  ds_read_b64_tr_b16 a[62:63], v223 offset:4096
  v_mfma_f32_16x16x32_bf16 v[188:191], a[24:27], a[184:187], v[188:191]
  v_exp_f32 v157, v157
  v_mfma_f32_16x16x32_bf16 v[188:191], a[28:31], a[188:191], v[188:191]
  v_cvt_pk_bf16_f32 v154, v156, v157
  v_mfma_f32_16x16x32_bf16 v[184:187], a[12:15], a[188:191], v[204:207]
  s_cmp_lg_u32 s59, 0
  v_exp_f32 v158, v158
  v_mfma_f32_16x16x32_bf16 v[184:187], a[8:11], a[184:187], v[184:187]
  s_cbranch_scc1 L_ev6
  s_waitcnt vmcnt(17) lgkmcnt(0)
L_ev6_ret:
  v_smfmac_f32_16x16x64_bf16 v[208:211], v[248:251], v[132:139], v252
  s_barrier
  v_mfma_f32_16x16x32_bf16 v[184:187], a[4:7], a[180:183], v[184:187]
  v_exp_f32 v159, v159
  v_mfma_f32_16x16x32_bf16 v[184:187], a[0:3], a[176:179], v[184:187]
  v_cvt_pk_bf16_f32 v155, v158, v159
  v_mfma_f32_16x16x32_bf16 v[0:3], a[32:35], v[132:135], v[0:3]
  v_exp_f32 v167, v167
  v_mfma_f32_16x16x32_bf16 v[4:7], a[36:39], v[132:135], v[4:7]
  ds_read_b128 a[0:3], v212 offset:0
  v_mfma_f32_16x16x32_bf16 v[8:11], a[40:43], v[132:135], v[8:11]
  v_exp_f32 v166, v166
  v_mfma_f32_16x16x32_bf16 v[12:15], a[44:47], v[132:135], v[12:15]
  ds_read_b128 a[4:7], v213 offset:0
  v_cvt_pk_bf16_f32 v167, v166, v167
  v_mfma_f32_16x16x32_bf16 v[16:19], a[48:51], v[132:135], v[16:19]
  s_pack_ll_b32_b16 m0, s30, 0
  v_exp_f32 v165, v165
  v_mfma_f32_16x16x32_bf16 v[20:23], a[52:55], v[132:135], v[20:23]
  buffer_load_dwordx4 v224, s[12:15], s30 offen offset:0 nt lds
  v_mfma_f32_16x16x32_bf16 v[24:27], a[56:59], v[132:135], v[24:27]
  s_addk_i32 s30, 0x1000
  v_exp_f32 v164, v164
  v_mfma_f32_16x16x32_bf16 v[28:31], a[60:63], v[132:135], v[28:31]
  ds_read_b128 a[8:11], v214 offset:0
  v_cvt_pk_bf16_f32 v166, v164, v165
  v_mfma_f32_16x16x32_bf16 v[60:63], a[60:63], v[136:139], v[60:63]
  v_exp_f32 v163, v163
  v_mfma_f32_16x16x32_bf16 v[56:59], a[56:59], v[136:139], v[56:59]
  ds_read_b128 a[12:15], v215 offset:0
  v_mfma_f32_16x16x32_bf16 v[52:55], a[52:55], v[136:139], v[52:55]
  v_exp_f32 v162, v162
  v_mfma_f32_16x16x32_bf16 v[48:51], a[48:51], v[136:139], v[48:51]
  ds_read_b128 a[16:19], v212 offset:4096
  v_cvt_pk_bf16_f32 v165, v162, v163
  v_mfma_f32_16x16x32_bf16 v[44:47], a[44:47], v[136:139], v[44:47]
  s_pack_ll_b32_b16 m0, s31, 1
  v_exp_f32 v161, v161
  v_mfma_f32_16x16x32_bf16 v[40:43], a[40:43], v[136:139], v[40:43]
  buffer_load_dwordx4 v225, s[16:19], s31 offen offset:0 nt lds
  v_mfma_f32_16x16x32_bf16 v[36:39], a[36:39], v[136:139], v[36:39]
  s_addk_i32 s31, 0x1000
  v_exp_f32 v160, v160
  v_mfma_f32_16x16x32_bf16 v[32:35], a[32:35], v[136:139], v[32:35]
  ds_read_b128 a[20:23], v213 offset:4096
  v_cvt_pk_bf16_f32 v164, v160, v161
  v_smfmac_f32_16x16x64_bf16 v[226:229], v[248:251], v[148:155], v252
  v_mfma_f32_16x16x32_bf16 v[64:67], a[32:35], v[148:151], v[64:67]
  v_exp_f32 v168, v168
  v_mfma_f32_16x16x32_bf16 v[68:71], a[36:39], v[148:151], v[68:71]
  ds_read_b128 a[24:27], v214 offset:4096
  v_mfma_f32_16x16x32_bf16 v[72:75], a[40:43], v[148:151], v[72:75]
  v_exp_f32 v169, v169
  v_mfma_f32_16x16x32_bf16 v[76:79], a[44:47], v[148:151], v[76:79]
  ds_read_b128 a[28:31], v215 offset:4096
  v_cvt_pk_bf16_f32 v168, v168, v169
  v_mfma_f32_16x16x32_bf16 v[80:83], a[48:51], v[148:151], v[80:83]
  s_pack_ll_b32_b16 m0, s30, 0
  v_exp_f32 v170, v170
  v_mfma_f32_16x16x32_bf16 v[84:87], a[52:55], v[148:151], v[84:87]
  buffer_load_dwordx4 v224, s[12:15], s30 offen offset:0 nt lds
  v_mfma_f32_16x16x32_bf16 v[88:91], a[56:59], v[148:151], v[88:91]
  s_addk_i32 s30, 0x1000
  v_exp_f32 v171, v171
  v_mfma_f32_16x16x32_bf16 v[92:95], a[60:63], v[148:151], v[92:95]
  v_cvt_pk_bf16_f32 v169, v170, v171
  v_mfma_f32_16x16x32_bf16 v[124:127], a[60:63], v[152:155], v[124:127]
  s_sub_u32 s28, s28, 1
  v_exp_f32 v172, v172
  v_mfma_f32_16x16x32_bf16 v[120:123], a[56:59], v[152:155], v[120:123]
  v_mfma_f32_16x16x32_bf16 v[116:119], a[52:55], v[152:155], v[116:119]
  s_waitcnt lgkmcnt(0)
  v_exp_f32 v173, v173
  v_mfma_f32_16x16x32_bf16 v[112:115], a[48:51], v[152:155], v[112:115]
  v_cvt_pk_bf16_f32 v170, v172, v173
  v_mfma_f32_16x16x32_bf16 v[108:111], a[44:47], v[152:155], v[108:111]
  s_pack_ll_b32_b16 m0, s31, 1
  v_exp_f32 v174, v174
  v_mfma_f32_16x16x32_bf16 v[104:107], a[40:43], v[152:155], v[104:107]
  buffer_load_dwordx4 v225, s[16:19], s31 offen offset:0 nt lds
  v_mfma_f32_16x16x32_bf16 v[100:103], a[36:39], v[152:155], v[100:103]
  s_addk_i32 s31, 0x1000
  v_exp_f32 v175, v175
  v_mfma_f32_16x16x32_bf16 v[96:99], a[32:35], v[152:155], v[96:99]
  s_cmp_eq_u32 s28, 0
  v_cvt_pk_bf16_f32 v171, v174, v175
  s_cbranch_scc1 L_tail
  v_mfma_f32_16x16x32_bf16 v[128:131], a[0:3], a[128:131], v[192:195]
  v_exp_f32 v183, v183
  v_mfma_f32_16x16x32_bf16 v[128:131], a[4:7], a[132:135], v[128:131]
  ds_read_b64_tr_b16 a[32:33], v216 offset:8192
  ds_read_b64_tr_b16 a[34:35], v216 offset:12288
  v_mfma_f32_16x16x32_bf16 v[128:131], a[8:11], a[136:139], v[128:131]
  s_cmp_eq_u32 s28, 1
  v_exp_f32 v182, v182
  v_mfma_f32_16x16x32_bf16 v[128:131], a[12:15], a[140:143], v[128:131]
  s_cselect_b32 s59, s0, 0
  ds_read_b64_tr_b16 a[36:37], v217 offset:8192
  v_cvt_pk_bf16_f32 v183, v182, v183
  v_mfma_f32_16x16x32_bf16 v[132:135], a[28:31], a[140:143], v[192:195]
  v_exp_f32 v181, v181
  v_mfma_f32_16x16x32_bf16 v[132:135], a[24:27], a[136:139], v[132:135]
  ds_read_b64_tr_b16 a[38:39], v217 offset:12288
  ds_read_b64_tr_b16 a[40:41], v218 offset:8192
  v_mfma_f32_16x16x32_bf16 v[132:135], a[20:23], a[132:135], v[132:135]
  v_exp_f32 v180, v180
  v_mfma_f32_16x16x32_bf16 v[132:135], a[16:19], a[128:131], v[132:135]
  ds_read_b64_tr_b16 a[42:43], v218 offset:12288
  v_cvt_pk_bf16_f32 v182, v180, v181
  v_mfma_f32_16x16x32_bf16 v[140:143], a[16:19], a[144:147], v[196:199]
  v_exp_f32 v179, v179
  v_mfma_f32_16x16x32_bf16 v[140:143], a[20:23], a[148:151], v[140:143]
  ds_read_b64_tr_b16 a[44:45], v219 offset:8192
  ds_read_b64_tr_b16 a[46:47], v219 offset:12288
  v_mfma_f32_16x16x32_bf16 v[140:143], a[24:27], a[152:155], v[140:143]
  v_exp_f32 v178, v178
  v_mfma_f32_16x16x32_bf16 v[140:143], a[28:31], a[156:159], v[140:143]
  ds_read_b64_tr_b16 a[48:49], v220 offset:8192
  v_cvt_pk_bf16_f32 v181, v178, v179
  v_mfma_f32_16x16x32_bf16 v[136:139], a[12:15], a[156:159], v[196:199]
  v_exp_f32 v177, v177
  v_mfma_f32_16x16x32_bf16 v[136:139], a[8:11], a[152:155], v[136:139]
  ds_read_b64_tr_b16 a[50:51], v220 offset:12288
  v_mfma_f32_16x16x32_bf16 v[136:139], a[4:7], a[148:151], v[136:139]
  v_exp_f32 v176, v176
  v_mfma_f32_16x16x32_bf16 v[136:139], a[0:3], a[144:147], v[136:139]
  ds_read_b64_tr_b16 a[52:53], v221 offset:8192
  v_cvt_pk_bf16_f32 v180, v176, v177
  v_mfma_f32_16x16x32_bf16 v[144:147], a[0:3], a[160:163], v[200:203]
  v_exp_f32 v184, v184
  v_mfma_f32_16x16x32_bf16 v[144:147], a[4:7], a[164:167], v[144:147]
  ds_read_b64_tr_b16 a[54:55], v221 offset:12288
  v_mfma_f32_16x16x32_bf16 v[144:147], a[8:11], a[168:171], v[144:147]
  v_exp_f32 v185, v185
  v_mfma_f32_16x16x32_bf16 v[144:147], a[12:15], a[172:175], v[144:147]
  ds_read_b64_tr_b16 a[56:57], v222 offset:8192
  v_cvt_pk_bf16_f32 v184, v184, v185
  v_mfma_f32_16x16x32_bf16 v[148:151], a[28:31], a[172:175], v[200:203]
  v_exp_f32 v186, v186
  v_mfma_f32_16x16x32_bf16 v[148:151], a[24:27], a[168:171], v[148:151]
  ds_read_b64_tr_b16 a[58:59], v222 offset:12288
  v_mfma_f32_16x16x32_bf16 v[148:151], a[20:23], a[164:167], v[148:151]
  v_exp_f32 v187, v187
  v_mfma_f32_16x16x32_bf16 v[148:151], a[16:19], a[160:163], v[148:151]
  ds_read_b64_tr_b16 a[60:61], v223 offset:8192
  v_cvt_pk_bf16_f32 v185, v186, v187
  v_mfma_f32_16x16x32_bf16 v[156:159], a[16:19], a[176:179], v[204:207]
  v_exp_f32 v188, v188
  v_mfma_f32_16x16x32_bf16 v[156:159], a[20:23], a[180:183], v[156:159]
  ds_read_b64_tr_b16 a[62:63], v223 offset:12288
  v_mfma_f32_16x16x32_bf16 v[156:159], a[24:27], a[184:187], v[156:159]
  v_exp_f32 v189, v189
  v_mfma_f32_16x16x32_bf16 v[156:159], a[28:31], a[188:191], v[156:159]
  v_cvt_pk_bf16_f32 v186, v188, v189
  v_mfma_f32_16x16x32_bf16 v[152:155], a[12:15], a[188:191], v[204:207]
  v_exp_f32 v190, v190
  v_mfma_f32_16x16x32_bf16 v[152:155], a[8:11], a[184:187], v[152:155]
  s_waitcnt vmcnt(19) lgkmcnt(0)
  v_smfmac_f32_16x16x64_bf16 v[208:211], v[248:251], v[164:171], v252
  s_barrier
  v_mfma_f32_16x16x32_bf16 v[152:155], a[4:7], a[180:183], v[152:155]
  v_exp_f32 v191, v191
  v_mfma_f32_16x16x32_bf16 v[152:155], a[0:3], a[176:179], v[152:155]
  v_cvt_pk_bf16_f32 v187, v190, v191
  v_mfma_f32_16x16x32_bf16 v[0:3], a[32:35], v[164:167], v[0:3]
  v_exp_f32 v135, v135
  v_mfma_f32_16x16x32_bf16 v[4:7], a[36:39], v[164:167], v[4:7]
  ds_read_b128 a[0:3], v212 offset:8192
  v_mfma_f32_16x16x32_bf16 v[8:11], a[40:43], v[164:167], v[8:11]
  v_exp_f32 v134, v134
  v_mfma_f32_16x16x32_bf16 v[12:15], a[44:47], v[164:167], v[12:15]
  ds_read_b128 a[4:7], v213 offset:8192
  v_cvt_pk_bf16_f32 v135, v134, v135
  v_mfma_f32_16x16x32_bf16 v[16:19], a[48:51], v[164:167], v[16:19]
  s_pack_ll_b32_b16 m0, s30, 0
  v_exp_f32 v133, v133
  v_mfma_f32_16x16x32_bf16 v[20:23], a[52:55], v[164:167], v[20:23]
  buffer_load_dwordx4 v224, s[12:15], s30 offen offset:0 nt lds
  v_mfma_f32_16x16x32_bf16 v[24:27], a[56:59], v[164:167], v[24:27]
  s_addk_i32 s30, 0x1000
  v_exp_f32 v132, v132
  v_mfma_f32_16x16x32_bf16 v[28:31], a[60:63], v[164:167], v[28:31]
  ds_read_b128 a[8:11], v214 offset:8192
  v_cvt_pk_bf16_f32 v134, v132, v133
  v_mfma_f32_16x16x32_bf16 v[60:63], a[60:63], v[168:171], v[60:63]
  v_exp_f32 v131, v131
  v_mfma_f32_16x16x32_bf16 v[56:59], a[56:59], v[168:171], v[56:59]
  ds_read_b128 a[12:15], v215 offset:8192
  v_mfma_f32_16x16x32_bf16 v[52:55], a[52:55], v[168:171], v[52:55]
  v_exp_f32 v130, v130
  v_mfma_f32_16x16x32_bf16 v[48:51], a[48:51], v[168:171], v[48:51]
  ds_read_b128 a[16:19], v212 offset:12288
  v_cvt_pk_bf16_f32 v133, v130, v131
  v_mfma_f32_16x16x32_bf16 v[44:47], a[44:47], v[168:171], v[44:47]
  s_pack_ll_b32_b16 m0, s31, 1
  v_exp_f32 v129, v129
  v_mfma_f32_16x16x32_bf16 v[40:43], a[40:43], v[168:171], v[40:43]
  buffer_load_dwordx4 v225, s[16:19], s31 offen offset:0 nt lds
  v_mfma_f32_16x16x32_bf16 v[36:39], a[36:39], v[168:171], v[36:39]
  s_addk_i32 s31, 0x1000
  v_exp_f32 v128, v128
  v_mfma_f32_16x16x32_bf16 v[32:35], a[32:35], v[168:171], v[32:35]
  ds_read_b128 a[20:23], v213 offset:12288
  v_cvt_pk_bf16_f32 v132, v128, v129
  v_smfmac_f32_16x16x64_bf16 v[226:229], v[248:251], v[180:187], v252
  v_mfma_f32_16x16x32_bf16 v[64:67], a[32:35], v[180:183], v[64:67]
  v_exp_f32 v136, v136
  v_mfma_f32_16x16x32_bf16 v[68:71], a[36:39], v[180:183], v[68:71]
  ds_read_b128 a[24:27], v214 offset:12288
  v_mfma_f32_16x16x32_bf16 v[72:75], a[40:43], v[180:183], v[72:75]
  v_exp_f32 v137, v137
  v_mfma_f32_16x16x32_bf16 v[76:79], a[44:47], v[180:183], v[76:79]
  ds_read_b128 a[28:31], v215 offset:12288
  v_cvt_pk_bf16_f32 v136, v136, v137
  v_mfma_f32_16x16x32_bf16 v[80:83], a[48:51], v[180:183], v[80:83]
  s_pack_ll_b32_b16 m0, s31, 1
  v_exp_f32 v138, v138
  v_mfma_f32_16x16x32_bf16 v[84:87], a[52:55], v[180:183], v[84:87]
  buffer_load_dwordx4 v225, s[16:19], s31 offen offset:0 nt lds
  v_mfma_f32_16x16x32_bf16 v[88:91], a[56:59], v[180:183], v[88:91]
  s_addk_i32 s31, 0x1000
  v_exp_f32 v139, v139
  v_mfma_f32_16x16x32_bf16 v[92:95], a[60:63], v[180:183], v[92:95]
  v_cvt_pk_bf16_f32 v137, v138, v139
  v_min_u32 v232, 6, v231
  v_mfma_f32_16x16x32_bf16 v[124:127], a[60:63], v[184:187], v[124:127]
  v_exp_f32 v140, v140
  v_mfma_f32_16x16x32_bf16 v[120:123], a[56:59], v[184:187], v[120:123]
  v_lshlrev_b32 v232, 7, v232
  v_mfma_f32_16x16x32_bf16 v[116:119], a[52:55], v[184:187], v[116:119]
  s_waitcnt lgkmcnt(0)
  v_exp_f32 v141, v141
  v_mfma_f32_16x16x32_bf16 v[112:115], a[48:51], v[184:187], v[112:115]
  v_cvt_pk_bf16_f32 v138, v140, v141
  v_mfma_f32_16x16x32_bf16 v[108:111], a[44:47], v[184:187], v[108:111]
  v_exp_f32 v142, v142
  v_mfma_f32_16x16x32_bf16 v[104:107], a[40:43], v[184:187], v[104:107]
  buffer_load_dword v253, v232, s[64:67], s40 offen
  v_mfma_f32_16x16x32_bf16 v[100:103], a[36:39], v[184:187], v[100:103]
  v_exp_f32 v143, v143
  v_mfma_f32_16x16x32_bf16 v[96:99], a[32:35], v[184:187], v[96:99]
  s_addk_i32 s40, 896
  v_cvt_pk_bf16_f32 v139, v142, v143
  s_branch L_aloop
L_tail:
  ds_read_b64_tr_b16 a[32:33], v216 offset:8192
  ds_read_b64_tr_b16 a[34:35], v216 offset:12288
  ds_read_b64_tr_b16 a[36:37], v217 offset:8192
  ds_read_b64_tr_b16 a[38:39], v217 offset:12288
  ds_read_b64_tr_b16 a[40:41], v218 offset:8192
  ds_read_b64_tr_b16 a[42:43], v218 offset:12288
  ds_read_b64_tr_b16 a[44:45], v219 offset:8192
  ds_read_b64_tr_b16 a[46:47], v219 offset:12288
  ds_read_b64_tr_b16 a[48:49], v220 offset:8192
  ds_read_b64_tr_b16 a[50:51], v220 offset:12288
  ds_read_b64_tr_b16 a[52:53], v221 offset:8192
  ds_read_b64_tr_b16 a[54:55], v221 offset:12288
  ds_read_b64_tr_b16 a[56:57], v222 offset:8192
  ds_read_b64_tr_b16 a[58:59], v222 offset:12288
  ds_read_b64_tr_b16 a[60:61], v223 offset:8192
  ds_read_b64_tr_b16 a[62:63], v223 offset:12288
  s_cmp_eq_u32 s29, 1
  s_cbranch_scc1 L_opre
L_opre_ret:
  v_smfmac_f32_16x16x64_bf16 v[208:211], v[248:251], v[164:171], v252
  s_waitcnt lgkmcnt(14)
  v_exp_f32 v183, v183
  v_exp_f32 v182, v182
  v_exp_f32 v181, v181
  v_exp_f32 v180, v180
  v_cvt_pk_bf16_f32 v183, v182, v183
  v_cvt_pk_bf16_f32 v182, v180, v181
  v_mfma_f32_16x16x32_bf16 v[0:3], a[32:35], v[164:167], v[0:3]
  s_waitcnt lgkmcnt(12)
  v_exp_f32 v179, v179
  v_mfma_f32_16x16x32_bf16 v[4:7], a[36:39], v[164:167], v[4:7]
  s_waitcnt lgkmcnt(10)
  v_exp_f32 v178, v178
  v_mfma_f32_16x16x32_bf16 v[8:11], a[40:43], v[164:167], v[8:11]
  s_waitcnt lgkmcnt(8)
  v_exp_f32 v177, v177
  v_mfma_f32_16x16x32_bf16 v[12:15], a[44:47], v[164:167], v[12:15]
  s_waitcnt lgkmcnt(6)
  s_pack_ll_b32_b16 m0, s31, 1
  v_exp_f32 v176, v176
  v_mfma_f32_16x16x32_bf16 v[16:19], a[48:51], v[164:167], v[16:19]
  s_waitcnt lgkmcnt(4)
  buffer_load_dwordx4 v225, s[16:19], s31 offen offset:0 nt lds
  v_cvt_pk_bf16_f32 v181, v178, v179
  v_cvt_pk_bf16_f32 v180, v176, v177
  s_addk_i32 s31, 0x1000
  v_mfma_f32_16x16x32_bf16 v[20:23], a[52:55], v[164:167], v[20:23]
  s_waitcnt lgkmcnt(2)
  v_exp_f32 v184, v184
  v_mfma_f32_16x16x32_bf16 v[24:27], a[56:59], v[164:167], v[24:27]
  s_waitcnt lgkmcnt(0)
  v_exp_f32 v185, v185
  v_mfma_f32_16x16x32_bf16 v[28:31], a[60:63], v[164:167], v[28:31]
  v_exp_f32 v186, v186
  v_mfma_f32_16x16x32_bf16 v[32:35], a[32:35], v[168:171], v[32:35]
  s_pack_ll_b32_b16 m0, s30, 0
  v_exp_f32 v187, v187
  v_mfma_f32_16x16x32_bf16 v[36:39], a[36:39], v[168:171], v[36:39]
  buffer_load_dwordx4 v224, s[12:15], s30 offen offset:0 nt lds
  v_cvt_pk_bf16_f32 v184, v184, v185
  v_cvt_pk_bf16_f32 v185, v186, v187
  s_addk_i32 s30, 0x1000
  v_mfma_f32_16x16x32_bf16 v[40:43], a[40:43], v[168:171], v[40:43]
  v_exp_f32 v188, v188
  v_mfma_f32_16x16x32_bf16 v[44:47], a[44:47], v[168:171], v[44:47]
  v_exp_f32 v189, v189
  v_mfma_f32_16x16x32_bf16 v[48:51], a[48:51], v[168:171], v[48:51]
  v_exp_f32 v190, v190
  v_mfma_f32_16x16x32_bf16 v[52:55], a[52:55], v[168:171], v[52:55]
  v_exp_f32 v191, v191
  v_mfma_f32_16x16x32_bf16 v[56:59], a[56:59], v[168:171], v[56:59]
  v_cvt_pk_bf16_f32 v186, v188, v189
  v_cvt_pk_bf16_f32 v187, v190, v191
  v_mfma_f32_16x16x32_bf16 v[60:63], a[60:63], v[168:171], v[60:63]
  s_pack_ll_b32_b16 m0, s31, 1
  v_add_f32 v208, v208, v209
  v_add_f32 v210, v210, v211
  v_mfma_f32_16x16x32_bf16 v[64:67], a[32:35], v[180:183], v[64:67]
  buffer_load_dwordx4 v225, s[16:19], s31 offen offset:0 nt lds
  s_addk_i32 s31, 0x1000
  v_smfmac_f32_16x16x64_bf16 v[226:229], v[248:251], v[180:187], v252
  v_mfma_f32_16x16x32_bf16 v[68:71], a[36:39], v[180:183], v[68:71]
  v_cmp_nlt_f32 s[84:85], v208, s57
  v_cmp_nlt_f32 s[86:87], v210, s57
  v_mfma_f32_16x16x32_bf16 v[72:75], a[40:43], v[180:183], v[72:75]
  v_rcp_f32 v240, v208
  v_mfma_f32_16x16x32_bf16 v[76:79], a[44:47], v[180:183], v[76:79]
  v_rcp_f32 v242, v210
  v_mfma_f32_16x16x32_bf16 v[80:83], a[48:51], v[180:183], v[80:83]
  v_mov_b32 v241, v240
  v_mov_b32 v243, v242
  v_mfma_f32_16x16x32_bf16 v[84:87], a[52:55], v[180:183], v[84:87]
  v_mfma_f32_16x16x32_bf16 v[88:91], a[56:59], v[180:183], v[88:91]
  v_mfma_f32_16x16x32_bf16 v[92:95], a[60:63], v[180:183], v[92:95]
  v_add_f32 v226, v226, v227
  v_add_f32 v228, v228, v229
  v_mfma_f32_16x16x32_bf16 v[96:99], a[32:35], v[184:187], v[96:99]
  v_cmp_nlt_f32 s[88:89], v226, s57
  v_cmp_nlt_f32 s[90:91], v228, s57
  v_mfma_f32_16x16x32_bf16 v[100:103], a[36:39], v[184:187], v[100:103]
  s_lshl_b32 s56, s24, 2
  v_rcp_f32 v244, v226
  v_mfma_f32_16x16x32_bf16 v[104:107], a[40:43], v[184:187], v[104:107]
  s_add_u32 s56, s56, 163824
  v_rcp_f32 v246, v228
  v_mfma_f32_16x16x32_bf16 v[108:111], a[44:47], v[184:187], v[108:111]
  s_or_b64 s[84:85], s[84:85], s[86:87]
  v_mov_b32 v245, v244
  v_mov_b32 v247, v246
  v_mfma_f32_16x16x32_bf16 v[112:115], a[48:51], v[184:187], v[112:115]
  s_or_b64 s[88:89], s[88:89], s[90:91]
  s_or_b64 s[84:85], s[84:85], s[88:89]
  s_cselect_b32 s55, 1, 0
  v_mfma_f32_16x16x32_bf16 v[116:119], a[52:55], v[184:187], v[116:119]
  v_mov_b32 v232, s56
  v_mov_b32 v233, s55
  v_mfma_f32_16x16x32_bf16 v[120:123], a[56:59], v[184:187], v[120:123]
  ds_write_b32 v232, v233 offset:0
  v_mov_b32 v234, 163824
  v_mfma_f32_16x16x32_bf16 v[124:127], a[60:63], v[184:187], v[124:127]
  s_cmp_eq_u32 s29, 1
  s_cbranch_scc1 L_tailB
  s_waitcnt vmcnt(20) lgkmcnt(0)
  s_barrier
  ds_read_b128 v[236:239], v234 offset:0
  v_pk_mul_f32 v[0:1], v[0:1], v[240:241]
  v_pk_mul_f32 v[2:3], v[2:3], v[240:241]
  v_pk_mul_f32 v[4:5], v[4:5], v[240:241]
  v_pk_mul_f32 v[6:7], v[6:7], v[240:241]
  v_cvt_pk_bf16_f32 v0, v0, v1
  v_cvt_pk_bf16_f32 v1, v2, v3
  v_cvt_pk_bf16_f32 v2, v4, v5
  v_cvt_pk_bf16_f32 v3, v6, v7
  v_pk_mul_f32 v[8:9], v[8:9], v[240:241]
  v_pk_mul_f32 v[10:11], v[10:11], v[240:241]
  v_pk_mul_f32 v[12:13], v[12:13], v[240:241]
  v_pk_mul_f32 v[14:15], v[14:15], v[240:241]
  v_cvt_pk_bf16_f32 v8, v8, v9
  v_cvt_pk_bf16_f32 v9, v10, v11
  v_cvt_pk_bf16_f32 v10, v12, v13
  v_cvt_pk_bf16_f32 v11, v14, v15
  v_pk_mul_f32 v[16:17], v[16:17], v[240:241]
  v_pk_mul_f32 v[18:19], v[18:19], v[240:241]
  v_pk_mul_f32 v[20:21], v[20:21], v[240:241]
  v_pk_mul_f32 v[22:23], v[22:23], v[240:241]
  v_cvt_pk_bf16_f32 v16, v16, v17
  v_cvt_pk_bf16_f32 v17, v18, v19
  v_cvt_pk_bf16_f32 v18, v20, v21
  v_cvt_pk_bf16_f32 v19, v22, v23
  v_pk_mul_f32 v[24:25], v[24:25], v[240:241]
  v_pk_mul_f32 v[26:27], v[26:27], v[240:241]
  v_pk_mul_f32 v[28:29], v[28:29], v[240:241]
  v_pk_mul_f32 v[30:31], v[30:31], v[240:241]
  v_cvt_pk_bf16_f32 v24, v24, v25
  v_cvt_pk_bf16_f32 v25, v26, v27
  v_cvt_pk_bf16_f32 v26, v28, v29
  v_cvt_pk_bf16_f32 v27, v30, v31
  s_pack_ll_b32_b16 m0, s31, 1
  v_pk_mul_f32 v[32:33], v[32:33], v[242:243]
  v_pk_mul_f32 v[34:35], v[34:35], v[242:243]
  v_pk_mul_f32 v[36:37], v[36:37], v[242:243]
  v_pk_mul_f32 v[38:39], v[38:39], v[242:243]
  v_cvt_pk_bf16_f32 v32, v32, v33
  v_cvt_pk_bf16_f32 v33, v34, v35
  v_cvt_pk_bf16_f32 v34, v36, v37
  v_cvt_pk_bf16_f32 v35, v38, v39
  v_pk_mul_f32 v[40:41], v[40:41], v[242:243]
  v_pk_mul_f32 v[42:43], v[42:43], v[242:243]
  v_pk_mul_f32 v[44:45], v[44:45], v[242:243]
  v_pk_mul_f32 v[46:47], v[46:47], v[242:243]
  v_cvt_pk_bf16_f32 v40, v40, v41
  v_cvt_pk_bf16_f32 v41, v42, v43
  v_cvt_pk_bf16_f32 v42, v44, v45
  v_cvt_pk_bf16_f32 v43, v46, v47
  v_pk_mul_f32 v[48:49], v[48:49], v[242:243]
  v_pk_mul_f32 v[50:51], v[50:51], v[242:243]
  v_pk_mul_f32 v[52:53], v[52:53], v[242:243]
  v_pk_mul_f32 v[54:55], v[54:55], v[242:243]
  v_cvt_pk_bf16_f32 v48, v48, v49
  v_cvt_pk_bf16_f32 v49, v50, v51
  v_cvt_pk_bf16_f32 v50, v52, v53
  v_cvt_pk_bf16_f32 v51, v54, v55
  v_pk_mul_f32 v[56:57], v[56:57], v[242:243]
  v_pk_mul_f32 v[58:59], v[58:59], v[242:243]
  v_pk_mul_f32 v[60:61], v[60:61], v[242:243]
  v_pk_mul_f32 v[62:63], v[62:63], v[242:243]
  v_cvt_pk_bf16_f32 v56, v56, v57
  v_cvt_pk_bf16_f32 v57, v58, v59
  v_cvt_pk_bf16_f32 v58, v60, v61
  v_cvt_pk_bf16_f32 v59, v62, v63
  buffer_load_dwordx4 v225, s[16:19], s31 offen offset:0 nt lds
  s_addk_i32 s31, 0x1000
  s_waitcnt lgkmcnt(0)
  v_or_b32 v236, v236, v237
  v_or3_b32 v236, v236, v238, v239
  s_nop 0
  v_readfirstlane_b32 s55, v236
  s_nop 3
  s_andn2_b32 s55, s55, s54
  s_cbranch_scc1 L_fallback
  v_pk_mul_f32 v[64:65], v[64:65], v[244:245]
  v_pk_mul_f32 v[66:67], v[66:67], v[244:245]
  v_pk_mul_f32 v[68:69], v[68:69], v[244:245]
  v_pk_mul_f32 v[70:71], v[70:71], v[244:245]
  v_cvt_pk_bf16_f32 v64, v64, v65
  v_cvt_pk_bf16_f32 v65, v66, v67
  v_cvt_pk_bf16_f32 v66, v68, v69
  v_cvt_pk_bf16_f32 v67, v70, v71
  v_pk_mul_f32 v[72:73], v[72:73], v[244:245]
  v_pk_mul_f32 v[74:75], v[74:75], v[244:245]
  v_pk_mul_f32 v[76:77], v[76:77], v[244:245]
  v_pk_mul_f32 v[78:79], v[78:79], v[244:245]
  v_cvt_pk_bf16_f32 v72, v72, v73
  v_cvt_pk_bf16_f32 v73, v74, v75
  v_cvt_pk_bf16_f32 v74, v76, v77
  v_cvt_pk_bf16_f32 v75, v78, v79
  v_pk_mul_f32 v[80:81], v[80:81], v[244:245]
  v_pk_mul_f32 v[82:83], v[82:83], v[244:245]
  v_pk_mul_f32 v[84:85], v[84:85], v[244:245]
  v_pk_mul_f32 v[86:87], v[86:87], v[244:245]
  v_cvt_pk_bf16_f32 v80, v80, v81
  v_cvt_pk_bf16_f32 v81, v82, v83
  v_cvt_pk_bf16_f32 v82, v84, v85
  v_cvt_pk_bf16_f32 v83, v86, v87
  v_pk_mul_f32 v[88:89], v[88:89], v[244:245]
  v_pk_mul_f32 v[90:91], v[90:91], v[244:245]
  v_pk_mul_f32 v[92:93], v[92:93], v[244:245]
  v_pk_mul_f32 v[94:95], v[94:95], v[244:245]
  v_cvt_pk_bf16_f32 v88, v88, v89
  v_cvt_pk_bf16_f32 v89, v90, v91
  v_cvt_pk_bf16_f32 v90, v92, v93
  v_cvt_pk_bf16_f32 v91, v94, v95
  v_pk_mul_f32 v[96:97], v[96:97], v[246:247]
  v_pk_mul_f32 v[98:99], v[98:99], v[246:247]
  v_pk_mul_f32 v[100:101], v[100:101], v[246:247]
  v_pk_mul_f32 v[102:103], v[102:103], v[246:247]
  v_cvt_pk_bf16_f32 v96, v96, v97
  v_cvt_pk_bf16_f32 v97, v98, v99
  v_cvt_pk_bf16_f32 v98, v100, v101
  v_cvt_pk_bf16_f32 v99, v102, v103
  v_pk_mul_f32 v[104:105], v[104:105], v[246:247]
  v_pk_mul_f32 v[106:107], v[106:107], v[246:247]
  v_pk_mul_f32 v[108:109], v[108:109], v[246:247]
  v_pk_mul_f32 v[110:111], v[110:111], v[246:247]
  v_cvt_pk_bf16_f32 v104, v104, v105
  v_cvt_pk_bf16_f32 v105, v106, v107
  v_cvt_pk_bf16_f32 v106, v108, v109
  v_cvt_pk_bf16_f32 v107, v110, v111
  v_pk_mul_f32 v[112:113], v[112:113], v[246:247]
  v_pk_mul_f32 v[114:115], v[114:115], v[246:247]
  v_pk_mul_f32 v[116:117], v[116:117], v[246:247]
  v_pk_mul_f32 v[118:119], v[118:119], v[246:247]
  v_cvt_pk_bf16_f32 v112, v112, v113
  v_cvt_pk_bf16_f32 v113, v114, v115
  v_cvt_pk_bf16_f32 v114, v116, v117
  v_cvt_pk_bf16_f32 v115, v118, v119
  v_pk_mul_f32 v[120:121], v[120:121], v[246:247]
  v_pk_mul_f32 v[122:123], v[122:123], v[246:247]
  v_pk_mul_f32 v[124:125], v[124:125], v[246:247]
  v_pk_mul_f32 v[126:127], v[126:127], v[246:247]
  v_cvt_pk_bf16_f32 v120, v120, v121
  v_cvt_pk_bf16_f32 v121, v122, v123
  v_cvt_pk_bf16_f32 v122, v124, v125
  v_cvt_pk_bf16_f32 v123, v126, v127
  v_accvgpr_read_b32 v128, a64
  v_accvgpr_read_b32 v129, a65
  v_accvgpr_read_b32 v130, a66
  v_accvgpr_read_b32 v131, a67
  v_accvgpr_read_b32 v132, a80
  v_accvgpr_read_b32 v133, a81
  v_accvgpr_read_b32 v134, a82
  v_accvgpr_read_b32 v135, a83
  v_pk_mul_f32 v[128:129], v[128:129], s[26:27]
  v_pk_mul_f32 v[130:131], v[130:131], s[26:27]
  v_pk_mul_f32 v[132:133], v[132:133], s[26:27]
  v_pk_mul_f32 v[134:135], v[134:135], s[26:27]
  s_pack_ll_b32_b16 m0, s30, 0
  v_cvt_pk_bf16_f32 v136, v128, v129
  v_cvt_pk_bf16_f32 v137, v130, v131
  v_cvt_pk_bf16_f32 v138, v132, v133
  v_cvt_pk_bf16_f32 v139, v134, v135
  v_accvgpr_write_b32 a128, v136
  v_accvgpr_write_b32 a129, v137
  v_accvgpr_write_b32 a130, v138
  v_accvgpr_write_b32 a131, v139
  v_accvgpr_read_b32 v140, a68
  v_accvgpr_read_b32 v141, a69
  v_accvgpr_read_b32 v142, a70
  v_accvgpr_read_b32 v143, a71
  v_accvgpr_read_b32 v144, a84
  v_accvgpr_read_b32 v145, a85
  v_accvgpr_read_b32 v146, a86
  v_accvgpr_read_b32 v147, a87
  v_pk_mul_f32 v[140:141], v[140:141], s[26:27]
  v_pk_mul_f32 v[142:143], v[142:143], s[26:27]
  v_pk_mul_f32 v[144:145], v[144:145], s[26:27]
  v_pk_mul_f32 v[146:147], v[146:147], s[26:27]
  v_cvt_pk_bf16_f32 v148, v140, v141
  v_cvt_pk_bf16_f32 v149, v142, v143
  v_cvt_pk_bf16_f32 v150, v144, v145
  v_cvt_pk_bf16_f32 v151, v146, v147
  v_accvgpr_write_b32 a144, v148
  v_accvgpr_write_b32 a145, v149
  v_accvgpr_write_b32 a146, v150
  v_accvgpr_write_b32 a147, v151
  v_accvgpr_read_b32 v152, a72
  v_accvgpr_read_b32 v153, a73
  v_accvgpr_read_b32 v154, a74
  v_accvgpr_read_b32 v155, a75
  v_accvgpr_read_b32 v156, a88
  v_accvgpr_read_b32 v157, a89
  v_accvgpr_read_b32 v158, a90
  v_accvgpr_read_b32 v159, a91
  v_pk_mul_f32 v[152:153], v[152:153], s[26:27]
  v_pk_mul_f32 v[154:155], v[154:155], s[26:27]
  v_pk_mul_f32 v[156:157], v[156:157], s[26:27]
  v_pk_mul_f32 v[158:159], v[158:159], s[26:27]
  v_cvt_pk_bf16_f32 v160, v152, v153
  v_cvt_pk_bf16_f32 v161, v154, v155
  v_cvt_pk_bf16_f32 v162, v156, v157
  v_cvt_pk_bf16_f32 v163, v158, v159
  v_accvgpr_write_b32 a160, v160
  v_accvgpr_write_b32 a161, v161
  v_accvgpr_write_b32 a162, v162
  v_accvgpr_write_b32 a163, v163
  v_accvgpr_read_b32 v164, a76
  v_accvgpr_read_b32 v165, a77
  v_accvgpr_read_b32 v166, a78
  v_accvgpr_read_b32 v167, a79
  v_accvgpr_read_b32 v168, a92
  v_accvgpr_read_b32 v169, a93
  v_accvgpr_read_b32 v170, a94
  v_accvgpr_read_b32 v171, a95
  v_pk_mul_f32 v[164:165], v[164:165], s[26:27]
  v_pk_mul_f32 v[166:167], v[166:167], s[26:27]
  v_pk_mul_f32 v[168:169], v[168:169], s[26:27]
  v_pk_mul_f32 v[170:171], v[170:171], s[26:27]
  v_cvt_pk_bf16_f32 v172, v164, v165
  v_cvt_pk_bf16_f32 v173, v166, v167
  v_cvt_pk_bf16_f32 v174, v168, v169
  v_cvt_pk_bf16_f32 v175, v170, v171
  v_accvgpr_write_b32 a176, v172
  v_accvgpr_write_b32 a177, v173
  v_accvgpr_write_b32 a178, v174
  v_accvgpr_write_b32 a179, v175
  v_accvgpr_read_b32 v128, a96
  v_accvgpr_read_b32 v129, a97
  v_accvgpr_read_b32 v130, a98
  v_accvgpr_read_b32 v131, a99
  v_accvgpr_read_b32 v132, a112
  v_accvgpr_read_b32 v133, a113
  v_accvgpr_read_b32 v134, a114
  v_accvgpr_read_b32 v135, a115
  buffer_load_dwordx4 v224, s[12:15], s30 offen offset:0 nt lds
  s_addk_i32 s30, 0x1000
  s_pack_ll_b32_b16 m0, s31, 1
  v_pk_mul_f32 v[128:129], v[128:129], s[26:27]
  v_pk_mul_f32 v[130:131], v[130:131], s[26:27]
  v_pk_mul_f32 v[132:133], v[132:133], s[26:27]
  v_pk_mul_f32 v[134:135], v[134:135], s[26:27]
  v_cvt_pk_bf16_f32 v136, v128, v129
  v_cvt_pk_bf16_f32 v137, v130, v131
  v_cvt_pk_bf16_f32 v138, v132, v133
  v_cvt_pk_bf16_f32 v139, v134, v135
  v_accvgpr_write_b32 a132, v136
  v_accvgpr_write_b32 a133, v137
  v_accvgpr_write_b32 a134, v138
  v_accvgpr_write_b32 a135, v139
  v_accvgpr_read_b32 v140, a100
  v_accvgpr_read_b32 v141, a101
  v_accvgpr_read_b32 v142, a102
  v_accvgpr_read_b32 v143, a103
  v_accvgpr_read_b32 v144, a116
  v_accvgpr_read_b32 v145, a117
  v_accvgpr_read_b32 v146, a118
  v_accvgpr_read_b32 v147, a119
  v_pk_mul_f32 v[140:141], v[140:141], s[26:27]
  v_pk_mul_f32 v[142:143], v[142:143], s[26:27]
  v_pk_mul_f32 v[144:145], v[144:145], s[26:27]
  v_pk_mul_f32 v[146:147], v[146:147], s[26:27]
  v_cvt_pk_bf16_f32 v148, v140, v141
  v_cvt_pk_bf16_f32 v149, v142, v143
  v_cvt_pk_bf16_f32 v150, v144, v145
  v_cvt_pk_bf16_f32 v151, v146, v147
  v_accvgpr_write_b32 a148, v148
  v_accvgpr_write_b32 a149, v149
  v_accvgpr_write_b32 a150, v150
  v_accvgpr_write_b32 a151, v151
  v_accvgpr_read_b32 v152, a104
  v_accvgpr_read_b32 v153, a105
  v_accvgpr_read_b32 v154, a106
  v_accvgpr_read_b32 v155, a107
  v_accvgpr_read_b32 v156, a120
  v_accvgpr_read_b32 v157, a121
  v_accvgpr_read_b32 v158, a122
  v_accvgpr_read_b32 v159, a123
  v_pk_mul_f32 v[152:153], v[152:153], s[26:27]
  v_pk_mul_f32 v[154:155], v[154:155], s[26:27]
  v_pk_mul_f32 v[156:157], v[156:157], s[26:27]
  v_pk_mul_f32 v[158:159], v[158:159], s[26:27]
  v_cvt_pk_bf16_f32 v160, v152, v153
  v_cvt_pk_bf16_f32 v161, v154, v155
  v_cvt_pk_bf16_f32 v162, v156, v157
  v_cvt_pk_bf16_f32 v163, v158, v159
  v_accvgpr_write_b32 a164, v160
  v_accvgpr_write_b32 a165, v161
  v_accvgpr_write_b32 a166, v162
  v_accvgpr_write_b32 a167, v163
  v_accvgpr_read_b32 v164, a108
  v_accvgpr_read_b32 v165, a109
  v_accvgpr_read_b32 v166, a110
  v_accvgpr_read_b32 v167, a111
  v_accvgpr_read_b32 v168, a124
  v_accvgpr_read_b32 v169, a125
  v_accvgpr_read_b32 v170, a126
  v_accvgpr_read_b32 v171, a127
  v_pk_mul_f32 v[164:165], v[164:165], s[26:27]
  v_pk_mul_f32 v[166:167], v[166:167], s[26:27]
  v_pk_mul_f32 v[168:169], v[168:169], s[26:27]
  v_pk_mul_f32 v[170:171], v[170:171], s[26:27]
  v_cvt_pk_bf16_f32 v172, v164, v165
  v_cvt_pk_bf16_f32 v173, v166, v167
  v_cvt_pk_bf16_f32 v174, v168, v169
  v_cvt_pk_bf16_f32 v175, v170, v171
  v_accvgpr_write_b32 a180, v172
  v_accvgpr_write_b32 a181, v173
  v_accvgpr_write_b32 a182, v174
  v_accvgpr_write_b32 a183, v175
  v_accvgpr_read_b32 v128, a192
  v_accvgpr_read_b32 v129, a193
  v_accvgpr_read_b32 v130, a194
  v_accvgpr_read_b32 v131, a195
  buffer_load_dwordx4 v225, s[16:19], s31 offen offset:0 nt lds
  s_addk_i32 s31, 0x1000
  s_pack_ll_b32_b16 m0, s30, 0
  v_accvgpr_read_b32 v132, a208
  v_accvgpr_read_b32 v133, a209
  v_accvgpr_read_b32 v134, a210
  v_accvgpr_read_b32 v135, a211
  v_pk_mul_f32 v[128:129], v[128:129], s[26:27]
  v_pk_mul_f32 v[130:131], v[130:131], s[26:27]
  v_pk_mul_f32 v[132:133], v[132:133], s[26:27]
  v_pk_mul_f32 v[134:135], v[134:135], s[26:27]
  v_cvt_pk_bf16_f32 v136, v128, v129
  v_cvt_pk_bf16_f32 v137, v130, v131
  v_cvt_pk_bf16_f32 v138, v132, v133
  v_cvt_pk_bf16_f32 v139, v134, v135
  v_accvgpr_write_b32 a136, v136
  v_accvgpr_write_b32 a137, v137
  v_accvgpr_write_b32 a138, v138
  v_accvgpr_write_b32 a139, v139
  v_accvgpr_read_b32 v140, a196
  v_accvgpr_read_b32 v141, a197
  v_accvgpr_read_b32 v142, a198
  v_accvgpr_read_b32 v143, a199
  v_accvgpr_read_b32 v144, a212
  v_accvgpr_read_b32 v145, a213
  v_accvgpr_read_b32 v146, a214
  v_accvgpr_read_b32 v147, a215
  v_pk_mul_f32 v[140:141], v[140:141], s[26:27]
  v_pk_mul_f32 v[142:143], v[142:143], s[26:27]
  v_pk_mul_f32 v[144:145], v[144:145], s[26:27]
  v_pk_mul_f32 v[146:147], v[146:147], s[26:27]
  v_cvt_pk_bf16_f32 v148, v140, v141
  v_cvt_pk_bf16_f32 v149, v142, v143
  v_cvt_pk_bf16_f32 v150, v144, v145
  v_cvt_pk_bf16_f32 v151, v146, v147
  v_accvgpr_write_b32 a152, v148
  v_accvgpr_write_b32 a153, v149
  v_accvgpr_write_b32 a154, v150
  v_accvgpr_write_b32 a155, v151
  v_accvgpr_read_b32 v152, a200
  v_accvgpr_read_b32 v153, a201
  v_accvgpr_read_b32 v154, a202
  v_accvgpr_read_b32 v155, a203
  v_accvgpr_read_b32 v156, a216
  v_accvgpr_read_b32 v157, a217
  v_accvgpr_read_b32 v158, a218
  v_accvgpr_read_b32 v159, a219
  v_pk_mul_f32 v[152:153], v[152:153], s[26:27]
  v_pk_mul_f32 v[154:155], v[154:155], s[26:27]
  v_pk_mul_f32 v[156:157], v[156:157], s[26:27]
  v_pk_mul_f32 v[158:159], v[158:159], s[26:27]
  v_cvt_pk_bf16_f32 v160, v152, v153
  v_cvt_pk_bf16_f32 v161, v154, v155
  v_cvt_pk_bf16_f32 v162, v156, v157
  v_cvt_pk_bf16_f32 v163, v158, v159
  v_accvgpr_write_b32 a168, v160
  v_accvgpr_write_b32 a169, v161
  v_accvgpr_write_b32 a170, v162
  v_accvgpr_write_b32 a171, v163
  v_accvgpr_read_b32 v164, a204
  v_accvgpr_read_b32 v165, a205
  v_accvgpr_read_b32 v166, a206
  v_accvgpr_read_b32 v167, a207
  v_accvgpr_read_b32 v168, a220
  v_accvgpr_read_b32 v169, a221
  v_accvgpr_read_b32 v170, a222
  v_accvgpr_read_b32 v171, a223
  v_pk_mul_f32 v[164:165], v[164:165], s[26:27]
  v_pk_mul_f32 v[166:167], v[166:167], s[26:27]
  v_pk_mul_f32 v[168:169], v[168:169], s[26:27]
  v_pk_mul_f32 v[170:171], v[170:171], s[26:27]
  v_cvt_pk_bf16_f32 v172, v164, v165
  v_cvt_pk_bf16_f32 v173, v166, v167
  v_cvt_pk_bf16_f32 v174, v168, v169
  v_cvt_pk_bf16_f32 v175, v170, v171
  v_accvgpr_write_b32 a184, v172
  v_accvgpr_write_b32 a185, v173
  v_accvgpr_write_b32 a186, v174
  v_accvgpr_write_b32 a187, v175
  buffer_load_dwordx4 v224, s[12:15], s30 offen offset:0 nt lds
  s_addk_i32 s30, 0x1000
  s_pack_ll_b32_b16 m0, s31, 1
  v_accvgpr_read_b32 v128, a224
  v_accvgpr_read_b32 v129, a225
  v_accvgpr_read_b32 v130, a226
  v_accvgpr_read_b32 v131, a227
  v_accvgpr_read_b32 v132, a240
  v_accvgpr_read_b32 v133, a241
  v_accvgpr_read_b32 v134, a242
  v_accvgpr_read_b32 v135, a243
  v_pk_mul_f32 v[128:129], v[128:129], s[26:27]
  v_pk_mul_f32 v[130:131], v[130:131], s[26:27]
  v_pk_mul_f32 v[132:133], v[132:133], s[26:27]
  v_pk_mul_f32 v[134:135], v[134:135], s[26:27]
  v_cvt_pk_bf16_f32 v136, v128, v129
  v_cvt_pk_bf16_f32 v137, v130, v131
  v_cvt_pk_bf16_f32 v138, v132, v133
  v_cvt_pk_bf16_f32 v139, v134, v135
  v_accvgpr_write_b32 a140, v136
  v_accvgpr_write_b32 a141, v137
  v_accvgpr_write_b32 a142, v138
  v_accvgpr_write_b32 a143, v139
  v_accvgpr_read_b32 v140, a228
  v_accvgpr_read_b32 v141, a229
  v_accvgpr_read_b32 v142, a230
  v_accvgpr_read_b32 v143, a231
  v_accvgpr_read_b32 v144, a244
  v_accvgpr_read_b32 v145, a245
  v_accvgpr_read_b32 v146, a246
  v_accvgpr_read_b32 v147, a247
  v_pk_mul_f32 v[140:141], v[140:141], s[26:27]
  v_pk_mul_f32 v[142:143], v[142:143], s[26:27]
  v_pk_mul_f32 v[144:145], v[144:145], s[26:27]
  v_pk_mul_f32 v[146:147], v[146:147], s[26:27]
  v_cvt_pk_bf16_f32 v148, v140, v141
  v_cvt_pk_bf16_f32 v149, v142, v143
  v_cvt_pk_bf16_f32 v150, v144, v145
  v_cvt_pk_bf16_f32 v151, v146, v147
  v_accvgpr_write_b32 a156, v148
  v_accvgpr_write_b32 a157, v149
  v_accvgpr_write_b32 a158, v150
  v_accvgpr_write_b32 a159, v151
  v_accvgpr_read_b32 v152, a232
  v_accvgpr_read_b32 v153, a233
  v_accvgpr_read_b32 v154, a234
  v_accvgpr_read_b32 v155, a235
  v_accvgpr_read_b32 v156, a248
  v_accvgpr_read_b32 v157, a249
  v_accvgpr_read_b32 v158, a250
  v_accvgpr_read_b32 v159, a251
  v_pk_mul_f32 v[152:153], v[152:153], s[26:27]
  v_pk_mul_f32 v[154:155], v[154:155], s[26:27]
  v_pk_mul_f32 v[156:157], v[156:157], s[26:27]
  v_pk_mul_f32 v[158:159], v[158:159], s[26:27]
  v_cvt_pk_bf16_f32 v160, v152, v153
  v_cvt_pk_bf16_f32 v161, v154, v155
  v_cvt_pk_bf16_f32 v162, v156, v157
  v_cvt_pk_bf16_f32 v163, v158, v159
  v_accvgpr_write_b32 a172, v160
  v_accvgpr_write_b32 a173, v161
  v_accvgpr_write_b32 a174, v162
  v_accvgpr_write_b32 a175, v163
  v_accvgpr_read_b32 v164, a236
  v_accvgpr_read_b32 v165, a237
  v_accvgpr_read_b32 v166, a238
  v_accvgpr_read_b32 v167, a239
  v_accvgpr_read_b32 v168, a252
  v_accvgpr_read_b32 v169, a253
  v_accvgpr_read_b32 v170, a254
  v_accvgpr_read_b32 v171, a255
  v_pk_mul_f32 v[164:165], v[164:165], s[26:27]
  v_pk_mul_f32 v[166:167], v[166:167], s[26:27]
  v_pk_mul_f32 v[168:169], v[168:169], s[26:27]
  v_pk_mul_f32 v[170:171], v[170:171], s[26:27]
  v_cvt_pk_bf16_f32 v172, v164, v165
  v_cvt_pk_bf16_f32 v173, v166, v167
  v_cvt_pk_bf16_f32 v174, v168, v169
  v_cvt_pk_bf16_f32 v175, v170, v171
  buffer_load_dwordx4 v225, s[16:19], s31 offen offset:0 nt lds
  s_addk_i32 s31, 0x1000
  v_accvgpr_write_b32 a188, v172
  v_accvgpr_write_b32 a189, v173
  v_accvgpr_write_b32 a190, v174
  v_accvgpr_write_b32 a191, v175
  s_mov_b32 s29, 1
  s_mov_b32 s54, 0
  s_mov_b32 s0, 1
  s_mul_i32 s55, s24, 5632
  s_add_u32 s55, s55, L_ev2-L_pc
  v_min_u32 v233, 43, v231
  v_lshl_add_u32 v233, v233, 7, s55
  v_min_u32 v233, L_fallback-L_pc, v233
  global_load_dword v253, v233, s[98:99]
  s_cmp_lg_u32 s24, 0
  s_cbranch_scc1 L_nosigR
  s_mov_b64 exec, 1
  v_mov_b32 v235, 1
  buffer_atomic_add v235, off, s[72:75], s81 sc1
  s_mov_b64 exec, -1
L_nosigR:
  v_mfma_f32_16x16x32_bf16 v[128:131], a[0:3], a[128:131], 0
  v_mov_b32 v208, 0
  v_mov_b32 v209, 0
  v_mfma_f32_16x16x32_bf16 v[136:139], a[0:3], a[144:147], 0
  s_pack_ll_b32_b16 m0, s31, 1
  v_mov_b32 v210, 0
  v_mov_b32 v211, 0
  v_mfma_f32_16x16x32_bf16 v[144:147], a[0:3], a[160:163], 0
  buffer_load_dwordx4 v225, s[16:19], s31 offen offset:0 nt lds
  v_mov_b32 v226, 0
  v_mfma_f32_16x16x32_bf16 v[152:155], a[0:3], a[176:179], 0
  s_addk_i32 s31, 0x1000
  v_mov_b32 v227, 0
  v_mov_b32 v228, 0
  v_mfma_f32_16x16x32_bf16 v[128:131], a[4:7], a[132:135], v[128:131]
  ds_read_b128 a[0:3], v212 offset:8192
  v_mov_b32 v229, 0
  v_mfma_f32_16x16x32_bf16 v[136:139], a[4:7], a[148:151], v[136:139]
  v_mov_b32 v244, 0
  v_mov_b32 v245, 0
  v_mfma_f32_16x16x32_bf16 v[144:147], a[4:7], a[164:167], v[144:147]
  v_mov_b32 v246, 0
  v_mov_b32 v247, 0
  v_mfma_f32_16x16x32_bf16 v[152:155], a[4:7], a[180:183], v[152:155]
  v_accvgpr_write_b32 a64, v0
  v_accvgpr_write_b32 a65, v1
  v_mfma_f32_16x16x32_bf16 v[128:131], a[8:11], a[136:139], v[128:131]
  ds_read_b128 a[4:7], v213 offset:8192
  v_accvgpr_write_b32 a66, v2
  v_mfma_f32_16x16x32_bf16 v[136:139], a[8:11], a[152:155], v[136:139]
  v_accvgpr_write_b32 a67, v3
  v_accvgpr_write_b32 a68, v8
  v_mfma_f32_16x16x32_bf16 v[144:147], a[8:11], a[168:171], v[144:147]
  v_accvgpr_write_b32 a69, v9
  v_accvgpr_write_b32 a70, v10
  v_mfma_f32_16x16x32_bf16 v[152:155], a[8:11], a[184:187], v[152:155]
  v_accvgpr_write_b32 a71, v11
  v_accvgpr_write_b32 a72, v16
  v_mfma_f32_16x16x32_bf16 v[128:131], a[12:15], a[140:143], v[128:131]
  ds_read_b128 a[8:11], v214 offset:8192
  v_accvgpr_write_b32 a73, v17
  v_mfma_f32_16x16x32_bf16 v[136:139], a[12:15], a[156:159], v[136:139]
  v_accvgpr_write_b32 a74, v18
  v_accvgpr_write_b32 a75, v19
  v_mfma_f32_16x16x32_bf16 v[144:147], a[12:15], a[172:175], v[144:147]
  v_accvgpr_write_b32 a76, v24
  v_accvgpr_write_b32 a77, v25
  v_mfma_f32_16x16x32_bf16 v[152:155], a[12:15], a[188:191], v[152:155]
  v_accvgpr_write_b32 a78, v26
  v_accvgpr_write_b32 a79, v27
  v_mfma_f32_16x16x32_bf16 v[132:135], a[16:19], a[128:131], 0
  ds_read_b128 a[12:15], v215 offset:8192
  v_accvgpr_write_b32 a80, v32
  v_mfma_f32_16x16x32_bf16 v[140:143], a[16:19], a[144:147], 0
  v_accvgpr_write_b32 a81, v33
  v_accvgpr_write_b32 a82, v34
  v_mfma_f32_16x16x32_bf16 v[148:151], a[16:19], a[160:163], 0
  v_accvgpr_write_b32 a83, v35
  v_accvgpr_write_b32 a84, v40
  v_mfma_f32_16x16x32_bf16 v[156:159], a[16:19], a[176:179], 0
  v_accvgpr_write_b32 a85, v41
  v_accvgpr_write_b32 a86, v42
  v_mfma_f32_16x16x32_bf16 v[132:135], a[20:23], a[132:135], v[132:135]
  ds_read_b128 a[16:19], v212 offset:12288
  v_accvgpr_write_b32 a87, v43
  v_mfma_f32_16x16x32_bf16 v[140:143], a[20:23], a[148:151], v[140:143]
  v_accvgpr_write_b32 a88, v48
  v_accvgpr_write_b32 a89, v49
  v_mfma_f32_16x16x32_bf16 v[148:151], a[20:23], a[164:167], v[148:151]
  v_accvgpr_write_b32 a90, v50
  v_accvgpr_write_b32 a91, v51
  v_mfma_f32_16x16x32_bf16 v[156:159], a[20:23], a[180:183], v[156:159]
  v_accvgpr_write_b32 a92, v56
  v_accvgpr_write_b32 a93, v57
  v_mfma_f32_16x16x32_bf16 v[132:135], a[24:27], a[136:139], v[132:135]
  ds_read_b128 a[20:23], v213 offset:12288
  v_accvgpr_write_b32 a94, v58
  v_mfma_f32_16x16x32_bf16 v[140:143], a[24:27], a[152:155], v[140:143]
  v_accvgpr_write_b32 a95, v59
  v_accvgpr_write_b32 a96, v64
  v_mfma_f32_16x16x32_bf16 v[148:151], a[24:27], a[168:171], v[148:151]
  v_accvgpr_write_b32 a97, v65
  v_accvgpr_write_b32 a98, v66
  v_mfma_f32_16x16x32_bf16 v[156:159], a[24:27], a[184:187], v[156:159]
  v_accvgpr_write_b32 a99, v67
  v_accvgpr_write_b32 a100, v72
  v_mfma_f32_16x16x32_bf16 v[132:135], a[28:31], a[140:143], v[132:135]
  ds_read_b128 a[24:27], v214 offset:12288
  v_accvgpr_write_b32 a101, v73
  v_mfma_f32_16x16x32_bf16 v[140:143], a[28:31], a[156:159], v[140:143]
  v_accvgpr_write_b32 a102, v74
  v_accvgpr_write_b32 a103, v75
  v_mfma_f32_16x16x32_bf16 v[148:151], a[28:31], a[172:175], v[148:151]
  v_accvgpr_write_b32 a104, v80
  v_accvgpr_write_b32 a105, v81
  v_mfma_f32_16x16x32_bf16 v[156:159], a[28:31], a[188:191], v[156:159]
  v_accvgpr_write_b32 a106, v82
  v_accvgpr_write_b32 a107, v83
  ds_read_b128 a[28:31], v215 offset:12288
  v_accvgpr_write_b32 a108, v88
  v_accvgpr_write_b32 a109, v89
  v_accvgpr_write_b32 a110, v90
  v_accvgpr_write_b32 a111, v91
  v_accvgpr_write_b32 a112, v96
  v_accvgpr_write_b32 a113, v97
  v_accvgpr_write_b32 a114, v98
  v_accvgpr_write_b32 a115, v99
  v_accvgpr_write_b32 a116, v104
  v_accvgpr_write_b32 a117, v105
  v_accvgpr_write_b32 a118, v106
  v_accvgpr_write_b32 a119, v107
  v_accvgpr_write_b32 a120, v112
  v_accvgpr_write_b32 a121, v113
  v_accvgpr_write_b32 a122, v114
  v_accvgpr_write_b32 a123, v115
  v_accvgpr_write_b32 a124, v120
  v_accvgpr_write_b32 a125, v121
  v_accvgpr_write_b32 a126, v122
  v_accvgpr_write_b32 a127, v123
  s_branch L_head2
L_ev2:
  s_waitcnt vmcnt(18) lgkmcnt(0)
  buffer_store_dwordx4 a[64:67], v230, s[20:23], s76 offen offset:0 sc1
  buffer_store_dwordx4 a[68:71], v230, s[20:23], s76 offen offset:1024 sc1
  buffer_store_dwordx4 a[72:75], v230, s[20:23], s76 offen offset:2048 sc1
  buffer_store_dwordx4 a[76:79], v230, s[20:23], s76 offen offset:3072 sc1
  s_branch L_ev2_ret
L_ev3:
  s_waitcnt vmcnt(22) lgkmcnt(0)
  buffer_store_dwordx4 a[80:83], v230, s[20:23], s77 offen offset:0 sc1
  buffer_store_dwordx4 a[84:87], v230, s[20:23], s77 offen offset:1024 sc1
  buffer_store_dwordx4 a[88:91], v230, s[20:23], s77 offen offset:2048 sc1
  buffer_store_dwordx4 a[92:95], v230, s[20:23], s77 offen offset:3072 sc1
  s_branch L_ev3_ret
L_ev4:
  s_waitcnt vmcnt(25) lgkmcnt(0)
  buffer_store_dwordx4 a[96:99], v230, s[20:23], s78 offen offset:0 sc1
  buffer_store_dwordx4 a[100:103], v230, s[20:23], s78 offen offset:1024 sc1
  buffer_store_dwordx4 a[104:107], v230, s[20:23], s78 offen offset:2048 sc1
  buffer_store_dwordx4 a[108:111], v230, s[20:23], s78 offen offset:3072 sc1
  s_branch L_ev4_ret
L_ev5:
  s_waitcnt vmcnt(29) lgkmcnt(0)
  buffer_store_dwordx4 a[112:115], v230, s[20:23], s79 offen offset:0 sc1
  buffer_store_dwordx4 a[116:119], v230, s[20:23], s79 offen offset:1024 sc1
  buffer_store_dwordx4 a[120:123], v230, s[20:23], s79 offen offset:2048 sc1
  buffer_store_dwordx4 a[124:127], v230, s[20:23], s79 offen offset:3072 sc1
  s_branch L_ev5_ret
L_ev6:
  s_waitcnt vmcnt(33) lgkmcnt(0)
  s_branch L_ev6_ret
L_opre:
  v_add_u32 v233, 0, v231
  v_mul_u32_u24 v234, 3277, v233
  v_lshrrev_b32 v234, 16, v234
  v_mul_u32_u24 v232, 20, v234
  v_sub_u32 v233, v233, v232
  v_lshrrev_b32 v232, 1, v234
  v_and_b32 v232, 2, v232
  v_xor_b32 v233, v233, v232
  v_mul_u32_u24 v234, 1280, v234
  v_lshl_add_u32 v233, v233, 4, v234
  v_subrev_u32 v192, 0, v233
  v_add_u32 v233, 64, v231
  v_mul_u32_u24 v234, 3277, v233
  v_lshrrev_b32 v234, 16, v234
  v_mul_u32_u24 v232, 20, v234
  v_sub_u32 v233, v233, v232
  v_lshrrev_b32 v232, 1, v234
  v_and_b32 v232, 2, v232
  v_xor_b32 v233, v233, v232
  v_mul_u32_u24 v234, 1280, v234
  v_lshl_add_u32 v233, v233, 4, v234
  v_subrev_u32 v193, 1024, v233
  v_add_u32 v233, 128, v231
  v_mul_u32_u24 v234, 3277, v233
  v_lshrrev_b32 v234, 16, v234
  v_mul_u32_u24 v232, 20, v234
  v_sub_u32 v233, v233, v232
  v_lshrrev_b32 v232, 1, v234
  v_and_b32 v232, 2, v232
  v_xor_b32 v233, v233, v232
  v_mul_u32_u24 v234, 1280, v234
  v_lshl_add_u32 v233, v233, 4, v234
  v_subrev_u32 v194, 2048, v233
  v_add_u32 v233, 192, v231
  v_mul_u32_u24 v234, 3277, v233
  v_lshrrev_b32 v234, 16, v234
  v_mul_u32_u24 v232, 20, v234
  v_sub_u32 v233, v233, v232
  v_lshrrev_b32 v232, 1, v234
  v_and_b32 v232, 2, v232
  v_xor_b32 v233, v233, v232
  v_mul_u32_u24 v234, 1280, v234
  v_lshl_add_u32 v233, v233, 4, v234
  v_subrev_u32 v195, 3072, v233
  v_add_u32 v233, 256, v231
  v_mul_u32_u24 v234, 3277, v233
  v_lshrrev_b32 v234, 16, v234
  v_mul_u32_u24 v232, 20, v234
  v_sub_u32 v233, v233, v232
  v_lshrrev_b32 v232, 1, v234
  v_and_b32 v232, 2, v232
  v_xor_b32 v233, v233, v232
  v_mul_u32_u24 v234, 1280, v234
  v_lshl_add_u32 v233, v233, 4, v234
  v_subrev_u32 v196, 0, v233
  s_mov_b32 s55, s101
  s_add_u32 m0, s100, 131072
  s_nop 0
  buffer_load_dwordx4 v192, s[64:67], s55 offen offset:0 lds
  buffer_load_dwordx4 v193, s[64:67], s55 offen offset:1024 lds
  buffer_load_dwordx4 v194, s[64:67], s55 offen offset:2048 lds
  buffer_load_dwordx4 v195, s[64:67], s55 offen offset:3072 lds
  s_add_u32 m0, s100, 135168
  s_nop 0
  buffer_load_dwordx4 v196, s[64:67], s55 offen offset:0 lds
  v_lshlrev_b32 v207, 2, v231
  buffer_load_dword v235, off, s[72:75], s81 sc1
  s_sub_u32 s55, s76, s53
  v_add_u32 v197, s55, v230
  s_sub_u32 s55, s77, s53
  v_add_u32 v198, s55, v230
  s_sub_u32 s55, s78, s53
  v_add_u32 v199, s55, v230
  s_sub_u32 s55, s79, s53
  v_add_u32 v200, s55, v230
  v_lshrrev_b32 v233, 2, v231
  v_mul_u32_u24 v233, 320, v233
  v_and_b32 v234, 3, v231
  v_lshl_add_u32 v233, v234, 3, v233
  v_and_b32 v234, 16, v231
  v_lshl_add_u32 v201, v234, 1, v233
  v_xor_b32 v202, 32, v201
  v_add_u32 v203, 131072, v201
  v_add_u32 v204, 131072, v202
  v_add_u32 v205, 69632, v201
  v_add_u32 v206, 69632, v202
  s_branch L_opre_ret
L_tailB:
  s_waitcnt vmcnt(0) lgkmcnt(0)
  s_barrier
  ds_read_b128 v[236:239], v234 offset:0
  v_readfirstlane_b32 s55, v235
  s_nop 3
  s_cmp_ge_u32 s55, 16
  s_cbranch_scc0 L_spinR
L_spinR_ret:
  s_cmp_eq_u32 s24, 0
  s_cselect_b32 s55, s59, 0
  s_mov_b32 s59, 0
  s_mov_b32 s0, 0
  s_cmp_eq_u32 s55, 0
  s_cbranch_scc1 L_nosigA
  s_mov_b64 exec, 1
  v_mov_b32 v233, 1
  buffer_store_dword v233, off, s[36:39], s80 offset:0 sc1
  s_mov_b64 exec, -1
L_nosigA:
  v_pk_mul_f32 v[0:1], v[0:1], v[240:241]
  v_pk_mul_f32 v[2:3], v[2:3], v[240:241]
  v_pk_mul_f32 v[4:5], v[4:5], v[240:241]
  v_pk_mul_f32 v[6:7], v[6:7], v[240:241]
  v_cvt_pk_bf16_f32 v128, v0, v1
  s_add_u32 s56, s101, 81920
  s_add_u32 m0, s100, 69632
  v_cvt_pk_bf16_f32 v129, v2, v3
  v_cvt_pk_bf16_f32 v130, v4, v5
  v_cvt_pk_bf16_f32 v131, v6, v7
  v_pk_mul_f32 v[8:9], v[8:9], v[240:241]
  v_pk_mul_f32 v[10:11], v[10:11], v[240:241]
  buffer_load_dwordx4 v192, s[64:67], s56 offen offset:0 lds
  v_pk_mul_f32 v[12:13], v[12:13], v[240:241]
  v_pk_mul_f32 v[14:15], v[14:15], v[240:241]
  v_cvt_pk_bf16_f32 v132, v8, v9
  v_cvt_pk_bf16_f32 v133, v10, v11
  v_cvt_pk_bf16_f32 v134, v12, v13
  buffer_load_dwordx4 v193, s[64:67], s56 offen offset:1024 lds
  v_cvt_pk_bf16_f32 v135, v14, v15
  v_pk_mul_f32 v[16:17], v[16:17], v[240:241]
  v_pk_mul_f32 v[18:19], v[18:19], v[240:241]
  v_pk_mul_f32 v[20:21], v[20:21], v[240:241]
  v_pk_mul_f32 v[22:23], v[22:23], v[240:241]
  buffer_load_dwordx4 v194, s[64:67], s56 offen offset:2048 lds
  v_cvt_pk_bf16_f32 v136, v16, v17
  v_cvt_pk_bf16_f32 v137, v18, v19
  v_cvt_pk_bf16_f32 v138, v20, v21
  v_cvt_pk_bf16_f32 v139, v22, v23
  v_pk_mul_f32 v[24:25], v[24:25], v[240:241]
  buffer_load_dwordx4 v195, s[64:67], s56 offen offset:3072 lds
  s_add_u32 m0, s100, 73728
  v_pk_mul_f32 v[26:27], v[26:27], v[240:241]
  v_pk_mul_f32 v[28:29], v[28:29], v[240:241]
  v_pk_mul_f32 v[30:31], v[30:31], v[240:241]
  v_cvt_pk_bf16_f32 v140, v24, v25
  v_cvt_pk_bf16_f32 v141, v26, v27
  buffer_load_dwordx4 v196, s[64:67], s56 offen offset:0 lds
  s_add_u32 s56, s56, 81920
  v_cvt_pk_bf16_f32 v142, v28, v29
  v_cvt_pk_bf16_f32 v143, v30, v31
  ds_read_b64_tr_b16 a[0:1], v203 offset:0
  ds_read_b64_tr_b16 a[2:3], v203 offset:5120
  ds_read_b64_tr_b16 a[4:5], v204 offset:0
  ds_read_b64_tr_b16 a[6:7], v204 offset:5120
  ds_read_b64_tr_b16 a[8:9], v203 offset:64
  ds_read_b64_tr_b16 a[10:11], v203 offset:5184
  ds_read_b64_tr_b16 a[12:13], v204 offset:64
  ds_read_b64_tr_b16 a[14:15], v204 offset:5184
  ds_read_b64_tr_b16 a[16:17], v203 offset:128
  ds_read_b64_tr_b16 a[18:19], v203 offset:5248
  ds_read_b64_tr_b16 a[20:21], v204 offset:128
  ds_read_b64_tr_b16 a[22:23], v204 offset:5248
  s_waitcnt lgkmcnt(0)
  v_or_b32 v236, v236, v237
  v_or3_b32 v236, v236, v238, v239
  s_nop 0
  v_readfirstlane_b32 s55, v236
  s_nop 3
  s_andn2_b32 s55, s55, s54
  s_cbranch_scc1 L_fallback
  s_and_b32 s8, s25, 3
  s_lshl_b32 s5, s82, 3
  s_lshl_b32 s15, 1, s5
  s_or_b32 s5, s5, 0x80000
  s_mov_b32 s6, 1
  s_mov_b32 s7, 15488
  s_mov_b32 s11, 0
  v_or_b32 v249, s24, v231
  v_lshlrev_b32 v249, 20, v249
  v_mov_b32 v248, s15
  buffer_atomic_add v248, v249, s[60:63], s7 offen sc0 sc1
  v_mov_b32 v250, v232
  v_mov_b32 v251, 163824
  v_mov_b32 v236, 0
  v_mov_b32 v237, 0
  v_mov_b32 v238, 0
  v_mov_b32 v239, 0
  v_pk_mul_f32 v[32:33], v[32:33], v[242:243]
  v_pk_mul_f32 v[34:35], v[34:35], v[242:243]
  v_pk_mul_f32 v[36:37], v[36:37], v[242:243]
  v_pk_mul_f32 v[38:39], v[38:39], v[242:243]
  v_cvt_pk_bf16_f32 v144, v32, v33
  v_cvt_pk_bf16_f32 v145, v34, v35
  v_cvt_pk_bf16_f32 v146, v36, v37
  v_cvt_pk_bf16_f32 v147, v38, v39
  s_add_u32 m0, s100, 90112
  v_pk_mul_f32 v[40:41], v[40:41], v[242:243]
  v_pk_mul_f32 v[42:43], v[42:43], v[242:243]
  v_pk_mul_f32 v[44:45], v[44:45], v[242:243]
  v_pk_mul_f32 v[46:47], v[46:47], v[242:243]
  v_cvt_pk_bf16_f32 v148, v40, v41
  v_cvt_pk_bf16_f32 v149, v42, v43
  v_cvt_pk_bf16_f32 v150, v44, v45
  v_cvt_pk_bf16_f32 v151, v46, v47
  buffer_load_dwordx4 v192, s[64:67], s56 offen offset:0 lds
  v_pk_mul_f32 v[48:49], v[48:49], v[242:243]
  v_pk_mul_f32 v[50:51], v[50:51], v[242:243]
  v_pk_mul_f32 v[52:53], v[52:53], v[242:243]
  v_pk_mul_f32 v[54:55], v[54:55], v[242:243]
  v_cvt_pk_bf16_f32 v152, v48, v49
  v_cvt_pk_bf16_f32 v153, v50, v51
  v_cvt_pk_bf16_f32 v154, v52, v53
  v_cvt_pk_bf16_f32 v155, v54, v55
  buffer_load_dwordx4 v193, s[64:67], s56 offen offset:1024 lds
  v_pk_mul_f32 v[56:57], v[56:57], v[242:243]
  v_pk_mul_f32 v[58:59], v[58:59], v[242:243]
  v_pk_mul_f32 v[60:61], v[60:61], v[242:243]
  v_pk_mul_f32 v[62:63], v[62:63], v[242:243]
  v_cvt_pk_bf16_f32 v156, v56, v57
  v_cvt_pk_bf16_f32 v157, v58, v59
  v_cvt_pk_bf16_f32 v158, v60, v61
  v_cvt_pk_bf16_f32 v159, v62, v63
  buffer_load_dwordx4 v194, s[64:67], s56 offen offset:2048 lds
  v_mfma_f32_32x32x16_bf16 v[0:15], v[236:239], v[236:239], 0
  v_mfma_f32_32x32x16_bf16 v[16:31], v[236:239], v[236:239], 0
  v_mfma_f32_32x32x16_bf16 v[32:47], v[236:239], v[236:239], 0
  v_pk_mul_f32 v[64:65], v[64:65], v[244:245]
  v_pk_mul_f32 v[66:67], v[66:67], v[244:245]
  v_pk_mul_f32 v[68:69], v[68:69], v[244:245]
  v_pk_mul_f32 v[70:71], v[70:71], v[244:245]
  v_cvt_pk_bf16_f32 v160, v64, v65
  buffer_load_dwordx4 v195, s[64:67], s56 offen offset:3072 lds
  s_add_u32 m0, s100, 94208
  v_cvt_pk_bf16_f32 v161, v66, v67
  v_cvt_pk_bf16_f32 v162, v68, v69
  v_cvt_pk_bf16_f32 v163, v70, v71
  v_pk_mul_f32 v[72:73], v[72:73], v[244:245]
  v_pk_mul_f32 v[74:75], v[74:75], v[244:245]
  v_pk_mul_f32 v[76:77], v[76:77], v[244:245]
  v_pk_mul_f32 v[78:79], v[78:79], v[244:245]
  v_cvt_pk_bf16_f32 v164, v72, v73
  buffer_load_dwordx4 v196, s[64:67], s56 offen offset:0 lds
  s_add_u32 s56, s56, 81920
  s_add_u32 m0, s100, 110592
  v_cvt_pk_bf16_f32 v165, v74, v75
  v_cvt_pk_bf16_f32 v166, v76, v77
  v_cvt_pk_bf16_f32 v167, v78, v79
  v_pk_mul_f32 v[80:81], v[80:81], v[244:245]
  v_pk_mul_f32 v[82:83], v[82:83], v[244:245]
  v_pk_mul_f32 v[84:85], v[84:85], v[244:245]
  v_pk_mul_f32 v[86:87], v[86:87], v[244:245]
  v_cvt_pk_bf16_f32 v168, v80, v81
  buffer_load_dwordx4 v192, s[64:67], s56 offen offset:0 lds
  v_cvt_pk_bf16_f32 v169, v82, v83
  v_cvt_pk_bf16_f32 v170, v84, v85
  v_cvt_pk_bf16_f32 v171, v86, v87
  v_pk_mul_f32 v[88:89], v[88:89], v[244:245]
  v_pk_mul_f32 v[90:91], v[90:91], v[244:245]
  v_pk_mul_f32 v[92:93], v[92:93], v[244:245]
  v_pk_mul_f32 v[94:95], v[94:95], v[244:245]
  v_cvt_pk_bf16_f32 v172, v88, v89
  buffer_load_dwordx4 v193, s[64:67], s56 offen offset:1024 lds
  v_cvt_pk_bf16_f32 v173, v90, v91
  v_cvt_pk_bf16_f32 v174, v92, v93
  v_cvt_pk_bf16_f32 v175, v94, v95
  v_pk_mul_f32 v[96:97], v[96:97], v[246:247]
  v_pk_mul_f32 v[98:99], v[98:99], v[246:247]
  v_pk_mul_f32 v[100:101], v[100:101], v[246:247]
  v_pk_mul_f32 v[102:103], v[102:103], v[246:247]
  v_cvt_pk_bf16_f32 v176, v96, v97
  buffer_load_dwordx4 v194, s[64:67], s56 offen offset:2048 lds
  v_cvt_pk_bf16_f32 v177, v98, v99
  v_cvt_pk_bf16_f32 v178, v100, v101
  v_cvt_pk_bf16_f32 v179, v102, v103
  v_pk_mul_f32 v[104:105], v[104:105], v[246:247]
  v_pk_mul_f32 v[106:107], v[106:107], v[246:247]
  v_pk_mul_f32 v[108:109], v[108:109], v[246:247]
  v_pk_mul_f32 v[110:111], v[110:111], v[246:247]
  v_cvt_pk_bf16_f32 v180, v104, v105
  buffer_load_dwordx4 v195, s[64:67], s56 offen offset:3072 lds
  s_add_u32 m0, s100, 114688
  v_cvt_pk_bf16_f32 v181, v106, v107
  v_cvt_pk_bf16_f32 v182, v108, v109
  v_cvt_pk_bf16_f32 v183, v110, v111
  v_pk_mul_f32 v[112:113], v[112:113], v[246:247]
  v_pk_mul_f32 v[114:115], v[114:115], v[246:247]
  v_pk_mul_f32 v[116:117], v[116:117], v[246:247]
  v_pk_mul_f32 v[118:119], v[118:119], v[246:247]
  v_cvt_pk_bf16_f32 v184, v112, v113
  buffer_load_dwordx4 v196, s[64:67], s56 offen offset:0 lds
  s_add_u32 s56, s56, 81920
  v_cvt_pk_bf16_f32 v185, v114, v115
  v_cvt_pk_bf16_f32 v186, v116, v117
  v_cvt_pk_bf16_f32 v187, v118, v119
  v_pk_mul_f32 v[120:121], v[120:121], v[246:247]
  v_pk_mul_f32 v[122:123], v[122:123], v[246:247]
  v_pk_mul_f32 v[124:125], v[124:125], v[246:247]
  v_pk_mul_f32 v[126:127], v[126:127], v[246:247]
  v_cvt_pk_bf16_f32 v188, v120, v121
  v_cvt_pk_bf16_f32 v189, v122, v123
  v_cvt_pk_bf16_f32 v190, v124, v125
  v_cvt_pk_bf16_f32 v191, v126, v127
  s_add_u32 s53, s53, 65536
  s_mul_i32 s55, s24, 1280
  s_add_u32 s55, s55, L_oexit-L_pc
  v_min_u32 v243, 9, v231
  v_lshl_add_u32 v243, v243, 7, s55
  v_mfma_f32_16x16x32_bf16 v[40:43], a[0:3], a[80:83], 0
  ds_read_b64_tr_b16 a[24:25], v203 offset:192
  ds_read_b64_tr_b16 a[26:27], v203 offset:5312
  v_mfma_f32_16x16x32_bf16 v[80:83], a[0:3], a[96:99], 0
  v_mfma_f32_16x16x32_bf16 v[120:123], a[0:3], a[112:115], 0
  v_mfma_f32_16x16x32_bf16 v[124:127], a[4:7], a[112:115], 0
  ds_read_b64_tr_b16 a[28:29], v204 offset:192
  ds_read_b64_tr_b16 a[30:31], v204 offset:5312
  v_mfma_f32_16x16x32_bf16 v[84:87], a[4:7], a[96:99], 0
  v_mfma_f32_16x16x32_bf16 v[44:47], a[4:7], a[80:83], 0
  v_mfma_f32_16x16x32_bf16 v[48:51], a[8:11], a[80:83], 0
  ds_read_b64_tr_b16 a[32:33], v203 offset:256
  ds_read_b64_tr_b16 a[34:35], v203 offset:5376
  v_mfma_f32_16x16x32_bf16 v[88:91], a[8:11], a[96:99], 0
  buffer_store_dwordx4 v[128:131], v197, s[20:23], s53 offen offset:0 sc1
  v_mfma_f32_16x16x32_bf16 v[208:211], a[8:11], a[112:115], 0
  v_mfma_f32_16x16x32_bf16 v[212:215], a[12:15], a[112:115], 0
  ds_read_b64_tr_b16 a[36:37], v204 offset:256
  ds_read_b64_tr_b16 a[38:39], v204 offset:5376
  v_mfma_f32_16x16x32_bf16 v[92:95], a[12:15], a[96:99], 0
  v_mfma_f32_16x16x32_bf16 v[52:55], a[12:15], a[80:83], 0
  v_mfma_f32_16x16x32_bf16 v[56:59], a[16:19], a[80:83], 0
  ds_read_b64_tr_b16 a[0:1], v203 offset:10240
  ds_read_b64_tr_b16 a[2:3], v203 offset:15360
  v_mfma_f32_16x16x32_bf16 v[96:99], a[16:19], a[96:99], 0
  v_mfma_f32_16x16x32_bf16 v[216:219], a[16:19], a[112:115], 0
  v_mfma_f32_16x16x32_bf16 v[220:223], a[20:23], a[112:115], 0
  ds_read_b64_tr_b16 a[4:5], v204 offset:10240
  ds_read_b64_tr_b16 a[6:7], v204 offset:15360
  v_mfma_f32_16x16x32_bf16 v[100:103], a[20:23], a[96:99], 0
  v_mfma_f32_16x16x32_bf16 v[60:63], a[20:23], a[80:83], 0
  s_waitcnt lgkmcnt(10)
  v_mfma_f32_16x16x32_bf16 v[64:67], a[24:27], a[80:83], 0
  ds_read_b64_tr_b16 a[8:9], v203 offset:10304
  ds_read_b64_tr_b16 a[10:11], v203 offset:15424
  v_mfma_f32_16x16x32_bf16 v[104:107], a[24:27], a[96:99], 0
  v_mfma_f32_16x16x32_bf16 v[224:227], a[24:27], a[112:115], 0
  s_waitcnt lgkmcnt(10)
  v_mfma_f32_16x16x32_bf16 v[228:231], a[28:31], a[112:115], 0
  ds_read_b64_tr_b16 a[12:13], v204 offset:10304
  ds_read_b64_tr_b16 a[14:15], v204 offset:15424
  v_mfma_f32_16x16x32_bf16 v[108:111], a[28:31], a[96:99], 0
  v_mfma_f32_16x16x32_bf16 v[68:71], a[28:31], a[80:83], 0
  s_waitcnt lgkmcnt(10)
  v_mfma_f32_16x16x32_bf16 v[72:75], a[32:35], a[80:83], 0
  ds_read_b64_tr_b16 a[16:17], v203 offset:10368
  ds_read_b64_tr_b16 a[18:19], v203 offset:15488
  v_mfma_f32_16x16x32_bf16 v[112:115], a[32:35], a[96:99], 0
  buffer_store_dwordx4 v[132:135], v197, s[20:23], s53 offen offset:1024 sc1
  v_mfma_f32_16x16x32_bf16 v[232:235], a[32:35], a[112:115], 0
  s_waitcnt lgkmcnt(10)
  v_mfma_f32_16x16x32_bf16 v[236:239], a[36:39], a[112:115], 0
  ds_read_b64_tr_b16 a[20:21], v204 offset:10368
  ds_read_b64_tr_b16 a[22:23], v204 offset:15488
  v_mfma_f32_16x16x32_bf16 v[116:119], a[36:39], a[96:99], 0
  v_mfma_f32_16x16x32_bf16 v[76:79], a[36:39], a[80:83], 0
  s_waitcnt lgkmcnt(10)
  v_mfma_f32_16x16x32_bf16 v[40:43], a[0:3], a[84:87], v[40:43]
  ds_read_b64_tr_b16 a[24:25], v203 offset:10432
  ds_read_b64_tr_b16 a[26:27], v203 offset:15552
  v_mfma_f32_16x16x32_bf16 v[80:83], a[0:3], a[100:103], v[80:83]
  v_mfma_f32_16x16x32_bf16 v[120:123], a[0:3], a[116:119], v[120:123]
  s_waitcnt lgkmcnt(10)
  v_mfma_f32_16x16x32_bf16 v[124:127], a[4:7], a[116:119], v[124:127]
  ds_read_b64_tr_b16 a[28:29], v204 offset:10432
  ds_read_b64_tr_b16 a[30:31], v204 offset:15552
  v_mfma_f32_16x16x32_bf16 v[84:87], a[4:7], a[100:103], v[84:87]
  v_mfma_f32_16x16x32_bf16 v[44:47], a[4:7], a[84:87], v[44:47]
  s_waitcnt lgkmcnt(10)
  v_mfma_f32_16x16x32_bf16 v[48:51], a[8:11], a[84:87], v[48:51]
  ds_read_b64_tr_b16 a[32:33], v203 offset:10496
  ds_read_b64_tr_b16 a[34:35], v203 offset:15616
  v_mfma_f32_16x16x32_bf16 v[88:91], a[8:11], a[100:103], v[88:91]
  buffer_store_dwordx4 v[136:139], v197, s[20:23], s53 offen offset:2048 sc1
  v_mfma_f32_16x16x32_bf16 v[208:211], a[8:11], a[116:119], v[208:211]
  s_waitcnt lgkmcnt(10)
  v_mfma_f32_16x16x32_bf16 v[212:215], a[12:15], a[116:119], v[212:215]
  ds_read_b64_tr_b16 a[36:37], v204 offset:10496
  ds_read_b64_tr_b16 a[38:39], v204 offset:15616
  v_mfma_f32_16x16x32_bf16 v[92:95], a[12:15], a[100:103], v[92:95]
  s_waitcnt vmcnt(13)
  v_mfma_f32_16x16x32_bf16 v[52:55], a[12:15], a[84:87], v[52:55]
  s_waitcnt lgkmcnt(10)
  v_readfirstlane_b32 s15, v248
  v_mfma_f32_16x16x32_bf16 v[56:59], a[16:19], a[84:87], v[56:59]
  s_nop 0
  v_mov_b32 v245, s15
  v_mfma_f32_16x16x32_bf16 v[96:99], a[16:19], a[100:103], v[96:99]
  v_mfma_f32_16x16x32_bf16 v[216:219], a[16:19], a[116:119], v[216:219]
  s_waitcnt lgkmcnt(8)
  ds_write_b32 v250, v245 offset:0
  v_mfma_f32_16x16x32_bf16 v[220:223], a[20:23], a[116:119], v[220:223]
  s_waitcnt vmcnt(14) lgkmcnt(0)
  v_mfma_f32_16x16x32_bf16 v[100:103], a[20:23], a[100:103], v[100:103]
  s_barrier
  v_mfma_f32_16x16x32_bf16 v[60:63], a[20:23], a[84:87], v[60:63]
  ds_read_b32 v246, v251 offset:0
  ds_read_b64_tr_b16 a[0:1], v205 offset:0
  ds_read_b64_tr_b16 a[2:3], v205 offset:5120
  v_mfma_f32_16x16x32_bf16 v[64:67], a[24:27], a[84:87], v[64:67]
  v_mfma_f32_16x16x32_bf16 v[104:107], a[24:27], a[100:103], v[104:107]
  ds_read_b64_tr_b16 a[4:5], v206 offset:0
  ds_read_b64_tr_b16 a[6:7], v206 offset:5120
  v_mfma_f32_16x16x32_bf16 v[224:227], a[24:27], a[116:119], v[224:227]
  v_mfma_f32_16x16x32_bf16 v[228:231], a[28:31], a[116:119], v[228:231]
  ds_read_b64_tr_b16 a[8:9], v205 offset:64
  ds_read_b64_tr_b16 a[10:11], v205 offset:5184
  v_mfma_f32_16x16x32_bf16 v[108:111], a[28:31], a[100:103], v[108:111]
  v_mfma_f32_16x16x32_bf16 v[68:71], a[28:31], a[84:87], v[68:71]
  ds_read_b64_tr_b16 a[12:13], v206 offset:64
  ds_read_b64_tr_b16 a[14:15], v206 offset:5184
  v_mfma_f32_16x16x32_bf16 v[72:75], a[32:35], a[84:87], v[72:75]
  v_mfma_f32_16x16x32_bf16 v[112:115], a[32:35], a[100:103], v[112:115]
  ds_read_b64_tr_b16 a[16:17], v205 offset:128
  ds_read_b64_tr_b16 a[18:19], v205 offset:5248
  v_mfma_f32_16x16x32_bf16 v[232:235], a[32:35], a[116:119], v[232:235]
  buffer_store_dwordx4 v[140:143], v197, s[20:23], s53 offen offset:3072 sc1
  v_mfma_f32_16x16x32_bf16 v[236:239], a[36:39], a[116:119], v[236:239]
  ds_read_b64_tr_b16 a[20:21], v206 offset:128
  ds_read_b64_tr_b16 a[22:23], v206 offset:5248
  v_mfma_f32_16x16x32_bf16 v[116:119], a[36:39], a[100:103], v[116:119]
  v_mfma_f32_16x16x32_bf16 v[76:79], a[36:39], a[84:87], v[76:79]
  s_waitcnt lgkmcnt(10)
  s_waitcnt lgkmcnt(12)
  v_readfirstlane_b32 s4, v246
  v_mfma_f32_16x16x32_bf16 v[40:43], a[0:3], a[88:91], v[40:43]
  s_bfe_u32 s19, s4, s5
  ds_read_b64_tr_b16 a[24:25], v205 offset:192
  ds_read_b64_tr_b16 a[26:27], v205 offset:5312
  v_mfma_f32_16x16x32_bf16 v[80:83], a[0:3], a[104:107], v[80:83]
  s_cmp_lt_u32 s19, 6
  s_cselect_b32 s12, s6, 0
  s_mov_b32 s26, s5
  v_mfma_f32_16x16x32_bf16 v[120:123], a[0:3], a[120:123], v[120:123]
  s_waitcnt lgkmcnt(10)
  s_lshl_b32 s15, 1, s5
  s_add_u32 s4, s4, s15
  s_lshl_b32 s17, s82, 3
  v_mfma_f32_16x16x32_bf16 v[124:127], a[4:7], a[120:123], v[124:127]
  s_or_b32 s17, s17, 0x80000
  ds_read_b64_tr_b16 a[28:29], v206 offset:192
  ds_read_b64_tr_b16 a[30:31], v206 offset:5312
  v_mfma_f32_16x16x32_bf16 v[84:87], a[4:7], a[104:107], v[84:87]
  s_xor_b32 s5, s17, 8
  s_bfe_u32 s16, s4, s5
  s_xor_b32 s56, s17, 16
  v_mfma_f32_16x16x32_bf16 v[44:47], a[4:7], a[88:91], v[44:47]
  s_waitcnt lgkmcnt(10)
  s_bfe_u32 s15, s4, s56
  v_mfma_f32_16x16x32_bf16 v[48:51], a[8:11], a[88:91], v[48:51]
  ds_read_b64_tr_b16 a[32:33], v205 offset:256
  ds_read_b64_tr_b16 a[34:35], v205 offset:5376
  v_mfma_f32_16x16x32_bf16 v[88:91], a[8:11], a[104:107], v[88:91]
  buffer_store_dwordx4 v[144:147], v198, s[20:23], s53 offen offset:0 sc1
  v_mfma_f32_16x16x32_bf16 v[208:211], a[8:11], a[120:123], v[208:211]
  s_waitcnt lgkmcnt(10)
  s_cmp_lt_u32 s15, s16
  s_cselect_b32 s5, s56, s5
  s_cselect_b32 s16, s15, s16
  v_mfma_f32_16x16x32_bf16 v[212:215], a[12:15], a[120:123], v[212:215]
  s_xor_b32 s56, s17, 24
  ds_read_b64_tr_b16 a[36:37], v206 offset:256
  ds_read_b64_tr_b16 a[38:39], v206 offset:5376
  v_mfma_f32_16x16x32_bf16 v[92:95], a[12:15], a[104:107], v[92:95]
  s_bfe_u32 s15, s4, s56
  v_mfma_f32_16x16x32_bf16 v[52:55], a[12:15], a[88:91], v[52:55]
  s_waitcnt lgkmcnt(10)
  s_cmp_lt_u32 s15, s16
  s_cselect_b32 s5, s56, s5
  s_cselect_b32 s16, s15, s16
  v_mfma_f32_16x16x32_bf16 v[56:59], a[16:19], a[88:91], v[56:59]
  s_bfe_u32 s15, s4, s17
  ds_read_b64_tr_b16 a[0:1], v205 offset:10240
  ds_read_b64_tr_b16 a[2:3], v205 offset:15360
  v_mfma_f32_16x16x32_bf16 v[96:99], a[16:19], a[104:107], v[96:99]
  s_cmp_lt_u32 s15, 6
  s_cselect_b32 s5, s17, s5
  s_cselect_b32 s16, s15, s16
  v_mfma_f32_16x16x32_bf16 v[216:219], a[16:19], a[120:123], v[216:219]
  s_waitcnt lgkmcnt(10)
  s_cmp_lt_u32 s16, 6
  s_cselect_b32 s6, s12, 0
  s_mov_b32 s15, 15488
  v_mfma_f32_16x16x32_bf16 v[220:223], a[20:23], a[120:123], v[220:223]
  ds_read_b64_tr_b16 a[4:5], v206 offset:10240
  ds_read_b64_tr_b16 a[6:7], v206 offset:15360
  v_mfma_f32_16x16x32_bf16 v[100:103], a[20:23], a[104:107], v[100:103]
  s_cmp_lg_u32 s6, 0
  s_cselect_b32 s7, s15, 0x40000000
  s_lshl_b32 s15, 1, s5
  v_mfma_f32_16x16x32_bf16 v[60:63], a[20:23], a[88:91], v[60:63]
  s_waitcnt lgkmcnt(10)
  v_mfma_f32_16x16x32_bf16 v[64:67], a[24:27], a[88:91], v[64:67]
  ds_read_b64_tr_b16 a[8:9], v205 offset:10304
  ds_read_b64_tr_b16 a[10:11], v205 offset:15424
  v_mfma_f32_16x16x32_bf16 v[104:107], a[24:27], a[104:107], v[104:107]
  v_mfma_f32_16x16x32_bf16 v[224:227], a[24:27], a[120:123], v[224:227]
  s_waitcnt lgkmcnt(10)
  v_mfma_f32_16x16x32_bf16 v[228:231], a[28:31], a[120:123], v[228:231]
  ds_read_b64_tr_b16 a[12:13], v206 offset:10304
  ds_read_b64_tr_b16 a[14:15], v206 offset:15424
  v_mfma_f32_16x16x32_bf16 v[108:111], a[28:31], a[104:107], v[108:111]
  v_mov_b32 v248, s15
  v_mfma_f32_16x16x32_bf16 v[68:71], a[28:31], a[88:91], v[68:71]
  s_waitcnt lgkmcnt(10)
  buffer_atomic_add v248, v249, s[60:63], s7 offen sc0 sc1
  v_mfma_f32_16x16x32_bf16 v[72:75], a[32:35], a[88:91], v[72:75]
  ds_read_b64_tr_b16 a[16:17], v205 offset:10368
  ds_read_b64_tr_b16 a[18:19], v205 offset:15488
  buffer_load_dword v252, v207, s[36:39], 0 offen sc1
  v_mfma_f32_16x16x32_bf16 v[112:115], a[32:35], a[104:107], v[112:115]
  buffer_store_dwordx4 v[148:151], v198, s[20:23], s53 offen offset:1024 sc1
  v_mfma_f32_16x16x32_bf16 v[232:235], a[32:35], a[120:123], v[232:235]
  s_waitcnt lgkmcnt(10)
  v_mfma_f32_16x16x32_bf16 v[236:239], a[36:39], a[120:123], v[236:239]
  ds_read_b64_tr_b16 a[20:21], v206 offset:10368
  ds_read_b64_tr_b16 a[22:23], v206 offset:15488
  v_mfma_f32_16x16x32_bf16 v[116:119], a[36:39], a[104:107], v[116:119]
  v_mfma_f32_16x16x32_bf16 v[76:79], a[36:39], a[88:91], v[76:79]
  s_waitcnt lgkmcnt(10)
  v_mfma_f32_16x16x32_bf16 v[40:43], a[0:3], a[92:95], v[40:43]
  ds_read_b64_tr_b16 a[24:25], v205 offset:10432
  ds_read_b64_tr_b16 a[26:27], v205 offset:15552
  v_mfma_f32_16x16x32_bf16 v[80:83], a[0:3], a[108:111], v[80:83]
  s_cmp_ge_u32 s19, 3
  s_cselect_b32 s18, 1, 0
  s_mul_i32 s15, s18, 3
  v_mfma_f32_16x16x32_bf16 v[120:123], a[0:3], a[124:127], v[120:123]
  s_waitcnt lgkmcnt(10)
  s_sub_u32 s15, s19, s15
  s_cmp_ge_u32 s15, s8
  s_addc_u32 s15, s15, 0
  v_mfma_f32_16x16x32_bf16 v[124:127], a[4:7], a[124:127], v[124:127]
  s_and_b32 s15, s15, 3
  ds_read_b64_tr_b16 a[28:29], v206 offset:10432
  ds_read_b64_tr_b16 a[30:31], v206 offset:15552
  v_mfma_f32_16x16x32_bf16 v[84:87], a[4:7], a[108:111], v[84:87]
  s_bfe_u32 s9, s26, 0x20003
  s_lshl2_add_u32 s15, s9, s15
  s_lshl4_add_u32 s9, s18, s15
  v_mfma_f32_16x16x32_bf16 v[44:47], a[4:7], a[92:95], v[44:47]
  s_waitcnt lgkmcnt(10)
  s_lshl_b32 s87, s9, 12
  s_lshl1_add_u32 s15, s15, s18
  s_lshl3_add_u32 s15, s15, s24
  v_mfma_f32_16x16x32_bf16 v[48:51], a[8:11], a[92:95], v[48:51]
  s_mul_i32 s84, s15, 20480
  ds_read_b64_tr_b16 a[32:33], v205 offset:10496
  ds_read_b64_tr_b16 a[34:35], v205 offset:15616
  v_mfma_f32_16x16x32_bf16 v[88:91], a[8:11], a[108:111], v[88:91]
  s_xor_b32 s10, s12, 1
  s_and_b32 s18, s18, s12
  buffer_store_dwordx4 v[152:155], v198, s[20:23], s53 offen offset:2048 sc1
  v_mfma_f32_16x16x32_bf16 v[208:211], a[8:11], a[124:127], v[208:211]
  s_waitcnt lgkmcnt(10)
  s_cmp_eq_u32 s12, 0
  s_cselect_b32 s84, 0x40000000, s84
  s_cselect_b32 s87, 0x40000000, s87
  v_mfma_f32_16x16x32_bf16 v[212:215], a[12:15], a[124:127], v[212:215]
  ds_read_b64_tr_b16 a[36:37], v206 offset:10496
  ds_read_b64_tr_b16 a[38:39], v206 offset:15616
  v_mfma_f32_16x16x32_bf16 v[92:95], a[12:15], a[108:111], v[92:95]
  v_mfma_f32_16x16x32_bf16 v[52:55], a[12:15], a[92:95], v[52:55]
  s_waitcnt lgkmcnt(10)
  v_mfma_f32_16x16x32_bf16 v[56:59], a[16:19], a[92:95], v[56:59]
  v_mfma_f32_16x16x32_bf16 v[96:99], a[16:19], a[108:111], v[96:99]
  v_mfma_f32_16x16x32_bf16 v[216:219], a[16:19], a[124:127], v[216:219]
  s_waitcnt lgkmcnt(8)
  v_mfma_f32_16x16x32_bf16 v[220:223], a[20:23], a[124:127], v[220:223]
  s_waitcnt vmcnt(14) lgkmcnt(0)
  v_mfma_f32_16x16x32_bf16 v[100:103], a[20:23], a[108:111], v[100:103]
  s_barrier
  v_mfma_f32_16x16x32_bf16 v[60:63], a[20:23], a[92:95], v[60:63]
  ds_read_b64_tr_b16 a[0:1], v205 offset:20480
  ds_read_b64_tr_b16 a[2:3], v205 offset:25600
  v_mfma_f32_16x16x32_bf16 v[64:67], a[24:27], a[92:95], v[64:67]
  s_add_u32 m0, s100, 0
  v_mfma_f32_16x16x32_bf16 v[104:107], a[24:27], a[108:111], v[104:107]
  ds_read_b64_tr_b16 a[4:5], v206 offset:20480
  ds_read_b64_tr_b16 a[6:7], v206 offset:25600
  v_mfma_f32_16x16x32_bf16 v[224:227], a[24:27], a[124:127], v[224:227]
  buffer_load_dwordx4 v192, s[64:67], s84 offen offset:0 lds
  v_mfma_f32_16x16x32_bf16 v[228:231], a[28:31], a[124:127], v[228:231]
  ds_read_b64_tr_b16 a[8:9], v205 offset:20544
  ds_read_b64_tr_b16 a[10:11], v205 offset:25664
  v_mfma_f32_16x16x32_bf16 v[108:111], a[28:31], a[108:111], v[108:111]
  v_mfma_f32_16x16x32_bf16 v[68:71], a[28:31], a[92:95], v[68:71]
  ds_read_b64_tr_b16 a[12:13], v206 offset:20544
  ds_read_b64_tr_b16 a[14:15], v206 offset:25664
  v_mfma_f32_16x16x32_bf16 v[72:75], a[32:35], a[92:95], v[72:75]
  v_mfma_f32_16x16x32_bf16 v[112:115], a[32:35], a[108:111], v[112:115]
  ds_read_b64_tr_b16 a[16:17], v205 offset:20608
  ds_read_b64_tr_b16 a[18:19], v205 offset:25728
  v_mfma_f32_16x16x32_bf16 v[232:235], a[32:35], a[124:127], v[232:235]
  buffer_store_dwordx4 v[156:159], v198, s[20:23], s53 offen offset:3072 sc1
  v_mfma_f32_16x16x32_bf16 v[236:239], a[36:39], a[124:127], v[236:239]
  ds_read_b64_tr_b16 a[20:21], v206 offset:20608
  ds_read_b64_tr_b16 a[22:23], v206 offset:25728
  v_mfma_f32_16x16x32_bf16 v[116:119], a[36:39], a[108:111], v[116:119]
  buffer_load_dwordx4 v193, s[64:67], s84 offen offset:1024 lds
  v_mfma_f32_16x16x32_bf16 v[76:79], a[36:39], a[92:95], v[76:79]
  s_waitcnt lgkmcnt(10)
  v_mfma_f32_16x16x32_bf16 v[40:43], a[0:3], v[144:147], v[40:43]
  ds_read_b64_tr_b16 a[24:25], v205 offset:20672
  ds_read_b64_tr_b16 a[26:27], v205 offset:25792
  v_mfma_f32_16x16x32_bf16 v[80:83], a[0:3], v[160:163], v[80:83]
  v_mfma_f32_16x16x32_bf16 v[120:123], a[0:3], v[176:179], v[120:123]
  s_waitcnt lgkmcnt(10)
  v_mfma_f32_16x16x32_bf16 v[124:127], a[4:7], v[176:179], v[124:127]
  ds_read_b64_tr_b16 a[28:29], v206 offset:20672
  ds_read_b64_tr_b16 a[30:31], v206 offset:25792
  v_mfma_f32_16x16x32_bf16 v[84:87], a[4:7], v[160:163], v[84:87]
  buffer_load_dwordx4 v194, s[64:67], s84 offen offset:2048 lds
  v_mfma_f32_16x16x32_bf16 v[44:47], a[4:7], v[144:147], v[44:47]
  s_waitcnt lgkmcnt(10)
  v_mfma_f32_16x16x32_bf16 v[48:51], a[8:11], v[144:147], v[48:51]
  ds_read_b64_tr_b16 a[32:33], v205 offset:20736
  ds_read_b64_tr_b16 a[34:35], v205 offset:25856
  v_mfma_f32_16x16x32_bf16 v[88:91], a[8:11], v[160:163], v[88:91]
  buffer_store_dwordx4 v[160:163], v199, s[20:23], s53 offen offset:0 sc1
  v_mfma_f32_16x16x32_bf16 v[208:211], a[8:11], v[176:179], v[208:211]
  s_waitcnt lgkmcnt(10)
  v_mfma_f32_16x16x32_bf16 v[212:215], a[12:15], v[176:179], v[212:215]
  ds_read_b64_tr_b16 a[36:37], v206 offset:20736
  ds_read_b64_tr_b16 a[38:39], v206 offset:25856
  v_mfma_f32_16x16x32_bf16 v[92:95], a[12:15], v[160:163], v[92:95]
  v_mfma_f32_16x16x32_bf16 v[52:55], a[12:15], v[144:147], v[52:55]
  s_waitcnt lgkmcnt(10)
  buffer_load_dwordx4 v195, s[64:67], s84 offen offset:3072 lds
  v_mfma_f32_16x16x32_bf16 v[56:59], a[16:19], v[144:147], v[56:59]
  ds_read_b64_tr_b16 a[0:1], v205 offset:30720
  ds_read_b64_tr_b16 a[2:3], v205 offset:35840
  v_mfma_f32_16x16x32_bf16 v[96:99], a[16:19], v[160:163], v[96:99]
  v_mfma_f32_16x16x32_bf16 v[216:219], a[16:19], v[176:179], v[216:219]
  s_waitcnt lgkmcnt(10)
  v_mfma_f32_16x16x32_bf16 v[220:223], a[20:23], v[176:179], v[220:223]
  ds_read_b64_tr_b16 a[4:5], v206 offset:30720
  ds_read_b64_tr_b16 a[6:7], v206 offset:35840
  v_mfma_f32_16x16x32_bf16 v[100:103], a[20:23], v[160:163], v[100:103]
  s_add_u32 m0, s100, 4096
  v_mfma_f32_16x16x32_bf16 v[60:63], a[20:23], v[144:147], v[60:63]
  s_waitcnt lgkmcnt(10)
  v_mfma_f32_16x16x32_bf16 v[64:67], a[24:27], v[144:147], v[64:67]
  ds_read_b64_tr_b16 a[8:9], v205 offset:30784
  ds_read_b64_tr_b16 a[10:11], v205 offset:35904
  v_mfma_f32_16x16x32_bf16 v[104:107], a[24:27], v[160:163], v[104:107]
  v_mfma_f32_16x16x32_bf16 v[224:227], a[24:27], v[176:179], v[224:227]
  s_waitcnt lgkmcnt(10)
  buffer_load_dwordx4 v196, s[64:67], s84 offen offset:0 lds
  v_mfma_f32_16x16x32_bf16 v[228:231], a[28:31], v[176:179], v[228:231]
  ds_read_b64_tr_b16 a[12:13], v206 offset:30784
  ds_read_b64_tr_b16 a[14:15], v206 offset:35904
  v_mfma_f32_16x16x32_bf16 v[108:111], a[28:31], v[160:163], v[108:111]
  s_add_u32 s84, s84, 81920
  v_mfma_f32_16x16x32_bf16 v[68:71], a[28:31], v[144:147], v[68:71]
  s_waitcnt lgkmcnt(10)
  v_mfma_f32_16x16x32_bf16 v[72:75], a[32:35], v[144:147], v[72:75]
  s_andn2_b32 s55, s18, s11
  s_cbranch_scc1 L_frch
L_frch_ret:
  ds_read_b64_tr_b16 a[16:17], v205 offset:30848
  ds_read_b64_tr_b16 a[18:19], v205 offset:35968
  v_mfma_f32_16x16x32_bf16 v[112:115], a[32:35], v[160:163], v[112:115]
  s_waitcnt vmcnt(9)
  buffer_store_dwordx4 v[164:167], v199, s[20:23], s53 offen offset:1024 sc1
  v_readlane_b32 s55, v252, s9
  v_mfma_f32_16x16x32_bf16 v[232:235], a[32:35], v[176:179], v[232:235]
  s_waitcnt lgkmcnt(10)
  v_mfma_f32_16x16x32_bf16 v[236:239], a[36:39], v[176:179], v[236:239]
  ds_read_b64_tr_b16 a[20:21], v206 offset:30848
  ds_read_b64_tr_b16 a[22:23], v206 offset:35968
  v_mfma_f32_16x16x32_bf16 v[116:119], a[36:39], v[160:163], v[116:119]
  s_or_b32 s55, s55, s10
  s_cbranch_scc0 L_spinh
L_spinh_ret:
  v_mfma_f32_16x16x32_bf16 v[76:79], a[36:39], v[144:147], v[76:79]
  s_waitcnt lgkmcnt(10)
  v_mfma_f32_16x16x32_bf16 v[40:43], a[0:3], v[148:151], v[40:43]
  ds_read_b64_tr_b16 a[24:25], v205 offset:30912
  ds_read_b64_tr_b16 a[26:27], v205 offset:36032
  v_mfma_f32_16x16x32_bf16 v[80:83], a[0:3], v[164:167], v[80:83]
  buffer_load_dwordx4 a[128:131], v197, s[20:23], s87 offen offset:0 sc1
  v_mfma_f32_16x16x32_bf16 v[120:123], a[0:3], v[180:183], v[120:123]
  s_waitcnt lgkmcnt(10)
  v_mfma_f32_16x16x32_bf16 v[124:127], a[4:7], v[180:183], v[124:127]
  ds_read_b64_tr_b16 a[28:29], v206 offset:30912
  ds_read_b64_tr_b16 a[30:31], v206 offset:36032
  v_mfma_f32_16x16x32_bf16 v[84:87], a[4:7], v[164:167], v[84:87]
  buffer_store_dwordx4 v[168:171], v199, s[20:23], s53 offen offset:2048 sc1
  v_mfma_f32_16x16x32_bf16 v[44:47], a[4:7], v[148:151], v[44:47]
  s_waitcnt lgkmcnt(10)
  v_mfma_f32_16x16x32_bf16 v[48:51], a[8:11], v[148:151], v[48:51]
  ds_read_b64_tr_b16 a[32:33], v205 offset:30976
  ds_read_b64_tr_b16 a[34:35], v205 offset:36096
  v_mfma_f32_16x16x32_bf16 v[88:91], a[8:11], v[164:167], v[88:91]
  buffer_load_dwordx4 a[132:135], v198, s[20:23], s87 offen offset:0 sc1
  v_mfma_f32_16x16x32_bf16 v[208:211], a[8:11], v[180:183], v[208:211]
  s_waitcnt lgkmcnt(10)
  v_mfma_f32_16x16x32_bf16 v[212:215], a[12:15], v[180:183], v[212:215]
  ds_read_b64_tr_b16 a[36:37], v206 offset:30976
  ds_read_b64_tr_b16 a[38:39], v206 offset:36096
  v_mfma_f32_16x16x32_bf16 v[92:95], a[12:15], v[164:167], v[92:95]
  buffer_store_dwordx4 v[172:175], v199, s[20:23], s53 offen offset:3072 sc1
  v_mfma_f32_16x16x32_bf16 v[52:55], a[12:15], v[148:151], v[52:55]
  s_waitcnt lgkmcnt(10)
  v_readfirstlane_b32 s15, v248
  v_mfma_f32_16x16x32_bf16 v[56:59], a[16:19], v[148:151], v[56:59]
  s_nop 0
  v_mov_b32 v245, s15
  v_mfma_f32_16x16x32_bf16 v[96:99], a[16:19], v[164:167], v[96:99]
  buffer_load_dwordx4 a[136:139], v199, s[20:23], s87 offen offset:0 sc1
  v_mfma_f32_16x16x32_bf16 v[216:219], a[16:19], v[180:183], v[216:219]
  s_waitcnt lgkmcnt(8)
  ds_write_b32 v250, v245 offset:0
  v_mfma_f32_16x16x32_bf16 v[220:223], a[20:23], v[180:183], v[220:223]
  s_waitcnt vmcnt(22) lgkmcnt(0)
  v_mfma_f32_16x16x32_bf16 v[100:103], a[20:23], v[164:167], v[100:103]
  s_barrier
  v_mfma_f32_16x16x32_bf16 v[60:63], a[20:23], v[148:151], v[60:63]
  ds_read_b32 v246, v251 offset:0
  ds_read_b64_tr_b16 a[0:1], v205 offset:40960
  ds_read_b64_tr_b16 a[2:3], v205 offset:46080
  v_mfma_f32_16x16x32_bf16 v[64:67], a[24:27], v[148:151], v[64:67]
  s_add_u32 m0, s100, 20480
  v_mfma_f32_16x16x32_bf16 v[104:107], a[24:27], v[164:167], v[104:107]
  ds_read_b64_tr_b16 a[4:5], v206 offset:40960
  ds_read_b64_tr_b16 a[6:7], v206 offset:46080
  v_mfma_f32_16x16x32_bf16 v[224:227], a[24:27], v[180:183], v[224:227]
  buffer_load_dwordx4 v192, s[64:67], s84 offen offset:0 lds
  v_mfma_f32_16x16x32_bf16 v[228:231], a[28:31], v[180:183], v[228:231]
  ds_read_b64_tr_b16 a[8:9], v205 offset:41024
  ds_read_b64_tr_b16 a[10:11], v205 offset:46144
  v_mfma_f32_16x16x32_bf16 v[108:111], a[28:31], v[164:167], v[108:111]
  v_mfma_f32_16x16x32_bf16 v[68:71], a[28:31], v[148:151], v[68:71]
  ds_read_b64_tr_b16 a[12:13], v206 offset:41024
  ds_read_b64_tr_b16 a[14:15], v206 offset:46144
  v_mfma_f32_16x16x32_bf16 v[72:75], a[32:35], v[148:151], v[72:75]
  v_mfma_f32_16x16x32_bf16 v[112:115], a[32:35], v[164:167], v[112:115]
  ds_read_b64_tr_b16 a[16:17], v205 offset:41088
  ds_read_b64_tr_b16 a[18:19], v205 offset:46208
  v_mfma_f32_16x16x32_bf16 v[232:235], a[32:35], v[180:183], v[232:235]
  buffer_load_dwordx4 a[140:143], v200, s[20:23], s87 offen offset:0 sc1
  v_mfma_f32_16x16x32_bf16 v[236:239], a[36:39], v[180:183], v[236:239]
  ds_read_b64_tr_b16 a[20:21], v206 offset:41088
  ds_read_b64_tr_b16 a[22:23], v206 offset:46208
  v_mfma_f32_16x16x32_bf16 v[116:119], a[36:39], v[164:167], v[116:119]
  buffer_load_dwordx4 v193, s[64:67], s84 offen offset:1024 lds
  v_mfma_f32_16x16x32_bf16 v[76:79], a[36:39], v[148:151], v[76:79]
  s_waitcnt lgkmcnt(10)
  s_waitcnt lgkmcnt(12)
  v_readfirstlane_b32 s4, v246
  v_mfma_f32_16x16x32_bf16 v[40:43], a[0:3], v[152:155], v[40:43]
  s_bfe_u32 s19, s4, s5
  ds_read_b64_tr_b16 a[24:25], v205 offset:41152
  ds_read_b64_tr_b16 a[26:27], v205 offset:46272
  v_mfma_f32_16x16x32_bf16 v[80:83], a[0:3], v[168:171], v[80:83]
  s_cmp_lt_u32 s19, 6
  s_cselect_b32 s13, s6, 0
  buffer_load_dwordx4 a[144:147], v197, s[20:23], s87 offen offset:1024 sc1
  v_mfma_f32_16x16x32_bf16 v[120:123], a[0:3], v[184:187], v[120:123]
  s_waitcnt lgkmcnt(10)
  s_mov_b32 s26, s5
  s_lshl_b32 s15, 1, s5
  s_add_u32 s4, s4, s15
  v_mfma_f32_16x16x32_bf16 v[124:127], a[4:7], v[184:187], v[124:127]
  s_lshl_b32 s17, s82, 3
  ds_read_b64_tr_b16 a[28:29], v206 offset:41152
  ds_read_b64_tr_b16 a[30:31], v206 offset:46272
  v_mfma_f32_16x16x32_bf16 v[84:87], a[4:7], v[168:171], v[84:87]
  s_or_b32 s17, s17, 0x80000
  s_xor_b32 s5, s17, 8
  buffer_load_dwordx4 v194, s[64:67], s84 offen offset:2048 lds
  v_mfma_f32_16x16x32_bf16 v[44:47], a[4:7], v[152:155], v[44:47]
  s_waitcnt lgkmcnt(10)
  s_bfe_u32 s16, s4, s5
  s_xor_b32 s56, s17, 16
  s_bfe_u32 s15, s4, s56
  v_mfma_f32_16x16x32_bf16 v[48:51], a[8:11], v[152:155], v[48:51]
  ds_read_b64_tr_b16 a[32:33], v205 offset:41216
  ds_read_b64_tr_b16 a[34:35], v205 offset:46336
  v_mfma_f32_16x16x32_bf16 v[88:91], a[8:11], v[168:171], v[88:91]
  buffer_load_dwordx4 a[148:151], v198, s[20:23], s87 offen offset:1024 sc1
  v_mfma_f32_16x16x32_bf16 v[208:211], a[8:11], v[184:187], v[208:211]
  s_waitcnt lgkmcnt(10)
  buffer_store_dwordx4 v[176:179], v200, s[20:23], s53 offen offset:0 sc1
  v_mfma_f32_16x16x32_bf16 v[212:215], a[12:15], v[184:187], v[212:215]
  ds_read_b64_tr_b16 a[36:37], v206 offset:41216
  ds_read_b64_tr_b16 a[38:39], v206 offset:46336
  v_mfma_f32_16x16x32_bf16 v[92:95], a[12:15], v[168:171], v[92:95]
  s_cmp_lt_u32 s15, s16
  s_cselect_b32 s5, s56, s5
  s_cselect_b32 s16, s15, s16
  v_mfma_f32_16x16x32_bf16 v[52:55], a[12:15], v[152:155], v[52:55]
  s_waitcnt lgkmcnt(10)
  s_xor_b32 s56, s17, 24
  s_bfe_u32 s15, s4, s56
  buffer_load_dwordx4 v195, s[64:67], s84 offen offset:3072 lds
  v_mfma_f32_16x16x32_bf16 v[56:59], a[16:19], v[152:155], v[56:59]
  ds_read_b64_tr_b16 a[0:1], v205 offset:51200
  ds_read_b64_tr_b16 a[2:3], v205 offset:56320
  v_mfma_f32_16x16x32_bf16 v[96:99], a[16:19], v[168:171], v[96:99]
  buffer_load_dwordx4 a[152:155], v199, s[20:23], s87 offen offset:1024 sc1
  v_mfma_f32_16x16x32_bf16 v[216:219], a[16:19], v[184:187], v[216:219]
  s_waitcnt lgkmcnt(10)
  s_cmp_lt_u32 s15, s16
  s_cselect_b32 s5, s56, s5
  s_cselect_b32 s16, s15, s16
  v_mfma_f32_16x16x32_bf16 v[220:223], a[20:23], v[184:187], v[220:223]
  s_bfe_u32 s15, s4, s17
  ds_read_b64_tr_b16 a[4:5], v206 offset:51200
  ds_read_b64_tr_b16 a[6:7], v206 offset:56320
  v_mfma_f32_16x16x32_bf16 v[100:103], a[20:23], v[168:171], v[100:103]
  s_add_u32 m0, s100, 24576
  v_mfma_f32_16x16x32_bf16 v[60:63], a[20:23], v[152:155], v[60:63]
  s_waitcnt lgkmcnt(10)
  s_cmp_lt_u32 s15, 6
  s_cselect_b32 s5, s17, s5
  s_cselect_b32 s16, s15, s16
  v_mfma_f32_16x16x32_bf16 v[64:67], a[24:27], v[152:155], v[64:67]
  ds_read_b64_tr_b16 a[8:9], v205 offset:51264
  ds_read_b64_tr_b16 a[10:11], v205 offset:56384
  v_mfma_f32_16x16x32_bf16 v[104:107], a[24:27], v[168:171], v[104:107]
  s_cmp_lt_u32 s16, 6
  s_cselect_b32 s6, s13, 0
  s_mov_b32 s15, 15488
  v_mfma_f32_16x16x32_bf16 v[224:227], a[24:27], v[184:187], v[224:227]
  s_waitcnt lgkmcnt(10)
  s_cmp_lg_u32 s6, 0
  s_cselect_b32 s7, s15, 0x40000000
  buffer_load_dwordx4 v196, s[64:67], s84 offen offset:0 lds
  v_mfma_f32_16x16x32_bf16 v[228:231], a[28:31], v[184:187], v[228:231]
  s_lshl_b32 s15, 1, s5
  ds_read_b64_tr_b16 a[12:13], v206 offset:51264
  ds_read_b64_tr_b16 a[14:15], v206 offset:56384
  v_mfma_f32_16x16x32_bf16 v[108:111], a[28:31], v[168:171], v[108:111]
  s_add_u32 s84, s84, 81920
  v_mov_b32 v248, s15
  v_mfma_f32_16x16x32_bf16 v[68:71], a[28:31], v[152:155], v[68:71]
  s_waitcnt lgkmcnt(10)
  buffer_store_dwordx4 v[180:183], v200, s[20:23], s53 offen offset:1024 sc1
  buffer_atomic_add v248, v249, s[60:63], s7 offen sc0 sc1
  v_mfma_f32_16x16x32_bf16 v[72:75], a[32:35], v[152:155], v[72:75]
  ds_read_b64_tr_b16 a[16:17], v205 offset:51328
  ds_read_b64_tr_b16 a[18:19], v205 offset:56448
  buffer_load_dword v252, v207, s[36:39], 0 offen sc1
  v_mfma_f32_16x16x32_bf16 v[112:115], a[32:35], v[168:171], v[112:115]
  buffer_load_dwordx4 a[156:159], v200, s[20:23], s87 offen offset:1024 sc1
  v_mfma_f32_16x16x32_bf16 v[232:235], a[32:35], v[184:187], v[232:235]
  s_waitcnt lgkmcnt(10)
  v_mfma_f32_16x16x32_bf16 v[236:239], a[36:39], v[184:187], v[236:239]
  ds_read_b64_tr_b16 a[20:21], v206 offset:51328
  ds_read_b64_tr_b16 a[22:23], v206 offset:56448
  v_mfma_f32_16x16x32_bf16 v[116:119], a[36:39], v[168:171], v[116:119]
  v_mfma_f32_16x16x32_bf16 v[76:79], a[36:39], v[152:155], v[76:79]
  s_waitcnt lgkmcnt(10)
  v_mfma_f32_16x16x32_bf16 v[40:43], a[0:3], v[156:159], v[40:43]
  ds_read_b64_tr_b16 a[24:25], v205 offset:51392
  ds_read_b64_tr_b16 a[26:27], v205 offset:56512
  v_mfma_f32_16x16x32_bf16 v[80:83], a[0:3], v[172:175], v[80:83]
  s_cmp_ge_u32 s19, 3
  s_cselect_b32 s18, 1, 0
  buffer_load_dwordx4 a[160:163], v197, s[20:23], s87 offen offset:2048 sc1
  v_mfma_f32_16x16x32_bf16 v[120:123], a[0:3], v[188:191], v[120:123]
  s_waitcnt lgkmcnt(10)
  s_mul_i32 s15, s18, 3
  s_sub_u32 s15, s19, s15
  v_mfma_f32_16x16x32_bf16 v[124:127], a[4:7], v[188:191], v[124:127]
  ds_read_b64_tr_b16 a[28:29], v206 offset:51392
  ds_read_b64_tr_b16 a[30:31], v206 offset:56512
  v_mfma_f32_16x16x32_bf16 v[84:87], a[4:7], v[172:175], v[84:87]
  s_cmp_ge_u32 s15, s8
  s_addc_u32 s15, s15, 0
  buffer_store_dwordx4 v[184:187], v200, s[20:23], s53 offen offset:2048 sc1
  v_mfma_f32_16x16x32_bf16 v[44:47], a[4:7], v[156:159], v[44:47]
  s_waitcnt lgkmcnt(10)
  s_and_b32 s15, s15, 3
  s_bfe_u32 s9, s26, 0x20003
  s_lshl2_add_u32 s15, s9, s15
  v_mfma_f32_16x16x32_bf16 v[48:51], a[8:11], v[156:159], v[48:51]
  s_lshl4_add_u32 s9, s18, s15
  ds_read_b64_tr_b16 a[32:33], v205 offset:51456
  ds_read_b64_tr_b16 a[34:35], v205 offset:56576
  v_mfma_f32_16x16x32_bf16 v[88:91], a[8:11], v[172:175], v[88:91]
  s_lshl_b32 s88, s9, 12
  s_lshl1_add_u32 s15, s15, s18
  buffer_load_dwordx4 a[164:167], v198, s[20:23], s87 offen offset:2048 sc1
  v_mfma_f32_16x16x32_bf16 v[208:211], a[8:11], v[188:191], v[208:211]
  s_waitcnt lgkmcnt(10)
  s_lshl3_add_u32 s15, s15, s24
  s_mul_i32 s85, s15, 20480
  s_xor_b32 s10, s13, 1
  v_mfma_f32_16x16x32_bf16 v[212:215], a[12:15], v[188:191], v[212:215]
  s_and_b32 s18, s18, s13
  ds_read_b64_tr_b16 a[36:37], v206 offset:51456
  ds_read_b64_tr_b16 a[38:39], v206 offset:56576
  v_mfma_f32_16x16x32_bf16 v[92:95], a[12:15], v[172:175], v[92:95]
  buffer_store_dwordx4 v[188:191], v200, s[20:23], s53 offen offset:3072 sc1
  v_mfma_f32_16x16x32_bf16 v[52:55], a[12:15], v[156:159], v[52:55]
  s_waitcnt lgkmcnt(10)
  s_cmp_eq_u32 s13, 0
  s_cselect_b32 s85, 0x40000000, s85
  s_cselect_b32 s88, 0x40000000, s88
  v_mfma_f32_16x16x32_bf16 v[56:59], a[16:19], v[156:159], v[56:59]
  v_mfma_f32_16x16x32_bf16 v[96:99], a[16:19], v[172:175], v[96:99]
  buffer_load_dwordx4 a[168:171], v199, s[20:23], s87 offen offset:2048 sc1
  v_mfma_f32_16x16x32_bf16 v[216:219], a[16:19], v[188:191], v[216:219]
  s_waitcnt lgkmcnt(8)
  v_mfma_f32_16x16x32_bf16 v[220:223], a[20:23], v[188:191], v[220:223]
  s_waitcnt vmcnt(25) lgkmcnt(0)
  v_mfma_f32_16x16x32_bf16 v[100:103], a[20:23], v[172:175], v[100:103]
  s_barrier
  v_mfma_f32_16x16x32_bf16 v[60:63], a[20:23], v[156:159], v[60:63]
  ds_read_b64_tr_b16 a[0:1], v201 offset:0
  ds_read_b64_tr_b16 a[2:3], v201 offset:5120
  v_mfma_f32_16x16x32_bf16 v[64:67], a[24:27], v[156:159], v[64:67]
  s_add_u32 m0, s100, 40960
  v_mfma_f32_16x16x32_bf16 v[104:107], a[24:27], v[172:175], v[104:107]
  ds_read_b64_tr_b16 a[4:5], v202 offset:0
  ds_read_b64_tr_b16 a[6:7], v202 offset:5120
  v_mfma_f32_16x16x32_bf16 v[224:227], a[24:27], v[188:191], v[224:227]
  buffer_load_dwordx4 v192, s[64:67], s85 offen offset:0 lds
  v_mfma_f32_16x16x32_bf16 v[228:231], a[28:31], v[188:191], v[228:231]
  ds_read_b64_tr_b16 a[8:9], v201 offset:64
  ds_read_b64_tr_b16 a[10:11], v201 offset:5184
  v_mfma_f32_16x16x32_bf16 v[108:111], a[28:31], v[172:175], v[108:111]
  v_mfma_f32_16x16x32_bf16 v[68:71], a[28:31], v[156:159], v[68:71]
  ds_read_b64_tr_b16 a[12:13], v202 offset:64
  ds_read_b64_tr_b16 a[14:15], v202 offset:5184
  v_mfma_f32_16x16x32_bf16 v[72:75], a[32:35], v[156:159], v[72:75]
  v_mfma_f32_16x16x32_bf16 v[112:115], a[32:35], v[172:175], v[112:115]
  ds_read_b64_tr_b16 a[16:17], v201 offset:128
  ds_read_b64_tr_b16 a[18:19], v201 offset:5248
  v_mfma_f32_16x16x32_bf16 v[232:235], a[32:35], v[188:191], v[232:235]
  buffer_load_dwordx4 a[172:175], v200, s[20:23], s87 offen offset:2048 sc1
  v_mfma_f32_16x16x32_bf16 v[236:239], a[36:39], v[188:191], v[236:239]
  ds_read_b64_tr_b16 a[20:21], v202 offset:128
  ds_read_b64_tr_b16 a[22:23], v202 offset:5248
  v_mfma_f32_16x16x32_bf16 v[116:119], a[36:39], v[172:175], v[116:119]
  s_waitcnt vmcnt(19)
  buffer_load_dwordx4 v193, s[64:67], s85 offen offset:1024 lds
  v_mfma_f32_16x16x32_bf16 v[76:79], a[36:39], v[156:159], v[76:79]
  s_cmp_eq_u32 s12, 0
  s_cbranch_scc1 L_oexit
.p2align 6
L_oloop:
  s_waitcnt lgkmcnt(10)
  v_mfma_f32_16x16x32_bf16 v[0:3], a[0:3], a[128:131], v[0:3]
  ds_read_b64_tr_b16 a[24:25], v201 offset:192
  ds_read_b64_tr_b16 a[26:27], v201 offset:5312
  v_mfma_f32_16x16x32_bf16 v[40:43], a[0:3], a[132:135], v[40:43]
  v_mfma_f32_16x16x32_bf16 v[80:83], a[0:3], a[136:139], v[80:83]
  buffer_load_dwordx4 a[176:179], v197, s[20:23], s87 offen offset:3072 sc1
  v_mfma_f32_16x16x32_bf16 v[120:123], a[0:3], a[140:143], v[120:123]
  s_waitcnt lgkmcnt(10)
  v_mfma_f32_16x16x32_bf16 v[124:127], a[4:7], a[140:143], v[124:127]
  ds_read_b64_tr_b16 a[28:29], v202 offset:192
  ds_read_b64_tr_b16 a[30:31], v202 offset:5312
  v_mfma_f32_16x16x32_bf16 v[84:87], a[4:7], a[136:139], v[84:87]
  buffer_load_dwordx4 v194, s[64:67], s85 offen offset:2048 lds
  v_mfma_f32_16x16x32_bf16 v[44:47], a[4:7], a[132:135], v[44:47]
  v_mfma_f32_16x16x32_bf16 v[4:7], a[4:7], a[128:131], v[4:7]
  s_waitcnt lgkmcnt(10)
  v_mfma_f32_16x16x32_bf16 v[8:11], a[8:11], a[128:131], v[8:11]
  ds_read_b64_tr_b16 a[32:33], v201 offset:256
  ds_read_b64_tr_b16 a[34:35], v201 offset:5376
  v_mfma_f32_16x16x32_bf16 v[48:51], a[8:11], a[132:135], v[48:51]
  v_mfma_f32_16x16x32_bf16 v[88:91], a[8:11], a[136:139], v[88:91]
  buffer_load_dwordx4 a[180:183], v198, s[20:23], s87 offen offset:3072 sc1
  v_mfma_f32_16x16x32_bf16 v[208:211], a[8:11], a[140:143], v[208:211]
  s_waitcnt lgkmcnt(10)
  v_mfma_f32_16x16x32_bf16 v[212:215], a[12:15], a[140:143], v[212:215]
  ds_read_b64_tr_b16 a[36:37], v202 offset:256
  ds_read_b64_tr_b16 a[38:39], v202 offset:5376
  v_mfma_f32_16x16x32_bf16 v[92:95], a[12:15], a[136:139], v[92:95]
  v_mfma_f32_16x16x32_bf16 v[52:55], a[12:15], a[132:135], v[52:55]
  v_mfma_f32_16x16x32_bf16 v[12:15], a[12:15], a[128:131], v[12:15]
  s_waitcnt lgkmcnt(10)
  buffer_load_dwordx4 v195, s[64:67], s85 offen offset:3072 lds
  v_mfma_f32_16x16x32_bf16 v[16:19], a[16:19], a[128:131], v[16:19]
  ds_read_b64_tr_b16 a[0:1], v201 offset:10240
  ds_read_b64_tr_b16 a[2:3], v201 offset:15360
  v_mfma_f32_16x16x32_bf16 v[56:59], a[16:19], a[132:135], v[56:59]
  v_mfma_f32_16x16x32_bf16 v[96:99], a[16:19], a[136:139], v[96:99]
  buffer_load_dwordx4 a[184:187], v199, s[20:23], s87 offen offset:3072 sc1
  v_mfma_f32_16x16x32_bf16 v[216:219], a[16:19], a[140:143], v[216:219]
  s_waitcnt lgkmcnt(10)
  v_mfma_f32_16x16x32_bf16 v[220:223], a[20:23], a[140:143], v[220:223]
  ds_read_b64_tr_b16 a[4:5], v202 offset:10240
  ds_read_b64_tr_b16 a[6:7], v202 offset:15360
  v_mfma_f32_16x16x32_bf16 v[100:103], a[20:23], a[136:139], v[100:103]
  s_add_u32 m0, s100, 45056
  v_mfma_f32_16x16x32_bf16 v[60:63], a[20:23], a[132:135], v[60:63]
  v_mfma_f32_16x16x32_bf16 v[20:23], a[20:23], a[128:131], v[20:23]
  s_waitcnt lgkmcnt(10)
  v_mfma_f32_16x16x32_bf16 v[24:27], a[24:27], a[128:131], v[24:27]
  ds_read_b64_tr_b16 a[8:9], v201 offset:10304
  ds_read_b64_tr_b16 a[10:11], v201 offset:15424
  v_mfma_f32_16x16x32_bf16 v[64:67], a[24:27], a[132:135], v[64:67]
  v_mfma_f32_16x16x32_bf16 v[104:107], a[24:27], a[136:139], v[104:107]
  v_mfma_f32_16x16x32_bf16 v[224:227], a[24:27], a[140:143], v[224:227]
  s_waitcnt lgkmcnt(10)
  buffer_load_dwordx4 v196, s[64:67], s85 offen offset:0 lds
  v_mfma_f32_16x16x32_bf16 v[228:231], a[28:31], a[140:143], v[228:231]
  ds_read_b64_tr_b16 a[12:13], v202 offset:10304
  ds_read_b64_tr_b16 a[14:15], v202 offset:15424
  v_mfma_f32_16x16x32_bf16 v[108:111], a[28:31], a[136:139], v[108:111]
  s_add_u32 s85, s85, 81920
  v_mfma_f32_16x16x32_bf16 v[68:71], a[28:31], a[132:135], v[68:71]
  v_mfma_f32_16x16x32_bf16 v[28:31], a[28:31], a[128:131], v[28:31]
  s_waitcnt lgkmcnt(10)
  buffer_load_dwordx4 a[188:191], v200, s[20:23], s87 offen offset:3072 sc1
  v_mfma_f32_16x16x32_bf16 v[32:35], a[32:35], a[128:131], v[32:35]
  ds_read_b64_tr_b16 a[16:17], v201 offset:10368
  ds_read_b64_tr_b16 a[18:19], v201 offset:15488
  v_mfma_f32_16x16x32_bf16 v[72:75], a[32:35], a[132:135], v[72:75]
  v_mfma_f32_16x16x32_bf16 v[112:115], a[32:35], a[136:139], v[112:115]
  s_andn2_b32 s55, s18, s11
  s_cbranch_scc1 L_frc0
L_frc0_ret:
  v_mfma_f32_16x16x32_bf16 v[232:235], a[32:35], a[140:143], v[232:235]
  s_waitcnt lgkmcnt(10)
  s_waitcnt vmcnt(13)
  v_readlane_b32 s55, v252, s9
  v_mfma_f32_16x16x32_bf16 v[236:239], a[36:39], a[140:143], v[236:239]
  ds_read_b64_tr_b16 a[20:21], v202 offset:10368
  ds_read_b64_tr_b16 a[22:23], v202 offset:15488
  v_mfma_f32_16x16x32_bf16 v[116:119], a[36:39], a[136:139], v[116:119]
  v_mfma_f32_16x16x32_bf16 v[76:79], a[36:39], a[132:135], v[76:79]
  s_or_b32 s55, s55, s10
  s_cbranch_scc0 L_spin0
L_spin0_ret:
  v_mfma_f32_16x16x32_bf16 v[36:39], a[36:39], a[128:131], v[36:39]
  s_waitcnt lgkmcnt(10)
  v_mfma_f32_16x16x32_bf16 v[0:3], a[0:3], a[144:147], v[0:3]
  ds_read_b64_tr_b16 a[24:25], v201 offset:10432
  ds_read_b64_tr_b16 a[26:27], v201 offset:15552
  v_mfma_f32_16x16x32_bf16 v[40:43], a[0:3], a[148:151], v[40:43]
  v_mfma_f32_16x16x32_bf16 v[80:83], a[0:3], a[152:155], v[80:83]
  buffer_load_dwordx4 a[128:131], v197, s[20:23], s88 offen offset:0 sc1
  v_mfma_f32_16x16x32_bf16 v[120:123], a[0:3], a[156:159], v[120:123]
  s_waitcnt lgkmcnt(10)
  v_mfma_f32_16x16x32_bf16 v[124:127], a[4:7], a[156:159], v[124:127]
  ds_read_b64_tr_b16 a[28:29], v202 offset:10432
  ds_read_b64_tr_b16 a[30:31], v202 offset:15552
  v_mfma_f32_16x16x32_bf16 v[84:87], a[4:7], a[152:155], v[84:87]
  v_mfma_f32_16x16x32_bf16 v[44:47], a[4:7], a[148:151], v[44:47]
  v_mfma_f32_16x16x32_bf16 v[4:7], a[4:7], a[144:147], v[4:7]
  s_waitcnt lgkmcnt(10)
  v_mfma_f32_16x16x32_bf16 v[8:11], a[8:11], a[144:147], v[8:11]
  ds_read_b64_tr_b16 a[32:33], v201 offset:10496
  ds_read_b64_tr_b16 a[34:35], v201 offset:15616
  v_mfma_f32_16x16x32_bf16 v[48:51], a[8:11], a[148:151], v[48:51]
  v_mfma_f32_16x16x32_bf16 v[88:91], a[8:11], a[152:155], v[88:91]
  buffer_load_dwordx4 a[132:135], v198, s[20:23], s88 offen offset:0 sc1
  v_mfma_f32_16x16x32_bf16 v[208:211], a[8:11], a[156:159], v[208:211]
  s_waitcnt lgkmcnt(10)
  v_mfma_f32_16x16x32_bf16 v[212:215], a[12:15], a[156:159], v[212:215]
  ds_read_b64_tr_b16 a[36:37], v202 offset:10496
  ds_read_b64_tr_b16 a[38:39], v202 offset:15616
  v_mfma_f32_16x16x32_bf16 v[92:95], a[12:15], a[152:155], v[92:95]
  v_mfma_f32_16x16x32_bf16 v[52:55], a[12:15], a[148:151], v[52:55]
  v_mfma_f32_16x16x32_bf16 v[12:15], a[12:15], a[144:147], v[12:15]
  s_waitcnt lgkmcnt(10)
  v_mfma_f32_16x16x32_bf16 v[16:19], a[16:19], a[144:147], v[16:19]
  v_readfirstlane_b32 s15, v248
  v_mfma_f32_16x16x32_bf16 v[56:59], a[16:19], a[148:151], v[56:59]
  s_nop 0
  v_mov_b32 v245, s15
  v_mfma_f32_16x16x32_bf16 v[96:99], a[16:19], a[152:155], v[96:99]
  buffer_load_dwordx4 a[136:139], v199, s[20:23], s88 offen offset:0 sc1
  v_mfma_f32_16x16x32_bf16 v[216:219], a[16:19], a[156:159], v[216:219]
  s_waitcnt lgkmcnt(8)
  ds_write_b32 v250, v245 offset:0
  v_mfma_f32_16x16x32_bf16 v[220:223], a[20:23], a[156:159], v[220:223]
  s_waitcnt vmcnt(19) lgkmcnt(0)
  v_mfma_f32_16x16x32_bf16 v[100:103], a[20:23], a[152:155], v[100:103]
  s_barrier
  v_mfma_f32_16x16x32_bf16 v[60:63], a[20:23], a[148:151], v[60:63]
  ds_read_b32 v246, v251 offset:0
  ds_read_b64_tr_b16 a[0:1], v201 offset:20480
  ds_read_b64_tr_b16 a[2:3], v201 offset:25600
  v_mfma_f32_16x16x32_bf16 v[20:23], a[20:23], a[144:147], v[20:23]
  s_add_u32 m0, s100, 0
  v_mfma_f32_16x16x32_bf16 v[24:27], a[24:27], a[144:147], v[24:27]
  ds_read_b64_tr_b16 a[4:5], v202 offset:20480
  ds_read_b64_tr_b16 a[6:7], v202 offset:25600
  v_mfma_f32_16x16x32_bf16 v[64:67], a[24:27], a[148:151], v[64:67]
  buffer_load_dwordx4 v192, s[64:67], s85 offen offset:0 lds
  v_mfma_f32_16x16x32_bf16 v[104:107], a[24:27], a[152:155], v[104:107]
  ds_read_b64_tr_b16 a[8:9], v201 offset:20544
  ds_read_b64_tr_b16 a[10:11], v201 offset:25664
  v_mfma_f32_16x16x32_bf16 v[224:227], a[24:27], a[156:159], v[224:227]
  v_mfma_f32_16x16x32_bf16 v[228:231], a[28:31], a[156:159], v[228:231]
  ds_read_b64_tr_b16 a[12:13], v202 offset:20544
  ds_read_b64_tr_b16 a[14:15], v202 offset:25664
  v_mfma_f32_16x16x32_bf16 v[108:111], a[28:31], a[152:155], v[108:111]
  v_mfma_f32_16x16x32_bf16 v[68:71], a[28:31], a[148:151], v[68:71]
  ds_read_b64_tr_b16 a[16:17], v201 offset:20608
  ds_read_b64_tr_b16 a[18:19], v201 offset:25728
  v_mfma_f32_16x16x32_bf16 v[28:31], a[28:31], a[144:147], v[28:31]
  buffer_load_dwordx4 a[140:143], v200, s[20:23], s88 offen offset:0 sc1
  v_mfma_f32_16x16x32_bf16 v[32:35], a[32:35], a[144:147], v[32:35]
  ds_read_b64_tr_b16 a[20:21], v202 offset:20608
  ds_read_b64_tr_b16 a[22:23], v202 offset:25728
  v_mfma_f32_16x16x32_bf16 v[72:75], a[32:35], a[148:151], v[72:75]
  v_mfma_f32_16x16x32_bf16 v[112:115], a[32:35], a[152:155], v[112:115]
  v_mfma_f32_16x16x32_bf16 v[232:235], a[32:35], a[156:159], v[232:235]
  buffer_load_dwordx4 v193, s[64:67], s85 offen offset:1024 lds
  v_mfma_f32_16x16x32_bf16 v[236:239], a[36:39], a[156:159], v[236:239]
  v_mfma_f32_16x16x32_bf16 v[116:119], a[36:39], a[152:155], v[116:119]
  v_mfma_f32_16x16x32_bf16 v[76:79], a[36:39], a[148:151], v[76:79]
  s_waitcnt vmcnt(14)
  v_mfma_f32_16x16x32_bf16 v[36:39], a[36:39], a[144:147], v[36:39]
  s_waitcnt lgkmcnt(10)
  s_waitcnt lgkmcnt(12)
  v_readfirstlane_b32 s4, v246
  v_mfma_f32_16x16x32_bf16 v[0:3], a[0:3], a[160:163], v[0:3]
  s_bfe_u32 s19, s4, s5
  ds_read_b64_tr_b16 a[24:25], v201 offset:20672
  ds_read_b64_tr_b16 a[26:27], v201 offset:25792
  v_mfma_f32_16x16x32_bf16 v[40:43], a[0:3], a[164:167], v[40:43]
  s_cmp_lt_u32 s19, 6
  s_cselect_b32 s14, s6, 0
  s_mov_b32 s26, s5
  v_mfma_f32_16x16x32_bf16 v[80:83], a[0:3], a[168:171], v[80:83]
  s_lshl_b32 s15, 1, s5
  s_add_u32 s4, s4, s15
  buffer_load_dwordx4 a[144:147], v197, s[20:23], s88 offen offset:1024 sc1
  v_mfma_f32_16x16x32_bf16 v[120:123], a[0:3], a[172:175], v[120:123]
  s_waitcnt lgkmcnt(10)
  s_lshl_b32 s17, s82, 3
  s_or_b32 s17, s17, 0x80000
  s_xor_b32 s5, s17, 8
  v_mfma_f32_16x16x32_bf16 v[124:127], a[4:7], a[172:175], v[124:127]
  s_bfe_u32 s16, s4, s5
  ds_read_b64_tr_b16 a[28:29], v202 offset:20672
  ds_read_b64_tr_b16 a[30:31], v202 offset:25792
  v_mfma_f32_16x16x32_bf16 v[84:87], a[4:7], a[168:171], v[84:87]
  s_xor_b32 s56, s17, 16
  s_bfe_u32 s15, s4, s56
  buffer_load_dwordx4 v194, s[64:67], s85 offen offset:2048 lds
  v_mfma_f32_16x16x32_bf16 v[44:47], a[4:7], a[164:167], v[44:47]
  s_cmp_lt_u32 s15, s16
  s_cselect_b32 s5, s56, s5
  s_cselect_b32 s16, s15, s16
  v_mfma_f32_16x16x32_bf16 v[4:7], a[4:7], a[160:163], v[4:7]
  s_waitcnt lgkmcnt(10)
  s_xor_b32 s56, s17, 24
  s_bfe_u32 s15, s4, s56
  v_mfma_f32_16x16x32_bf16 v[8:11], a[8:11], a[160:163], v[8:11]
  ds_read_b64_tr_b16 a[32:33], v201 offset:20736
  ds_read_b64_tr_b16 a[34:35], v201 offset:25856
  v_mfma_f32_16x16x32_bf16 v[48:51], a[8:11], a[164:167], v[48:51]
  s_cmp_lt_u32 s15, s16
  s_cselect_b32 s5, s56, s5
  s_cselect_b32 s16, s15, s16
  v_mfma_f32_16x16x32_bf16 v[88:91], a[8:11], a[168:171], v[88:91]
  s_bfe_u32 s15, s4, s17
  buffer_load_dwordx4 a[148:151], v198, s[20:23], s88 offen offset:1024 sc1
  v_mfma_f32_16x16x32_bf16 v[208:211], a[8:11], a[172:175], v[208:211]
  s_waitcnt lgkmcnt(10)
  s_cmp_lt_u32 s15, 6
  s_cselect_b32 s5, s17, s5
  s_cselect_b32 s16, s15, s16
  v_mfma_f32_16x16x32_bf16 v[212:215], a[12:15], a[172:175], v[212:215]
  ds_read_b64_tr_b16 a[36:37], v202 offset:20736
  ds_read_b64_tr_b16 a[38:39], v202 offset:25856
  v_mfma_f32_16x16x32_bf16 v[92:95], a[12:15], a[168:171], v[92:95]
  s_cmp_lt_u32 s16, 6
  s_cselect_b32 s6, s14, 0
  s_mov_b32 s15, 15488
  v_mfma_f32_16x16x32_bf16 v[52:55], a[12:15], a[164:167], v[52:55]
  s_cmp_lg_u32 s6, 0
  s_cselect_b32 s7, s15, 0x40000000
  s_lshl_b32 s15, 1, s5
  v_mfma_f32_16x16x32_bf16 v[12:15], a[12:15], a[160:163], v[12:15]
  s_waitcnt lgkmcnt(10)
  buffer_load_dwordx4 v195, s[64:67], s85 offen offset:3072 lds
  v_mfma_f32_16x16x32_bf16 v[16:19], a[16:19], a[160:163], v[16:19]
  ds_read_b64_tr_b16 a[0:1], v201 offset:30720
  ds_read_b64_tr_b16 a[2:3], v201 offset:35840
  v_mfma_f32_16x16x32_bf16 v[56:59], a[16:19], a[164:167], v[56:59]
  v_mfma_f32_16x16x32_bf16 v[96:99], a[16:19], a[168:171], v[96:99]
  buffer_load_dwordx4 a[152:155], v199, s[20:23], s88 offen offset:1024 sc1
  v_mfma_f32_16x16x32_bf16 v[216:219], a[16:19], a[172:175], v[216:219]
  s_waitcnt lgkmcnt(10)
  v_mfma_f32_16x16x32_bf16 v[220:223], a[20:23], a[172:175], v[220:223]
  ds_read_b64_tr_b16 a[4:5], v202 offset:30720
  ds_read_b64_tr_b16 a[6:7], v202 offset:35840
  v_mfma_f32_16x16x32_bf16 v[100:103], a[20:23], a[168:171], v[100:103]
  s_add_u32 m0, s100, 4096
  v_mfma_f32_16x16x32_bf16 v[60:63], a[20:23], a[164:167], v[60:63]
  v_mfma_f32_16x16x32_bf16 v[20:23], a[20:23], a[160:163], v[20:23]
  s_waitcnt lgkmcnt(10)
  v_mfma_f32_16x16x32_bf16 v[24:27], a[24:27], a[160:163], v[24:27]
  ds_read_b64_tr_b16 a[8:9], v201 offset:30784
  ds_read_b64_tr_b16 a[10:11], v201 offset:35904
  v_mfma_f32_16x16x32_bf16 v[64:67], a[24:27], a[164:167], v[64:67]
  v_mfma_f32_16x16x32_bf16 v[104:107], a[24:27], a[168:171], v[104:107]
  v_mfma_f32_16x16x32_bf16 v[224:227], a[24:27], a[172:175], v[224:227]
  s_waitcnt lgkmcnt(10)
  buffer_load_dwordx4 v196, s[64:67], s85 offen offset:0 lds
  v_mfma_f32_16x16x32_bf16 v[228:231], a[28:31], a[172:175], v[228:231]
  ds_read_b64_tr_b16 a[12:13], v202 offset:30784
  ds_read_b64_tr_b16 a[14:15], v202 offset:35904
  v_mov_b32 v248, s15
  v_mfma_f32_16x16x32_bf16 v[108:111], a[28:31], a[168:171], v[108:111]
  s_add_u32 s85, s85, 81920
  buffer_atomic_add v248, v249, s[60:63], s7 offen sc0 sc1
  v_mfma_f32_16x16x32_bf16 v[68:71], a[28:31], a[164:167], v[68:71]
  buffer_load_dword v252, v207, s[36:39], 0 offen sc1
  v_mfma_f32_16x16x32_bf16 v[28:31], a[28:31], a[160:163], v[28:31]
  s_waitcnt lgkmcnt(10)
  buffer_load_dwordx4 a[156:159], v200, s[20:23], s88 offen offset:1024 sc1
  v_mfma_f32_16x16x32_bf16 v[32:35], a[32:35], a[160:163], v[32:35]
  ds_read_b64_tr_b16 a[16:17], v201 offset:30848
  ds_read_b64_tr_b16 a[18:19], v201 offset:35968
  v_mfma_f32_16x16x32_bf16 v[72:75], a[32:35], a[164:167], v[72:75]
  v_mfma_f32_16x16x32_bf16 v[112:115], a[32:35], a[168:171], v[112:115]
  v_mfma_f32_16x16x32_bf16 v[232:235], a[32:35], a[172:175], v[232:235]
  s_waitcnt lgkmcnt(10)
  v_mfma_f32_16x16x32_bf16 v[236:239], a[36:39], a[172:175], v[236:239]
  ds_read_b64_tr_b16 a[20:21], v202 offset:30848
  ds_read_b64_tr_b16 a[22:23], v202 offset:35968
  v_mfma_f32_16x16x32_bf16 v[116:119], a[36:39], a[168:171], v[116:119]
  v_mfma_f32_16x16x32_bf16 v[76:79], a[36:39], a[164:167], v[76:79]
  s_waitcnt vmcnt(15)
  v_mfma_f32_16x16x32_bf16 v[36:39], a[36:39], a[160:163], v[36:39]
  s_waitcnt lgkmcnt(10)
  v_mfma_f32_16x16x32_bf16 v[0:3], a[0:3], a[176:179], v[0:3]
  ds_read_b64_tr_b16 a[24:25], v201 offset:30912
  ds_read_b64_tr_b16 a[26:27], v201 offset:36032
  v_mfma_f32_16x16x32_bf16 v[40:43], a[0:3], a[180:183], v[40:43]
  s_cmp_ge_u32 s19, 3
  s_cselect_b32 s18, 1, 0
  s_mul_i32 s15, s18, 3
  v_mfma_f32_16x16x32_bf16 v[80:83], a[0:3], a[184:187], v[80:83]
  s_sub_u32 s15, s19, s15
  buffer_load_dwordx4 a[160:163], v197, s[20:23], s88 offen offset:2048 sc1
  v_mfma_f32_16x16x32_bf16 v[120:123], a[0:3], a[188:191], v[120:123]
  s_waitcnt lgkmcnt(10)
  s_cmp_ge_u32 s15, s8
  s_addc_u32 s15, s15, 0
  s_and_b32 s15, s15, 3
  v_mfma_f32_16x16x32_bf16 v[124:127], a[4:7], a[188:191], v[124:127]
  s_bfe_u32 s9, s26, 0x20003
  ds_read_b64_tr_b16 a[28:29], v202 offset:30912
  ds_read_b64_tr_b16 a[30:31], v202 offset:36032
  v_mfma_f32_16x16x32_bf16 v[84:87], a[4:7], a[184:187], v[84:87]
  s_lshl2_add_u32 s15, s9, s15
  s_lshl4_add_u32 s9, s18, s15
  s_lshl_b32 s89, s9, 12
  v_mfma_f32_16x16x32_bf16 v[44:47], a[4:7], a[180:183], v[44:47]
  s_lshl1_add_u32 s15, s15, s18
  s_lshl3_add_u32 s15, s15, s24
  s_mul_i32 s86, s15, 20480
  v_mfma_f32_16x16x32_bf16 v[4:7], a[4:7], a[176:179], v[4:7]
  s_waitcnt lgkmcnt(10)
  s_xor_b32 s10, s14, 1
  s_and_b32 s18, s18, s14
  v_mfma_f32_16x16x32_bf16 v[8:11], a[8:11], a[176:179], v[8:11]
  ds_read_b64_tr_b16 a[32:33], v201 offset:30976
  ds_read_b64_tr_b16 a[34:35], v201 offset:36096
  v_mfma_f32_16x16x32_bf16 v[48:51], a[8:11], a[180:183], v[48:51]
  s_cmp_eq_u32 s14, 0
  s_cselect_b32 s86, 0x40000000, s86
  s_cselect_b32 s89, 0x40000000, s89
  v_mfma_f32_16x16x32_bf16 v[88:91], a[8:11], a[184:187], v[88:91]
  buffer_load_dwordx4 a[164:167], v198, s[20:23], s88 offen offset:2048 sc1
  v_mfma_f32_16x16x32_bf16 v[208:211], a[8:11], a[188:191], v[208:211]
  s_waitcnt lgkmcnt(10)
  v_mfma_f32_16x16x32_bf16 v[212:215], a[12:15], a[188:191], v[212:215]
  ds_read_b64_tr_b16 a[36:37], v202 offset:30976
  ds_read_b64_tr_b16 a[38:39], v202 offset:36096
  v_mfma_f32_16x16x32_bf16 v[92:95], a[12:15], a[184:187], v[92:95]
  v_mfma_f32_16x16x32_bf16 v[52:55], a[12:15], a[180:183], v[52:55]
  v_mfma_f32_16x16x32_bf16 v[12:15], a[12:15], a[176:179], v[12:15]
  s_waitcnt lgkmcnt(10)
  v_mfma_f32_16x16x32_bf16 v[16:19], a[16:19], a[176:179], v[16:19]
  v_mfma_f32_16x16x32_bf16 v[56:59], a[16:19], a[180:183], v[56:59]
  v_mfma_f32_16x16x32_bf16 v[96:99], a[16:19], a[184:187], v[96:99]
  buffer_load_dwordx4 a[168:171], v199, s[20:23], s88 offen offset:2048 sc1
  v_mfma_f32_16x16x32_bf16 v[216:219], a[16:19], a[188:191], v[216:219]
  s_waitcnt lgkmcnt(8)
  v_mfma_f32_16x16x32_bf16 v[220:223], a[20:23], a[188:191], v[220:223]
  s_waitcnt vmcnt(19) lgkmcnt(0)
  v_mfma_f32_16x16x32_bf16 v[100:103], a[20:23], a[184:187], v[100:103]
  s_barrier
  v_mfma_f32_16x16x32_bf16 v[60:63], a[20:23], a[180:183], v[60:63]
  ds_read_b64_tr_b16 a[0:1], v201 offset:40960
  ds_read_b64_tr_b16 a[2:3], v201 offset:46080
  v_mfma_f32_16x16x32_bf16 v[20:23], a[20:23], a[176:179], v[20:23]
  s_add_u32 m0, s100, 20480
  v_mfma_f32_16x16x32_bf16 v[24:27], a[24:27], a[176:179], v[24:27]
  ds_read_b64_tr_b16 a[4:5], v202 offset:40960
  ds_read_b64_tr_b16 a[6:7], v202 offset:46080
  v_mfma_f32_16x16x32_bf16 v[64:67], a[24:27], a[180:183], v[64:67]
  buffer_load_dwordx4 v192, s[64:67], s86 offen offset:0 lds
  v_mfma_f32_16x16x32_bf16 v[104:107], a[24:27], a[184:187], v[104:107]
  ds_read_b64_tr_b16 a[8:9], v201 offset:41024
  ds_read_b64_tr_b16 a[10:11], v201 offset:46144
  v_mfma_f32_16x16x32_bf16 v[224:227], a[24:27], a[188:191], v[224:227]
  s_cmp_eq_u32 s11, 0
  s_cbranch_scc1 L_sigB
L_sigB_ret:
  v_mfma_f32_16x16x32_bf16 v[228:231], a[28:31], a[188:191], v[228:231]
  ds_read_b64_tr_b16 a[12:13], v202 offset:41024
  ds_read_b64_tr_b16 a[14:15], v202 offset:46144
  v_mfma_f32_16x16x32_bf16 v[108:111], a[28:31], a[184:187], v[108:111]
  v_mfma_f32_16x16x32_bf16 v[68:71], a[28:31], a[180:183], v[68:71]
  ds_read_b64_tr_b16 a[16:17], v201 offset:41088
  ds_read_b64_tr_b16 a[18:19], v201 offset:46208
  v_mfma_f32_16x16x32_bf16 v[28:31], a[28:31], a[176:179], v[28:31]
  buffer_load_dwordx4 a[172:175], v200, s[20:23], s88 offen offset:2048 sc1
  v_mfma_f32_16x16x32_bf16 v[32:35], a[32:35], a[176:179], v[32:35]
  ds_read_b64_tr_b16 a[20:21], v202 offset:41088
  ds_read_b64_tr_b16 a[22:23], v202 offset:46208
  v_mfma_f32_16x16x32_bf16 v[72:75], a[32:35], a[180:183], v[72:75]
  v_mfma_f32_16x16x32_bf16 v[112:115], a[32:35], a[184:187], v[112:115]
  v_mfma_f32_16x16x32_bf16 v[232:235], a[32:35], a[188:191], v[232:235]
  buffer_load_dwordx4 v193, s[64:67], s86 offen offset:1024 lds
  v_mfma_f32_16x16x32_bf16 v[236:239], a[36:39], a[188:191], v[236:239]
  v_mfma_f32_16x16x32_bf16 v[116:119], a[36:39], a[184:187], v[116:119]
  v_mfma_f32_16x16x32_bf16 v[76:79], a[36:39], a[180:183], v[76:79]
  s_waitcnt vmcnt(16)
  v_mfma_f32_16x16x32_bf16 v[36:39], a[36:39], a[176:179], v[36:39]
  s_cmp_eq_u32 s13, 0
  s_cbranch_scc1 L_oexit
  s_waitcnt lgkmcnt(10)
  v_mfma_f32_16x16x32_bf16 v[0:3], a[0:3], a[128:131], v[0:3]
  ds_read_b64_tr_b16 a[24:25], v201 offset:41152
  ds_read_b64_tr_b16 a[26:27], v201 offset:46272
  v_mfma_f32_16x16x32_bf16 v[40:43], a[0:3], a[132:135], v[40:43]
  v_mfma_f32_16x16x32_bf16 v[80:83], a[0:3], a[136:139], v[80:83]
  buffer_load_dwordx4 a[176:179], v197, s[20:23], s88 offen offset:3072 sc1
  v_mfma_f32_16x16x32_bf16 v[120:123], a[0:3], a[140:143], v[120:123]
  s_waitcnt lgkmcnt(10)
  v_mfma_f32_16x16x32_bf16 v[124:127], a[4:7], a[140:143], v[124:127]
  ds_read_b64_tr_b16 a[28:29], v202 offset:41152
  ds_read_b64_tr_b16 a[30:31], v202 offset:46272
  v_mfma_f32_16x16x32_bf16 v[84:87], a[4:7], a[136:139], v[84:87]
  buffer_load_dwordx4 v194, s[64:67], s86 offen offset:2048 lds
  v_mfma_f32_16x16x32_bf16 v[44:47], a[4:7], a[132:135], v[44:47]
  v_mfma_f32_16x16x32_bf16 v[4:7], a[4:7], a[128:131], v[4:7]
  s_waitcnt lgkmcnt(10)
  v_mfma_f32_16x16x32_bf16 v[8:11], a[8:11], a[128:131], v[8:11]
  ds_read_b64_tr_b16 a[32:33], v201 offset:41216
  ds_read_b64_tr_b16 a[34:35], v201 offset:46336
  v_mfma_f32_16x16x32_bf16 v[48:51], a[8:11], a[132:135], v[48:51]
  v_mfma_f32_16x16x32_bf16 v[88:91], a[8:11], a[136:139], v[88:91]
  buffer_load_dwordx4 a[180:183], v198, s[20:23], s88 offen offset:3072 sc1
  v_mfma_f32_16x16x32_bf16 v[208:211], a[8:11], a[140:143], v[208:211]
  s_waitcnt lgkmcnt(10)
  v_mfma_f32_16x16x32_bf16 v[212:215], a[12:15], a[140:143], v[212:215]
  ds_read_b64_tr_b16 a[36:37], v202 offset:41216
  ds_read_b64_tr_b16 a[38:39], v202 offset:46336
  v_mfma_f32_16x16x32_bf16 v[92:95], a[12:15], a[136:139], v[92:95]
  v_mfma_f32_16x16x32_bf16 v[52:55], a[12:15], a[132:135], v[52:55]
  v_mfma_f32_16x16x32_bf16 v[12:15], a[12:15], a[128:131], v[12:15]
  s_waitcnt lgkmcnt(10)
  buffer_load_dwordx4 v195, s[64:67], s86 offen offset:3072 lds
  v_mfma_f32_16x16x32_bf16 v[16:19], a[16:19], a[128:131], v[16:19]
  ds_read_b64_tr_b16 a[0:1], v201 offset:51200
  ds_read_b64_tr_b16 a[2:3], v201 offset:56320
  v_mfma_f32_16x16x32_bf16 v[56:59], a[16:19], a[132:135], v[56:59]
  v_mfma_f32_16x16x32_bf16 v[96:99], a[16:19], a[136:139], v[96:99]
  buffer_load_dwordx4 a[184:187], v199, s[20:23], s88 offen offset:3072 sc1
  v_mfma_f32_16x16x32_bf16 v[216:219], a[16:19], a[140:143], v[216:219]
  s_waitcnt lgkmcnt(10)
  v_mfma_f32_16x16x32_bf16 v[220:223], a[20:23], a[140:143], v[220:223]
  ds_read_b64_tr_b16 a[4:5], v202 offset:51200
  ds_read_b64_tr_b16 a[6:7], v202 offset:56320
  v_mfma_f32_16x16x32_bf16 v[100:103], a[20:23], a[136:139], v[100:103]
  s_add_u32 m0, s100, 24576
  v_mfma_f32_16x16x32_bf16 v[60:63], a[20:23], a[132:135], v[60:63]
  v_mfma_f32_16x16x32_bf16 v[20:23], a[20:23], a[128:131], v[20:23]
  s_waitcnt lgkmcnt(10)
  v_mfma_f32_16x16x32_bf16 v[24:27], a[24:27], a[128:131], v[24:27]
  ds_read_b64_tr_b16 a[8:9], v201 offset:51264
  ds_read_b64_tr_b16 a[10:11], v201 offset:56384
  v_mfma_f32_16x16x32_bf16 v[64:67], a[24:27], a[132:135], v[64:67]
  v_mfma_f32_16x16x32_bf16 v[104:107], a[24:27], a[136:139], v[104:107]
  v_mfma_f32_16x16x32_bf16 v[224:227], a[24:27], a[140:143], v[224:227]
  s_waitcnt lgkmcnt(10)
  buffer_load_dwordx4 v196, s[64:67], s86 offen offset:0 lds
  v_mfma_f32_16x16x32_bf16 v[228:231], a[28:31], a[140:143], v[228:231]
  ds_read_b64_tr_b16 a[12:13], v202 offset:51264
  ds_read_b64_tr_b16 a[14:15], v202 offset:56384
  v_mfma_f32_16x16x32_bf16 v[108:111], a[28:31], a[136:139], v[108:111]
  s_add_u32 s86, s86, 81920
  v_mfma_f32_16x16x32_bf16 v[68:71], a[28:31], a[132:135], v[68:71]
  v_mfma_f32_16x16x32_bf16 v[28:31], a[28:31], a[128:131], v[28:31]
  s_waitcnt lgkmcnt(10)
  buffer_load_dwordx4 a[188:191], v200, s[20:23], s88 offen offset:3072 sc1
  v_mfma_f32_16x16x32_bf16 v[32:35], a[32:35], a[128:131], v[32:35]
  ds_read_b64_tr_b16 a[16:17], v201 offset:51328
  ds_read_b64_tr_b16 a[18:19], v201 offset:56448
  v_mfma_f32_16x16x32_bf16 v[72:75], a[32:35], a[132:135], v[72:75]
  v_mfma_f32_16x16x32_bf16 v[112:115], a[32:35], a[136:139], v[112:115]
  global_load_dword v253, v243, s[98:99]
  v_mfma_f32_16x16x32_bf16 v[232:235], a[32:35], a[140:143], v[232:235]
  s_waitcnt lgkmcnt(10)
  s_waitcnt vmcnt(14)
  v_readlane_b32 s55, v252, s9
  v_mfma_f32_16x16x32_bf16 v[236:239], a[36:39], a[140:143], v[236:239]
  ds_read_b64_tr_b16 a[20:21], v202 offset:51328
  ds_read_b64_tr_b16 a[22:23], v202 offset:56448
  v_mfma_f32_16x16x32_bf16 v[116:119], a[36:39], a[136:139], v[116:119]
  v_mfma_f32_16x16x32_bf16 v[76:79], a[36:39], a[132:135], v[76:79]
  s_or_b32 s55, s55, s10
  s_cbranch_scc0 L_spin1
L_spin1_ret:
  v_mfma_f32_16x16x32_bf16 v[36:39], a[36:39], a[128:131], v[36:39]
  s_waitcnt lgkmcnt(10)
  v_mfma_f32_16x16x32_bf16 v[0:3], a[0:3], a[144:147], v[0:3]
  ds_read_b64_tr_b16 a[24:25], v201 offset:51392
  ds_read_b64_tr_b16 a[26:27], v201 offset:56512
  v_mfma_f32_16x16x32_bf16 v[40:43], a[0:3], a[148:151], v[40:43]
  v_mfma_f32_16x16x32_bf16 v[80:83], a[0:3], a[152:155], v[80:83]
  buffer_load_dwordx4 a[128:131], v197, s[20:23], s89 offen offset:0 sc1
  v_mfma_f32_16x16x32_bf16 v[120:123], a[0:3], a[156:159], v[120:123]
  s_waitcnt lgkmcnt(10)
  v_mfma_f32_16x16x32_bf16 v[124:127], a[4:7], a[156:159], v[124:127]
  ds_read_b64_tr_b16 a[28:29], v202 offset:51392
  ds_read_b64_tr_b16 a[30:31], v202 offset:56512
  v_mfma_f32_16x16x32_bf16 v[84:87], a[4:7], a[152:155], v[84:87]
  v_mfma_f32_16x16x32_bf16 v[44:47], a[4:7], a[148:151], v[44:47]
  v_mfma_f32_16x16x32_bf16 v[4:7], a[4:7], a[144:147], v[4:7]
  s_waitcnt lgkmcnt(10)
  v_mfma_f32_16x16x32_bf16 v[8:11], a[8:11], a[144:147], v[8:11]
  ds_read_b64_tr_b16 a[32:33], v201 offset:51456
  ds_read_b64_tr_b16 a[34:35], v201 offset:56576
  v_mfma_f32_16x16x32_bf16 v[48:51], a[8:11], a[148:151], v[48:51]
  v_mfma_f32_16x16x32_bf16 v[88:91], a[8:11], a[152:155], v[88:91]
  buffer_load_dwordx4 a[132:135], v198, s[20:23], s89 offen offset:0 sc1
  v_mfma_f32_16x16x32_bf16 v[208:211], a[8:11], a[156:159], v[208:211]
  s_waitcnt lgkmcnt(10)
  v_mfma_f32_16x16x32_bf16 v[212:215], a[12:15], a[156:159], v[212:215]
  ds_read_b64_tr_b16 a[36:37], v202 offset:51456
  ds_read_b64_tr_b16 a[38:39], v202 offset:56576
  v_mfma_f32_16x16x32_bf16 v[92:95], a[12:15], a[152:155], v[92:95]
  v_mfma_f32_16x16x32_bf16 v[52:55], a[12:15], a[148:151], v[52:55]
  v_mfma_f32_16x16x32_bf16 v[12:15], a[12:15], a[144:147], v[12:15]
  s_waitcnt lgkmcnt(10)
  v_mfma_f32_16x16x32_bf16 v[16:19], a[16:19], a[144:147], v[16:19]
  v_readfirstlane_b32 s15, v248
  v_mfma_f32_16x16x32_bf16 v[56:59], a[16:19], a[148:151], v[56:59]
  s_nop 0
  v_mov_b32 v245, s15
  v_mfma_f32_16x16x32_bf16 v[96:99], a[16:19], a[152:155], v[96:99]
  buffer_load_dwordx4 a[136:139], v199, s[20:23], s89 offen offset:0 sc1
  v_mfma_f32_16x16x32_bf16 v[216:219], a[16:19], a[156:159], v[216:219]
  s_waitcnt lgkmcnt(8)
  ds_write_b32 v250, v245 offset:0
  v_mfma_f32_16x16x32_bf16 v[220:223], a[20:23], a[156:159], v[220:223]
  s_waitcnt vmcnt(20) lgkmcnt(0)
  v_mfma_f32_16x16x32_bf16 v[100:103], a[20:23], a[152:155], v[100:103]
  s_barrier
  v_mfma_f32_16x16x32_bf16 v[60:63], a[20:23], a[148:151], v[60:63]
  ds_read_b32 v246, v251 offset:0
  ds_read_b64_tr_b16 a[0:1], v201 offset:0
  ds_read_b64_tr_b16 a[2:3], v201 offset:5120
  v_mfma_f32_16x16x32_bf16 v[20:23], a[20:23], a[144:147], v[20:23]
  s_add_u32 m0, s100, 40960
  v_mfma_f32_16x16x32_bf16 v[24:27], a[24:27], a[144:147], v[24:27]
  ds_read_b64_tr_b16 a[4:5], v202 offset:0
  ds_read_b64_tr_b16 a[6:7], v202 offset:5120
  v_mfma_f32_16x16x32_bf16 v[64:67], a[24:27], a[148:151], v[64:67]
  buffer_load_dwordx4 v192, s[64:67], s86 offen offset:0 lds
  v_mfma_f32_16x16x32_bf16 v[104:107], a[24:27], a[152:155], v[104:107]
  ds_read_b64_tr_b16 a[8:9], v201 offset:64
  ds_read_b64_tr_b16 a[10:11], v201 offset:5184
  v_mfma_f32_16x16x32_bf16 v[224:227], a[24:27], a[156:159], v[224:227]
  v_mfma_f32_16x16x32_bf16 v[228:231], a[28:31], a[156:159], v[228:231]
  ds_read_b64_tr_b16 a[12:13], v202 offset:64
  ds_read_b64_tr_b16 a[14:15], v202 offset:5184
  v_mfma_f32_16x16x32_bf16 v[108:111], a[28:31], a[152:155], v[108:111]
  v_mfma_f32_16x16x32_bf16 v[68:71], a[28:31], a[148:151], v[68:71]
  ds_read_b64_tr_b16 a[16:17], v201 offset:128
  ds_read_b64_tr_b16 a[18:19], v201 offset:5248
  v_mfma_f32_16x16x32_bf16 v[28:31], a[28:31], a[144:147], v[28:31]
  buffer_load_dwordx4 a[140:143], v200, s[20:23], s89 offen offset:0 sc1
  v_mfma_f32_16x16x32_bf16 v[32:35], a[32:35], a[144:147], v[32:35]
  ds_read_b64_tr_b16 a[20:21], v202 offset:128
  ds_read_b64_tr_b16 a[22:23], v202 offset:5248
  v_mfma_f32_16x16x32_bf16 v[72:75], a[32:35], a[148:151], v[72:75]
  v_mfma_f32_16x16x32_bf16 v[112:115], a[32:35], a[152:155], v[112:115]
  v_mfma_f32_16x16x32_bf16 v[232:235], a[32:35], a[156:159], v[232:235]
  buffer_load_dwordx4 v193, s[64:67], s86 offen offset:1024 lds
  v_mfma_f32_16x16x32_bf16 v[236:239], a[36:39], a[156:159], v[236:239]
  v_mfma_f32_16x16x32_bf16 v[116:119], a[36:39], a[152:155], v[116:119]
  v_mfma_f32_16x16x32_bf16 v[76:79], a[36:39], a[148:151], v[76:79]
  s_waitcnt vmcnt(15)
  v_mfma_f32_16x16x32_bf16 v[36:39], a[36:39], a[144:147], v[36:39]
  s_waitcnt lgkmcnt(10)
  s_waitcnt lgkmcnt(12)
  v_readfirstlane_b32 s4, v246
  v_mfma_f32_16x16x32_bf16 v[0:3], a[0:3], a[160:163], v[0:3]
  s_bfe_u32 s19, s4, s5
  ds_read_b64_tr_b16 a[24:25], v201 offset:192
  ds_read_b64_tr_b16 a[26:27], v201 offset:5312
  v_mfma_f32_16x16x32_bf16 v[40:43], a[0:3], a[164:167], v[40:43]
  s_cmp_lt_u32 s19, 6
  s_cselect_b32 s12, s6, 0
  s_mov_b32 s26, s5
  v_mfma_f32_16x16x32_bf16 v[80:83], a[0:3], a[168:171], v[80:83]
  s_lshl_b32 s15, 1, s5
  s_add_u32 s4, s4, s15
  buffer_load_dwordx4 a[144:147], v197, s[20:23], s89 offen offset:1024 sc1
  v_mfma_f32_16x16x32_bf16 v[120:123], a[0:3], a[172:175], v[120:123]
  s_waitcnt lgkmcnt(10)
  s_lshl_b32 s17, s82, 3
  s_or_b32 s17, s17, 0x80000
  s_xor_b32 s5, s17, 8
  v_mfma_f32_16x16x32_bf16 v[124:127], a[4:7], a[172:175], v[124:127]
  s_bfe_u32 s16, s4, s5
  ds_read_b64_tr_b16 a[28:29], v202 offset:192
  ds_read_b64_tr_b16 a[30:31], v202 offset:5312
  v_mfma_f32_16x16x32_bf16 v[84:87], a[4:7], a[168:171], v[84:87]
  s_xor_b32 s56, s17, 16
  s_bfe_u32 s15, s4, s56
  buffer_load_dwordx4 v194, s[64:67], s86 offen offset:2048 lds
  v_mfma_f32_16x16x32_bf16 v[44:47], a[4:7], a[164:167], v[44:47]
  s_cmp_lt_u32 s15, s16
  s_cselect_b32 s5, s56, s5
  s_cselect_b32 s16, s15, s16
  v_mfma_f32_16x16x32_bf16 v[4:7], a[4:7], a[160:163], v[4:7]
  s_waitcnt lgkmcnt(10)
  s_xor_b32 s56, s17, 24
  s_bfe_u32 s15, s4, s56
  v_mfma_f32_16x16x32_bf16 v[8:11], a[8:11], a[160:163], v[8:11]
  ds_read_b64_tr_b16 a[32:33], v201 offset:256
  ds_read_b64_tr_b16 a[34:35], v201 offset:5376
  v_mfma_f32_16x16x32_bf16 v[48:51], a[8:11], a[164:167], v[48:51]
  s_cmp_lt_u32 s15, s16
  s_cselect_b32 s5, s56, s5
  s_cselect_b32 s16, s15, s16
  v_mfma_f32_16x16x32_bf16 v[88:91], a[8:11], a[168:171], v[88:91]
  s_bfe_u32 s15, s4, s17
  buffer_load_dwordx4 a[148:151], v198, s[20:23], s89 offen offset:1024 sc1
  v_mfma_f32_16x16x32_bf16 v[208:211], a[8:11], a[172:175], v[208:211]
  s_waitcnt lgkmcnt(10)
  s_cmp_lt_u32 s15, 6
  s_cselect_b32 s5, s17, s5
  s_cselect_b32 s16, s15, s16
  v_mfma_f32_16x16x32_bf16 v[212:215], a[12:15], a[172:175], v[212:215]
  ds_read_b64_tr_b16 a[36:37], v202 offset:256
  ds_read_b64_tr_b16 a[38:39], v202 offset:5376
  v_mfma_f32_16x16x32_bf16 v[92:95], a[12:15], a[168:171], v[92:95]
  s_cmp_lt_u32 s16, 6
  s_cselect_b32 s6, s12, 0
  s_mov_b32 s15, 15488
  v_mfma_f32_16x16x32_bf16 v[52:55], a[12:15], a[164:167], v[52:55]
  s_cmp_lg_u32 s6, 0
  s_cselect_b32 s7, s15, 0x40000000
  s_lshl_b32 s15, 1, s5
  v_mfma_f32_16x16x32_bf16 v[12:15], a[12:15], a[160:163], v[12:15]
  s_waitcnt lgkmcnt(10)
  buffer_load_dwordx4 v195, s[64:67], s86 offen offset:3072 lds
  v_mfma_f32_16x16x32_bf16 v[16:19], a[16:19], a[160:163], v[16:19]
  ds_read_b64_tr_b16 a[0:1], v201 offset:10240
  ds_read_b64_tr_b16 a[2:3], v201 offset:15360
  v_mfma_f32_16x16x32_bf16 v[56:59], a[16:19], a[164:167], v[56:59]
  v_mfma_f32_16x16x32_bf16 v[96:99], a[16:19], a[168:171], v[96:99]
  buffer_load_dwordx4 a[152:155], v199, s[20:23], s89 offen offset:1024 sc1
  v_mfma_f32_16x16x32_bf16 v[216:219], a[16:19], a[172:175], v[216:219]
  s_waitcnt lgkmcnt(10)
  v_mfma_f32_16x16x32_bf16 v[220:223], a[20:23], a[172:175], v[220:223]
  ds_read_b64_tr_b16 a[4:5], v202 offset:10240
  ds_read_b64_tr_b16 a[6:7], v202 offset:15360
  v_mfma_f32_16x16x32_bf16 v[100:103], a[20:23], a[168:171], v[100:103]
  s_add_u32 m0, s100, 45056
  v_mfma_f32_16x16x32_bf16 v[60:63], a[20:23], a[164:167], v[60:63]
  v_mfma_f32_16x16x32_bf16 v[20:23], a[20:23], a[160:163], v[20:23]
  s_waitcnt lgkmcnt(10)
  v_mfma_f32_16x16x32_bf16 v[24:27], a[24:27], a[160:163], v[24:27]
  ds_read_b64_tr_b16 a[8:9], v201 offset:10304
  ds_read_b64_tr_b16 a[10:11], v201 offset:15424
  v_mfma_f32_16x16x32_bf16 v[64:67], a[24:27], a[164:167], v[64:67]
  v_mfma_f32_16x16x32_bf16 v[104:107], a[24:27], a[168:171], v[104:107]
  v_mfma_f32_16x16x32_bf16 v[224:227], a[24:27], a[172:175], v[224:227]
  s_waitcnt lgkmcnt(10)
  buffer_load_dwordx4 v196, s[64:67], s86 offen offset:0 lds
  v_mfma_f32_16x16x32_bf16 v[228:231], a[28:31], a[172:175], v[228:231]
  ds_read_b64_tr_b16 a[12:13], v202 offset:10304
  ds_read_b64_tr_b16 a[14:15], v202 offset:15424
  v_mov_b32 v248, s15
  v_mfma_f32_16x16x32_bf16 v[108:111], a[28:31], a[168:171], v[108:111]
  s_add_u32 s86, s86, 81920
  buffer_atomic_add v248, v249, s[60:63], s7 offen sc0 sc1
  v_mfma_f32_16x16x32_bf16 v[68:71], a[28:31], a[164:167], v[68:71]
  buffer_load_dword v252, v207, s[36:39], 0 offen sc1
  v_mfma_f32_16x16x32_bf16 v[28:31], a[28:31], a[160:163], v[28:31]
  s_waitcnt lgkmcnt(10)
  buffer_load_dwordx4 a[156:159], v200, s[20:23], s89 offen offset:1024 sc1
  v_mfma_f32_16x16x32_bf16 v[32:35], a[32:35], a[160:163], v[32:35]
  ds_read_b64_tr_b16 a[16:17], v201 offset:10368
  ds_read_b64_tr_b16 a[18:19], v201 offset:15488
  v_mfma_f32_16x16x32_bf16 v[72:75], a[32:35], a[164:167], v[72:75]
  v_mfma_f32_16x16x32_bf16 v[112:115], a[32:35], a[168:171], v[112:115]
  v_mfma_f32_16x16x32_bf16 v[232:235], a[32:35], a[172:175], v[232:235]
  s_waitcnt lgkmcnt(10)
  v_mfma_f32_16x16x32_bf16 v[236:239], a[36:39], a[172:175], v[236:239]
  ds_read_b64_tr_b16 a[20:21], v202 offset:10368
  ds_read_b64_tr_b16 a[22:23], v202 offset:15488
  v_mfma_f32_16x16x32_bf16 v[116:119], a[36:39], a[168:171], v[116:119]
  v_mfma_f32_16x16x32_bf16 v[76:79], a[36:39], a[164:167], v[76:79]
  s_waitcnt vmcnt(16)
  v_mfma_f32_16x16x32_bf16 v[36:39], a[36:39], a[160:163], v[36:39]
  s_waitcnt lgkmcnt(10)
  v_mfma_f32_16x16x32_bf16 v[0:3], a[0:3], a[176:179], v[0:3]
  ds_read_b64_tr_b16 a[24:25], v201 offset:10432
  ds_read_b64_tr_b16 a[26:27], v201 offset:15552
  v_mfma_f32_16x16x32_bf16 v[40:43], a[0:3], a[180:183], v[40:43]
  s_cmp_ge_u32 s19, 3
  s_cselect_b32 s18, 1, 0
  s_mul_i32 s15, s18, 3
  v_mfma_f32_16x16x32_bf16 v[80:83], a[0:3], a[184:187], v[80:83]
  s_sub_u32 s15, s19, s15
  buffer_load_dwordx4 a[160:163], v197, s[20:23], s89 offen offset:2048 sc1
  v_mfma_f32_16x16x32_bf16 v[120:123], a[0:3], a[188:191], v[120:123]
  s_waitcnt lgkmcnt(10)
  s_cmp_ge_u32 s15, s8
  s_addc_u32 s15, s15, 0
  s_and_b32 s15, s15, 3
  v_mfma_f32_16x16x32_bf16 v[124:127], a[4:7], a[188:191], v[124:127]
  s_bfe_u32 s9, s26, 0x20003
  ds_read_b64_tr_b16 a[28:29], v202 offset:10432
  ds_read_b64_tr_b16 a[30:31], v202 offset:15552
  v_mfma_f32_16x16x32_bf16 v[84:87], a[4:7], a[184:187], v[84:87]
  s_lshl2_add_u32 s15, s9, s15
  s_lshl4_add_u32 s9, s18, s15
  s_lshl_b32 s87, s9, 12
  v_mfma_f32_16x16x32_bf16 v[44:47], a[4:7], a[180:183], v[44:47]
  s_lshl1_add_u32 s15, s15, s18
  s_lshl3_add_u32 s15, s15, s24
  s_mul_i32 s84, s15, 20480
  v_mfma_f32_16x16x32_bf16 v[4:7], a[4:7], a[176:179], v[4:7]
  s_waitcnt lgkmcnt(10)
  s_xor_b32 s10, s12, 1
  s_and_b32 s18, s18, s12
  v_mfma_f32_16x16x32_bf16 v[8:11], a[8:11], a[176:179], v[8:11]
  ds_read_b64_tr_b16 a[32:33], v201 offset:10496
  ds_read_b64_tr_b16 a[34:35], v201 offset:15616
  v_mfma_f32_16x16x32_bf16 v[48:51], a[8:11], a[180:183], v[48:51]
  s_cmp_eq_u32 s12, 0
  s_cselect_b32 s84, 0x40000000, s84
  s_cselect_b32 s87, 0x40000000, s87
  v_mfma_f32_16x16x32_bf16 v[88:91], a[8:11], a[184:187], v[88:91]
  buffer_load_dwordx4 a[164:167], v198, s[20:23], s89 offen offset:2048 sc1
  v_mfma_f32_16x16x32_bf16 v[208:211], a[8:11], a[188:191], v[208:211]
  s_waitcnt lgkmcnt(10)
  v_mfma_f32_16x16x32_bf16 v[212:215], a[12:15], a[188:191], v[212:215]
  ds_read_b64_tr_b16 a[36:37], v202 offset:10496
  ds_read_b64_tr_b16 a[38:39], v202 offset:15616
  v_mfma_f32_16x16x32_bf16 v[92:95], a[12:15], a[184:187], v[92:95]
  v_mfma_f32_16x16x32_bf16 v[52:55], a[12:15], a[180:183], v[52:55]
  v_mfma_f32_16x16x32_bf16 v[12:15], a[12:15], a[176:179], v[12:15]
  s_waitcnt lgkmcnt(10)
  v_mfma_f32_16x16x32_bf16 v[16:19], a[16:19], a[176:179], v[16:19]
  v_mfma_f32_16x16x32_bf16 v[56:59], a[16:19], a[180:183], v[56:59]
  v_mfma_f32_16x16x32_bf16 v[96:99], a[16:19], a[184:187], v[96:99]
  buffer_load_dwordx4 a[168:171], v199, s[20:23], s89 offen offset:2048 sc1
  v_mfma_f32_16x16x32_bf16 v[216:219], a[16:19], a[188:191], v[216:219]
  s_waitcnt lgkmcnt(8)
  v_mfma_f32_16x16x32_bf16 v[220:223], a[20:23], a[188:191], v[220:223]
  s_waitcnt vmcnt(20) lgkmcnt(0)
  v_mfma_f32_16x16x32_bf16 v[100:103], a[20:23], a[184:187], v[100:103]
  s_barrier
  v_mfma_f32_16x16x32_bf16 v[60:63], a[20:23], a[180:183], v[60:63]
  ds_read_b64_tr_b16 a[0:1], v201 offset:20480
  ds_read_b64_tr_b16 a[2:3], v201 offset:25600
  v_mfma_f32_16x16x32_bf16 v[20:23], a[20:23], a[176:179], v[20:23]
  s_add_u32 m0, s100, 0
  v_mfma_f32_16x16x32_bf16 v[24:27], a[24:27], a[176:179], v[24:27]
  ds_read_b64_tr_b16 a[4:5], v202 offset:20480
  ds_read_b64_tr_b16 a[6:7], v202 offset:25600
  v_mfma_f32_16x16x32_bf16 v[64:67], a[24:27], a[180:183], v[64:67]
  buffer_load_dwordx4 v192, s[64:67], s84 offen offset:0 lds
  v_mfma_f32_16x16x32_bf16 v[104:107], a[24:27], a[184:187], v[104:107]
  ds_read_b64_tr_b16 a[8:9], v201 offset:20544
  ds_read_b64_tr_b16 a[10:11], v201 offset:25664
  v_mfma_f32_16x16x32_bf16 v[224:227], a[24:27], a[188:191], v[224:227]
  v_mfma_f32_16x16x32_bf16 v[228:231], a[28:31], a[188:191], v[228:231]
  ds_read_b64_tr_b16 a[12:13], v202 offset:20544
  ds_read_b64_tr_b16 a[14:15], v202 offset:25664
  v_mfma_f32_16x16x32_bf16 v[108:111], a[28:31], a[184:187], v[108:111]
  v_mfma_f32_16x16x32_bf16 v[68:71], a[28:31], a[180:183], v[68:71]
  ds_read_b64_tr_b16 a[16:17], v201 offset:20608
  ds_read_b64_tr_b16 a[18:19], v201 offset:25728
  v_mfma_f32_16x16x32_bf16 v[28:31], a[28:31], a[176:179], v[28:31]
  buffer_load_dwordx4 a[172:175], v200, s[20:23], s89 offen offset:2048 sc1
  v_mfma_f32_16x16x32_bf16 v[32:35], a[32:35], a[176:179], v[32:35]
  ds_read_b64_tr_b16 a[20:21], v202 offset:20608
  ds_read_b64_tr_b16 a[22:23], v202 offset:25728
  v_mfma_f32_16x16x32_bf16 v[72:75], a[32:35], a[180:183], v[72:75]
  v_mfma_f32_16x16x32_bf16 v[112:115], a[32:35], a[184:187], v[112:115]
  v_mfma_f32_16x16x32_bf16 v[232:235], a[32:35], a[188:191], v[232:235]
  buffer_load_dwordx4 v193, s[64:67], s84 offen offset:1024 lds
  v_mfma_f32_16x16x32_bf16 v[236:239], a[36:39], a[188:191], v[236:239]
  v_mfma_f32_16x16x32_bf16 v[116:119], a[36:39], a[184:187], v[116:119]
  v_mfma_f32_16x16x32_bf16 v[76:79], a[36:39], a[180:183], v[76:79]
  s_waitcnt vmcnt(16)
  v_mfma_f32_16x16x32_bf16 v[36:39], a[36:39], a[176:179], v[36:39]
  s_cmp_eq_u32 s14, 0
  s_cbranch_scc1 L_oexit
  s_waitcnt lgkmcnt(10)
  v_mfma_f32_16x16x32_bf16 v[0:3], a[0:3], a[128:131], v[0:3]
  ds_read_b64_tr_b16 a[24:25], v201 offset:20672
  ds_read_b64_tr_b16 a[26:27], v201 offset:25792
  v_mfma_f32_16x16x32_bf16 v[40:43], a[0:3], a[132:135], v[40:43]
  v_mfma_f32_16x16x32_bf16 v[80:83], a[0:3], a[136:139], v[80:83]
  buffer_load_dwordx4 a[176:179], v197, s[20:23], s89 offen offset:3072 sc1
  v_mfma_f32_16x16x32_bf16 v[120:123], a[0:3], a[140:143], v[120:123]
  s_waitcnt lgkmcnt(10)
  v_mfma_f32_16x16x32_bf16 v[124:127], a[4:7], a[140:143], v[124:127]
  ds_read_b64_tr_b16 a[28:29], v202 offset:20672
  ds_read_b64_tr_b16 a[30:31], v202 offset:25792
  v_mfma_f32_16x16x32_bf16 v[84:87], a[4:7], a[136:139], v[84:87]
  buffer_load_dwordx4 v194, s[64:67], s84 offen offset:2048 lds
  v_mfma_f32_16x16x32_bf16 v[44:47], a[4:7], a[132:135], v[44:47]
  v_mfma_f32_16x16x32_bf16 v[4:7], a[4:7], a[128:131], v[4:7]
  s_waitcnt lgkmcnt(10)
  v_mfma_f32_16x16x32_bf16 v[8:11], a[8:11], a[128:131], v[8:11]
  ds_read_b64_tr_b16 a[32:33], v201 offset:20736
  ds_read_b64_tr_b16 a[34:35], v201 offset:25856
  v_mfma_f32_16x16x32_bf16 v[48:51], a[8:11], a[132:135], v[48:51]
  v_mfma_f32_16x16x32_bf16 v[88:91], a[8:11], a[136:139], v[88:91]
  buffer_load_dwordx4 a[180:183], v198, s[20:23], s89 offen offset:3072 sc1
  v_mfma_f32_16x16x32_bf16 v[208:211], a[8:11], a[140:143], v[208:211]
  s_waitcnt lgkmcnt(10)
  v_mfma_f32_16x16x32_bf16 v[212:215], a[12:15], a[140:143], v[212:215]
  ds_read_b64_tr_b16 a[36:37], v202 offset:20736
  ds_read_b64_tr_b16 a[38:39], v202 offset:25856
  v_mfma_f32_16x16x32_bf16 v[92:95], a[12:15], a[136:139], v[92:95]
  v_mfma_f32_16x16x32_bf16 v[52:55], a[12:15], a[132:135], v[52:55]
  v_mfma_f32_16x16x32_bf16 v[12:15], a[12:15], a[128:131], v[12:15]
  s_waitcnt lgkmcnt(10)
  buffer_load_dwordx4 v195, s[64:67], s84 offen offset:3072 lds
  v_mfma_f32_16x16x32_bf16 v[16:19], a[16:19], a[128:131], v[16:19]
  ds_read_b64_tr_b16 a[0:1], v201 offset:30720
  ds_read_b64_tr_b16 a[2:3], v201 offset:35840
  v_mfma_f32_16x16x32_bf16 v[56:59], a[16:19], a[132:135], v[56:59]
  v_mfma_f32_16x16x32_bf16 v[96:99], a[16:19], a[136:139], v[96:99]
  buffer_load_dwordx4 a[184:187], v199, s[20:23], s89 offen offset:3072 sc1
  v_mfma_f32_16x16x32_bf16 v[216:219], a[16:19], a[140:143], v[216:219]
  s_waitcnt lgkmcnt(10)
  v_mfma_f32_16x16x32_bf16 v[220:223], a[20:23], a[140:143], v[220:223]
  ds_read_b64_tr_b16 a[4:5], v202 offset:30720
  ds_read_b64_tr_b16 a[6:7], v202 offset:35840
  v_mfma_f32_16x16x32_bf16 v[100:103], a[20:23], a[136:139], v[100:103]
  s_add_u32 m0, s100, 4096
  v_mfma_f32_16x16x32_bf16 v[60:63], a[20:23], a[132:135], v[60:63]
  v_mfma_f32_16x16x32_bf16 v[20:23], a[20:23], a[128:131], v[20:23]
  s_waitcnt lgkmcnt(10)
  v_mfma_f32_16x16x32_bf16 v[24:27], a[24:27], a[128:131], v[24:27]
  ds_read_b64_tr_b16 a[8:9], v201 offset:30784
  ds_read_b64_tr_b16 a[10:11], v201 offset:35904
  v_mfma_f32_16x16x32_bf16 v[64:67], a[24:27], a[132:135], v[64:67]
  v_mfma_f32_16x16x32_bf16 v[104:107], a[24:27], a[136:139], v[104:107]
  v_mfma_f32_16x16x32_bf16 v[224:227], a[24:27], a[140:143], v[224:227]
  s_waitcnt lgkmcnt(10)
  buffer_load_dwordx4 v196, s[64:67], s84 offen offset:0 lds
  v_mfma_f32_16x16x32_bf16 v[228:231], a[28:31], a[140:143], v[228:231]
  ds_read_b64_tr_b16 a[12:13], v202 offset:30784
  ds_read_b64_tr_b16 a[14:15], v202 offset:35904
  v_mfma_f32_16x16x32_bf16 v[108:111], a[28:31], a[136:139], v[108:111]
  s_add_u32 s84, s84, 81920
  v_mfma_f32_16x16x32_bf16 v[68:71], a[28:31], a[132:135], v[68:71]
  v_mfma_f32_16x16x32_bf16 v[28:31], a[28:31], a[128:131], v[28:31]
  s_waitcnt lgkmcnt(10)
  buffer_load_dwordx4 a[188:191], v200, s[20:23], s89 offen offset:3072 sc1
  v_mfma_f32_16x16x32_bf16 v[32:35], a[32:35], a[128:131], v[32:35]
  ds_read_b64_tr_b16 a[16:17], v201 offset:30848
  ds_read_b64_tr_b16 a[18:19], v201 offset:35968
  v_mfma_f32_16x16x32_bf16 v[72:75], a[32:35], a[132:135], v[72:75]
  v_mfma_f32_16x16x32_bf16 v[112:115], a[32:35], a[136:139], v[112:115]
  v_mfma_f32_16x16x32_bf16 v[232:235], a[32:35], a[140:143], v[232:235]
  s_waitcnt lgkmcnt(10)
  s_waitcnt vmcnt(13)
  v_readlane_b32 s55, v252, s9
  v_mfma_f32_16x16x32_bf16 v[236:239], a[36:39], a[140:143], v[236:239]
  ds_read_b64_tr_b16 a[20:21], v202 offset:30848
  ds_read_b64_tr_b16 a[22:23], v202 offset:35968
  v_mfma_f32_16x16x32_bf16 v[116:119], a[36:39], a[136:139], v[116:119]
  v_mfma_f32_16x16x32_bf16 v[76:79], a[36:39], a[132:135], v[76:79]
  s_or_b32 s55, s55, s10
  s_cbranch_scc0 L_spin2
L_spin2_ret:
  v_mfma_f32_16x16x32_bf16 v[36:39], a[36:39], a[128:131], v[36:39]
  s_waitcnt lgkmcnt(10)
  v_mfma_f32_16x16x32_bf16 v[0:3], a[0:3], a[144:147], v[0:3]
  ds_read_b64_tr_b16 a[24:25], v201 offset:30912
  ds_read_b64_tr_b16 a[26:27], v201 offset:36032
  v_mfma_f32_16x16x32_bf16 v[40:43], a[0:3], a[148:151], v[40:43]
  v_mfma_f32_16x16x32_bf16 v[80:83], a[0:3], a[152:155], v[80:83]
  buffer_load_dwordx4 a[128:131], v197, s[20:23], s87 offen offset:0 sc1
  v_mfma_f32_16x16x32_bf16 v[120:123], a[0:3], a[156:159], v[120:123]
  s_waitcnt lgkmcnt(10)
  v_mfma_f32_16x16x32_bf16 v[124:127], a[4:7], a[156:159], v[124:127]
  ds_read_b64_tr_b16 a[28:29], v202 offset:30912
  ds_read_b64_tr_b16 a[30:31], v202 offset:36032
  v_mfma_f32_16x16x32_bf16 v[84:87], a[4:7], a[152:155], v[84:87]
  v_mfma_f32_16x16x32_bf16 v[44:47], a[4:7], a[148:151], v[44:47]
  v_mfma_f32_16x16x32_bf16 v[4:7], a[4:7], a[144:147], v[4:7]
  s_waitcnt lgkmcnt(10)
  v_mfma_f32_16x16x32_bf16 v[8:11], a[8:11], a[144:147], v[8:11]
  ds_read_b64_tr_b16 a[32:33], v201 offset:30976
  ds_read_b64_tr_b16 a[34:35], v201 offset:36096
  v_mfma_f32_16x16x32_bf16 v[48:51], a[8:11], a[148:151], v[48:51]
  v_mfma_f32_16x16x32_bf16 v[88:91], a[8:11], a[152:155], v[88:91]
  buffer_load_dwordx4 a[132:135], v198, s[20:23], s87 offen offset:0 sc1
  v_mfma_f32_16x16x32_bf16 v[208:211], a[8:11], a[156:159], v[208:211]
  s_waitcnt lgkmcnt(10)
  v_mfma_f32_16x16x32_bf16 v[212:215], a[12:15], a[156:159], v[212:215]
  ds_read_b64_tr_b16 a[36:37], v202 offset:30976
  ds_read_b64_tr_b16 a[38:39], v202 offset:36096
  v_mfma_f32_16x16x32_bf16 v[92:95], a[12:15], a[152:155], v[92:95]
  v_mfma_f32_16x16x32_bf16 v[52:55], a[12:15], a[148:151], v[52:55]
  v_mfma_f32_16x16x32_bf16 v[12:15], a[12:15], a[144:147], v[12:15]
  s_waitcnt lgkmcnt(10)
  v_mfma_f32_16x16x32_bf16 v[16:19], a[16:19], a[144:147], v[16:19]
  v_readfirstlane_b32 s15, v248
  v_mfma_f32_16x16x32_bf16 v[56:59], a[16:19], a[148:151], v[56:59]
  s_nop 0
  v_mov_b32 v245, s15
  v_mfma_f32_16x16x32_bf16 v[96:99], a[16:19], a[152:155], v[96:99]
  buffer_load_dwordx4 a[136:139], v199, s[20:23], s87 offen offset:0 sc1
  v_mfma_f32_16x16x32_bf16 v[216:219], a[16:19], a[156:159], v[216:219]
  s_waitcnt lgkmcnt(8)
  ds_write_b32 v250, v245 offset:0
  v_mfma_f32_16x16x32_bf16 v[220:223], a[20:23], a[156:159], v[220:223]
  s_waitcnt vmcnt(19) lgkmcnt(0)
  v_mfma_f32_16x16x32_bf16 v[100:103], a[20:23], a[152:155], v[100:103]
  s_barrier
  v_mfma_f32_16x16x32_bf16 v[60:63], a[20:23], a[148:151], v[60:63]
  ds_read_b32 v246, v251 offset:0
  ds_read_b64_tr_b16 a[0:1], v201 offset:40960
  ds_read_b64_tr_b16 a[2:3], v201 offset:46080
  v_mfma_f32_16x16x32_bf16 v[20:23], a[20:23], a[144:147], v[20:23]
  s_add_u32 m0, s100, 20480
  v_mfma_f32_16x16x32_bf16 v[24:27], a[24:27], a[144:147], v[24:27]
  ds_read_b64_tr_b16 a[4:5], v202 offset:40960
  ds_read_b64_tr_b16 a[6:7], v202 offset:46080
  v_mfma_f32_16x16x32_bf16 v[64:67], a[24:27], a[148:151], v[64:67]
  buffer_load_dwordx4 v192, s[64:67], s84 offen offset:0 lds
  v_mfma_f32_16x16x32_bf16 v[104:107], a[24:27], a[152:155], v[104:107]
  ds_read_b64_tr_b16 a[8:9], v201 offset:41024
  ds_read_b64_tr_b16 a[10:11], v201 offset:46144
  v_mfma_f32_16x16x32_bf16 v[224:227], a[24:27], a[156:159], v[224:227]
  v_mfma_f32_16x16x32_bf16 v[228:231], a[28:31], a[156:159], v[228:231]
  ds_read_b64_tr_b16 a[12:13], v202 offset:41024
  ds_read_b64_tr_b16 a[14:15], v202 offset:46144
  v_mfma_f32_16x16x32_bf16 v[108:111], a[28:31], a[152:155], v[108:111]
  v_mfma_f32_16x16x32_bf16 v[68:71], a[28:31], a[148:151], v[68:71]
  ds_read_b64_tr_b16 a[16:17], v201 offset:41088
  ds_read_b64_tr_b16 a[18:19], v201 offset:46208
  v_mfma_f32_16x16x32_bf16 v[28:31], a[28:31], a[144:147], v[28:31]
  buffer_load_dwordx4 a[140:143], v200, s[20:23], s87 offen offset:0 sc1
  v_mfma_f32_16x16x32_bf16 v[32:35], a[32:35], a[144:147], v[32:35]
  ds_read_b64_tr_b16 a[20:21], v202 offset:41088
  ds_read_b64_tr_b16 a[22:23], v202 offset:46208
  v_mfma_f32_16x16x32_bf16 v[72:75], a[32:35], a[148:151], v[72:75]
  v_mfma_f32_16x16x32_bf16 v[112:115], a[32:35], a[152:155], v[112:115]
  v_mfma_f32_16x16x32_bf16 v[232:235], a[32:35], a[156:159], v[232:235]
  buffer_load_dwordx4 v193, s[64:67], s84 offen offset:1024 lds
  v_mfma_f32_16x16x32_bf16 v[236:239], a[36:39], a[156:159], v[236:239]
  v_mfma_f32_16x16x32_bf16 v[116:119], a[36:39], a[152:155], v[116:119]
  v_mfma_f32_16x16x32_bf16 v[76:79], a[36:39], a[148:151], v[76:79]
  s_waitcnt vmcnt(14)
  v_mfma_f32_16x16x32_bf16 v[36:39], a[36:39], a[144:147], v[36:39]
  s_waitcnt lgkmcnt(10)
  s_waitcnt lgkmcnt(12)
  v_readfirstlane_b32 s4, v246
  v_mfma_f32_16x16x32_bf16 v[0:3], a[0:3], a[160:163], v[0:3]
  s_bfe_u32 s19, s4, s5
  ds_read_b64_tr_b16 a[24:25], v201 offset:41152
  ds_read_b64_tr_b16 a[26:27], v201 offset:46272
  v_mfma_f32_16x16x32_bf16 v[40:43], a[0:3], a[164:167], v[40:43]
  s_cmp_lt_u32 s19, 6
  s_cselect_b32 s13, s6, 0
  s_mov_b32 s26, s5
  v_mfma_f32_16x16x32_bf16 v[80:83], a[0:3], a[168:171], v[80:83]
  s_lshl_b32 s15, 1, s5
  s_add_u32 s4, s4, s15
  buffer_load_dwordx4 a[144:147], v197, s[20:23], s87 offen offset:1024 sc1
  v_mfma_f32_16x16x32_bf16 v[120:123], a[0:3], a[172:175], v[120:123]
  s_waitcnt lgkmcnt(10)
  s_lshl_b32 s17, s82, 3
  s_or_b32 s17, s17, 0x80000
  s_xor_b32 s5, s17, 8
  v_mfma_f32_16x16x32_bf16 v[124:127], a[4:7], a[172:175], v[124:127]
  s_bfe_u32 s16, s4, s5
  ds_read_b64_tr_b16 a[28:29], v202 offset:41152
  ds_read_b64_tr_b16 a[30:31], v202 offset:46272
  v_mfma_f32_16x16x32_bf16 v[84:87], a[4:7], a[168:171], v[84:87]
  s_xor_b32 s56, s17, 16
  s_bfe_u32 s15, s4, s56
  buffer_load_dwordx4 v194, s[64:67], s84 offen offset:2048 lds
  v_mfma_f32_16x16x32_bf16 v[44:47], a[4:7], a[164:167], v[44:47]
  s_cmp_lt_u32 s15, s16
  s_cselect_b32 s5, s56, s5
  s_cselect_b32 s16, s15, s16
  v_mfma_f32_16x16x32_bf16 v[4:7], a[4:7], a[160:163], v[4:7]
  s_waitcnt lgkmcnt(10)
  s_xor_b32 s56, s17, 24
  s_bfe_u32 s15, s4, s56
  v_mfma_f32_16x16x32_bf16 v[8:11], a[8:11], a[160:163], v[8:11]
  ds_read_b64_tr_b16 a[32:33], v201 offset:41216
  ds_read_b64_tr_b16 a[34:35], v201 offset:46336
  v_mfma_f32_16x16x32_bf16 v[48:51], a[8:11], a[164:167], v[48:51]
  s_cmp_lt_u32 s15, s16
  s_cselect_b32 s5, s56, s5
  s_cselect_b32 s16, s15, s16
  v_mfma_f32_16x16x32_bf16 v[88:91], a[8:11], a[168:171], v[88:91]
  s_bfe_u32 s15, s4, s17
  buffer_load_dwordx4 a[148:151], v198, s[20:23], s87 offen offset:1024 sc1
  v_mfma_f32_16x16x32_bf16 v[208:211], a[8:11], a[172:175], v[208:211]
  s_waitcnt lgkmcnt(10)
  s_cmp_lt_u32 s15, 6
  s_cselect_b32 s5, s17, s5
  s_cselect_b32 s16, s15, s16
  v_mfma_f32_16x16x32_bf16 v[212:215], a[12:15], a[172:175], v[212:215]
  ds_read_b64_tr_b16 a[36:37], v202 offset:41216
  ds_read_b64_tr_b16 a[38:39], v202 offset:46336
  v_mfma_f32_16x16x32_bf16 v[92:95], a[12:15], a[168:171], v[92:95]
  s_cmp_lt_u32 s16, 6
  s_cselect_b32 s6, s13, 0
  s_mov_b32 s15, 15488
  v_mfma_f32_16x16x32_bf16 v[52:55], a[12:15], a[164:167], v[52:55]
  s_cmp_lg_u32 s6, 0
  s_cselect_b32 s7, s15, 0x40000000
  s_lshl_b32 s15, 1, s5
  v_mfma_f32_16x16x32_bf16 v[12:15], a[12:15], a[160:163], v[12:15]
  s_waitcnt lgkmcnt(10)
  buffer_load_dwordx4 v195, s[64:67], s84 offen offset:3072 lds
  v_mfma_f32_16x16x32_bf16 v[16:19], a[16:19], a[160:163], v[16:19]
  ds_read_b64_tr_b16 a[0:1], v201 offset:51200
  ds_read_b64_tr_b16 a[2:3], v201 offset:56320
  v_mfma_f32_16x16x32_bf16 v[56:59], a[16:19], a[164:167], v[56:59]
  v_mfma_f32_16x16x32_bf16 v[96:99], a[16:19], a[168:171], v[96:99]
  buffer_load_dwordx4 a[152:155], v199, s[20:23], s87 offen offset:1024 sc1
  v_mfma_f32_16x16x32_bf16 v[216:219], a[16:19], a[172:175], v[216:219]
  s_waitcnt lgkmcnt(10)
  v_mfma_f32_16x16x32_bf16 v[220:223], a[20:23], a[172:175], v[220:223]
  ds_read_b64_tr_b16 a[4:5], v202 offset:51200
  ds_read_b64_tr_b16 a[6:7], v202 offset:56320
  v_mfma_f32_16x16x32_bf16 v[100:103], a[20:23], a[168:171], v[100:103]
  s_add_u32 m0, s100, 24576
  v_mfma_f32_16x16x32_bf16 v[60:63], a[20:23], a[164:167], v[60:63]
  v_mfma_f32_16x16x32_bf16 v[20:23], a[20:23], a[160:163], v[20:23]
  s_waitcnt lgkmcnt(10)
  v_mfma_f32_16x16x32_bf16 v[24:27], a[24:27], a[160:163], v[24:27]
  ds_read_b64_tr_b16 a[8:9], v201 offset:51264
  ds_read_b64_tr_b16 a[10:11], v201 offset:56384
  v_mfma_f32_16x16x32_bf16 v[64:67], a[24:27], a[164:167], v[64:67]
  v_mfma_f32_16x16x32_bf16 v[104:107], a[24:27], a[168:171], v[104:107]
  v_mfma_f32_16x16x32_bf16 v[224:227], a[24:27], a[172:175], v[224:227]
  s_waitcnt lgkmcnt(10)
  buffer_load_dwordx4 v196, s[64:67], s84 offen offset:0 lds
  v_mfma_f32_16x16x32_bf16 v[228:231], a[28:31], a[172:175], v[228:231]
  ds_read_b64_tr_b16 a[12:13], v202 offset:51264
  ds_read_b64_tr_b16 a[14:15], v202 offset:56384
  v_mov_b32 v248, s15
  v_mfma_f32_16x16x32_bf16 v[108:111], a[28:31], a[168:171], v[108:111]
  s_add_u32 s84, s84, 81920
  buffer_atomic_add v248, v249, s[60:63], s7 offen sc0 sc1
  v_mfma_f32_16x16x32_bf16 v[68:71], a[28:31], a[164:167], v[68:71]
  buffer_load_dword v252, v207, s[36:39], 0 offen sc1
  v_mfma_f32_16x16x32_bf16 v[28:31], a[28:31], a[160:163], v[28:31]
  s_waitcnt lgkmcnt(10)
  buffer_load_dwordx4 a[156:159], v200, s[20:23], s87 offen offset:1024 sc1
  v_mfma_f32_16x16x32_bf16 v[32:35], a[32:35], a[160:163], v[32:35]
  ds_read_b64_tr_b16 a[16:17], v201 offset:51328
  ds_read_b64_tr_b16 a[18:19], v201 offset:56448
  v_mfma_f32_16x16x32_bf16 v[72:75], a[32:35], a[164:167], v[72:75]
  v_mfma_f32_16x16x32_bf16 v[112:115], a[32:35], a[168:171], v[112:115]
  v_mfma_f32_16x16x32_bf16 v[232:235], a[32:35], a[172:175], v[232:235]
  s_waitcnt lgkmcnt(10)
  v_mfma_f32_16x16x32_bf16 v[236:239], a[36:39], a[172:175], v[236:239]
  ds_read_b64_tr_b16 a[20:21], v202 offset:51328
  ds_read_b64_tr_b16 a[22:23], v202 offset:56448
  v_mfma_f32_16x16x32_bf16 v[116:119], a[36:39], a[168:171], v[116:119]
  v_mfma_f32_16x16x32_bf16 v[76:79], a[36:39], a[164:167], v[76:79]
  s_waitcnt vmcnt(15)
  v_mfma_f32_16x16x32_bf16 v[36:39], a[36:39], a[160:163], v[36:39]
  s_waitcnt lgkmcnt(10)
  v_mfma_f32_16x16x32_bf16 v[0:3], a[0:3], a[176:179], v[0:3]
  ds_read_b64_tr_b16 a[24:25], v201 offset:51392
  ds_read_b64_tr_b16 a[26:27], v201 offset:56512
  v_mfma_f32_16x16x32_bf16 v[40:43], a[0:3], a[180:183], v[40:43]
  s_cmp_ge_u32 s19, 3
  s_cselect_b32 s18, 1, 0
  s_mul_i32 s15, s18, 3
  v_mfma_f32_16x16x32_bf16 v[80:83], a[0:3], a[184:187], v[80:83]
  s_sub_u32 s15, s19, s15
  buffer_load_dwordx4 a[160:163], v197, s[20:23], s87 offen offset:2048 sc1
  v_mfma_f32_16x16x32_bf16 v[120:123], a[0:3], a[188:191], v[120:123]
  s_waitcnt lgkmcnt(10)
  s_cmp_ge_u32 s15, s8
  s_addc_u32 s15, s15, 0
  s_and_b32 s15, s15, 3
  v_mfma_f32_16x16x32_bf16 v[124:127], a[4:7], a[188:191], v[124:127]
  s_bfe_u32 s9, s26, 0x20003
  ds_read_b64_tr_b16 a[28:29], v202 offset:51392
  ds_read_b64_tr_b16 a[30:31], v202 offset:56512
  v_mfma_f32_16x16x32_bf16 v[84:87], a[4:7], a[184:187], v[84:87]
  s_lshl2_add_u32 s15, s9, s15
  s_lshl4_add_u32 s9, s18, s15
  s_lshl_b32 s88, s9, 12
  v_mfma_f32_16x16x32_bf16 v[44:47], a[4:7], a[180:183], v[44:47]
  s_lshl1_add_u32 s15, s15, s18
  s_lshl3_add_u32 s15, s15, s24
  s_mul_i32 s85, s15, 20480
  v_mfma_f32_16x16x32_bf16 v[4:7], a[4:7], a[176:179], v[4:7]
  s_waitcnt lgkmcnt(10)
  s_xor_b32 s10, s13, 1
  s_and_b32 s18, s18, s13
  v_mfma_f32_16x16x32_bf16 v[8:11], a[8:11], a[176:179], v[8:11]
  ds_read_b64_tr_b16 a[32:33], v201 offset:51456
  ds_read_b64_tr_b16 a[34:35], v201 offset:56576
  v_mfma_f32_16x16x32_bf16 v[48:51], a[8:11], a[180:183], v[48:51]
  s_cmp_eq_u32 s13, 0
  s_cselect_b32 s85, 0x40000000, s85
  s_cselect_b32 s88, 0x40000000, s88
  v_mfma_f32_16x16x32_bf16 v[88:91], a[8:11], a[184:187], v[88:91]
  buffer_load_dwordx4 a[164:167], v198, s[20:23], s87 offen offset:2048 sc1
  v_mfma_f32_16x16x32_bf16 v[208:211], a[8:11], a[188:191], v[208:211]
  s_waitcnt lgkmcnt(10)
  v_mfma_f32_16x16x32_bf16 v[212:215], a[12:15], a[188:191], v[212:215]
  ds_read_b64_tr_b16 a[36:37], v202 offset:51456
  ds_read_b64_tr_b16 a[38:39], v202 offset:56576
  v_mfma_f32_16x16x32_bf16 v[92:95], a[12:15], a[184:187], v[92:95]
  v_mfma_f32_16x16x32_bf16 v[52:55], a[12:15], a[180:183], v[52:55]
  v_mfma_f32_16x16x32_bf16 v[12:15], a[12:15], a[176:179], v[12:15]
  s_waitcnt lgkmcnt(10)
  v_mfma_f32_16x16x32_bf16 v[16:19], a[16:19], a[176:179], v[16:19]
  v_mfma_f32_16x16x32_bf16 v[56:59], a[16:19], a[180:183], v[56:59]
  v_mfma_f32_16x16x32_bf16 v[96:99], a[16:19], a[184:187], v[96:99]
  buffer_load_dwordx4 a[168:171], v199, s[20:23], s87 offen offset:2048 sc1
  v_mfma_f32_16x16x32_bf16 v[216:219], a[16:19], a[188:191], v[216:219]
  s_waitcnt lgkmcnt(8)
  v_mfma_f32_16x16x32_bf16 v[220:223], a[20:23], a[188:191], v[220:223]
  s_waitcnt vmcnt(19) lgkmcnt(0)
  v_mfma_f32_16x16x32_bf16 v[100:103], a[20:23], a[184:187], v[100:103]
  s_barrier
  v_mfma_f32_16x16x32_bf16 v[60:63], a[20:23], a[180:183], v[60:63]
  ds_read_b64_tr_b16 a[0:1], v201 offset:0
  ds_read_b64_tr_b16 a[2:3], v201 offset:5120
  v_mfma_f32_16x16x32_bf16 v[20:23], a[20:23], a[176:179], v[20:23]
  s_add_u32 m0, s100, 40960
  v_mfma_f32_16x16x32_bf16 v[24:27], a[24:27], a[176:179], v[24:27]
  ds_read_b64_tr_b16 a[4:5], v202 offset:0
  ds_read_b64_tr_b16 a[6:7], v202 offset:5120
  v_mfma_f32_16x16x32_bf16 v[64:67], a[24:27], a[180:183], v[64:67]
  buffer_load_dwordx4 v192, s[64:67], s85 offen offset:0 lds
  v_mfma_f32_16x16x32_bf16 v[104:107], a[24:27], a[184:187], v[104:107]
  ds_read_b64_tr_b16 a[8:9], v201 offset:64
  ds_read_b64_tr_b16 a[10:11], v201 offset:5184
  v_mfma_f32_16x16x32_bf16 v[224:227], a[24:27], a[188:191], v[224:227]
  v_mfma_f32_16x16x32_bf16 v[228:231], a[28:31], a[188:191], v[228:231]
  ds_read_b64_tr_b16 a[12:13], v202 offset:64
  ds_read_b64_tr_b16 a[14:15], v202 offset:5184
  v_mfma_f32_16x16x32_bf16 v[108:111], a[28:31], a[184:187], v[108:111]
  v_mfma_f32_16x16x32_bf16 v[68:71], a[28:31], a[180:183], v[68:71]
  ds_read_b64_tr_b16 a[16:17], v201 offset:128
  ds_read_b64_tr_b16 a[18:19], v201 offset:5248
  v_mfma_f32_16x16x32_bf16 v[28:31], a[28:31], a[176:179], v[28:31]
  buffer_load_dwordx4 a[172:175], v200, s[20:23], s87 offen offset:2048 sc1
  v_mfma_f32_16x16x32_bf16 v[32:35], a[32:35], a[176:179], v[32:35]
  ds_read_b64_tr_b16 a[20:21], v202 offset:128
  ds_read_b64_tr_b16 a[22:23], v202 offset:5248
  v_mfma_f32_16x16x32_bf16 v[72:75], a[32:35], a[180:183], v[72:75]
  v_mfma_f32_16x16x32_bf16 v[112:115], a[32:35], a[184:187], v[112:115]
  v_mfma_f32_16x16x32_bf16 v[232:235], a[32:35], a[188:191], v[232:235]
  buffer_load_dwordx4 v193, s[64:67], s85 offen offset:1024 lds
  v_mfma_f32_16x16x32_bf16 v[236:239], a[36:39], a[188:191], v[236:239]
  v_mfma_f32_16x16x32_bf16 v[116:119], a[36:39], a[184:187], v[116:119]
  v_mfma_f32_16x16x32_bf16 v[76:79], a[36:39], a[180:183], v[76:79]
  s_waitcnt vmcnt(16)
  v_mfma_f32_16x16x32_bf16 v[36:39], a[36:39], a[176:179], v[36:39]
  s_cmp_eq_u32 s12, 0
  s_cbranch_scc0 L_oloop
L_oexit:
  s_cmp_eq_u32 s11, 0
  s_cbranch_scc1 L_frcx
L_frcx_ret:
  v_mbcnt_lo_u32_b32 v240, -1, 0
  v_mbcnt_hi_u32_b32 v240, -1, v240
  s_lshl_b32 s55, s24, 14
  v_lshl_add_u32 v241, v240, 4, s55
  v_add_u32 v242, 4096, v241
  s_xor_b32 s3, s82, 1
  s_lshl_b32 s77, s3, 16
  s_add_u32 s77, s77, 0
  s_xor_b32 s3, s82, 2
  s_lshl_b32 s78, s3, 16
  s_add_u32 s78, s78, 5120
  s_xor_b32 s3, s82, 3
  s_lshl_b32 s79, s3, 16
  s_add_u32 s79, s79, 10240
  s_waitcnt lgkmcnt(0)
  v_cvt_pk_bf16_f32 v144, v40, v41
  v_cvt_pk_bf16_f32 v145, v42, v43
  v_cvt_pk_bf16_f32 v146, v44, v45
  v_cvt_pk_bf16_f32 v147, v46, v47
  buffer_store_dwordx4 v[144:147], v241, s[60:63], s77 offen offset:0 sc1
  v_cvt_pk_bf16_f32 v148, v48, v49
  v_cvt_pk_bf16_f32 v149, v50, v51
  v_cvt_pk_bf16_f32 v150, v52, v53
  v_cvt_pk_bf16_f32 v151, v54, v55
  buffer_store_dwordx4 v[148:151], v241, s[60:63], s77 offen offset:1024 sc1
  v_cvt_pk_bf16_f32 v152, v56, v57
  v_cvt_pk_bf16_f32 v153, v58, v59
  v_cvt_pk_bf16_f32 v154, v60, v61
  v_cvt_pk_bf16_f32 v155, v62, v63
  buffer_store_dwordx4 v[152:155], v241, s[60:63], s77 offen offset:2048 sc1
  v_cvt_pk_bf16_f32 v156, v64, v65
  v_cvt_pk_bf16_f32 v157, v66, v67
  v_cvt_pk_bf16_f32 v158, v68, v69
  v_cvt_pk_bf16_f32 v159, v70, v71
  buffer_store_dwordx4 v[156:159], v241, s[60:63], s77 offen offset:3072 sc1
  v_cvt_pk_bf16_f32 v160, v72, v73
  v_cvt_pk_bf16_f32 v161, v74, v75
  v_cvt_pk_bf16_f32 v162, v76, v77
  v_cvt_pk_bf16_f32 v163, v78, v79
  buffer_store_dwordx4 v[160:163], v242, s[60:63], s77 offen offset:0 sc1
  v_cvt_pk_bf16_f32 v164, v80, v81
  v_cvt_pk_bf16_f32 v165, v82, v83
  v_cvt_pk_bf16_f32 v166, v84, v85
  v_cvt_pk_bf16_f32 v167, v86, v87
  buffer_store_dwordx4 v[164:167], v241, s[60:63], s78 offen offset:0 sc1
  v_cvt_pk_bf16_f32 v168, v88, v89
  v_cvt_pk_bf16_f32 v169, v90, v91
  v_cvt_pk_bf16_f32 v170, v92, v93
  v_cvt_pk_bf16_f32 v171, v94, v95
  buffer_store_dwordx4 v[168:171], v241, s[60:63], s78 offen offset:1024 sc1
  v_cvt_pk_bf16_f32 v172, v96, v97
  v_cvt_pk_bf16_f32 v173, v98, v99
  v_cvt_pk_bf16_f32 v174, v100, v101
  v_cvt_pk_bf16_f32 v175, v102, v103
  buffer_store_dwordx4 v[172:175], v241, s[60:63], s78 offen offset:2048 sc1
  v_cvt_pk_bf16_f32 v176, v104, v105
  v_cvt_pk_bf16_f32 v177, v106, v107
  v_cvt_pk_bf16_f32 v178, v108, v109
  v_cvt_pk_bf16_f32 v179, v110, v111
  buffer_store_dwordx4 v[176:179], v241, s[60:63], s78 offen offset:3072 sc1
  v_cvt_pk_bf16_f32 v180, v112, v113
  v_cvt_pk_bf16_f32 v181, v114, v115
  v_cvt_pk_bf16_f32 v182, v116, v117
  v_cvt_pk_bf16_f32 v183, v118, v119
  buffer_store_dwordx4 v[180:183], v242, s[60:63], s78 offen offset:0 sc1
  v_cvt_pk_bf16_f32 v184, v120, v121
  v_cvt_pk_bf16_f32 v185, v122, v123
  v_cvt_pk_bf16_f32 v186, v124, v125
  v_cvt_pk_bf16_f32 v187, v126, v127
  buffer_store_dwordx4 v[184:187], v241, s[60:63], s79 offen offset:0 sc1
  v_cvt_pk_bf16_f32 v188, v208, v209
  v_cvt_pk_bf16_f32 v189, v210, v211
  v_cvt_pk_bf16_f32 v190, v212, v213
  v_cvt_pk_bf16_f32 v191, v214, v215
  buffer_store_dwordx4 v[188:191], v241, s[60:63], s79 offen offset:1024 sc1
  ds_read_b64_tr_b16 a[0:1], v203 offset:0
  ds_read_b64_tr_b16 a[2:3], v203 offset:5120
  ds_read_b64_tr_b16 a[4:5], v204 offset:0
  ds_read_b64_tr_b16 a[6:7], v204 offset:5120
  ds_read_b64_tr_b16 a[8:9], v203 offset:64
  ds_read_b64_tr_b16 a[10:11], v203 offset:5184
  ds_read_b64_tr_b16 a[12:13], v204 offset:64
  ds_read_b64_tr_b16 a[14:15], v204 offset:5184
  ds_read_b64_tr_b16 a[16:17], v203 offset:128
  ds_read_b64_tr_b16 a[18:19], v203 offset:5248
  ds_read_b64_tr_b16 a[20:21], v204 offset:128
  ds_read_b64_tr_b16 a[22:23], v204 offset:5248
  ds_read_b64_tr_b16 a[24:25], v203 offset:192
  ds_read_b64_tr_b16 a[26:27], v203 offset:5312
  v_cvt_pk_bf16_f32 v144, v216, v217
  v_cvt_pk_bf16_f32 v145, v218, v219
  v_cvt_pk_bf16_f32 v146, v220, v221
  v_cvt_pk_bf16_f32 v147, v222, v223
  buffer_store_dwordx4 v[144:147], v241, s[60:63], s79 offen offset:2048 sc1
  v_cvt_pk_bf16_f32 v148, v224, v225
  v_cvt_pk_bf16_f32 v149, v226, v227
  v_cvt_pk_bf16_f32 v150, v228, v229
  v_cvt_pk_bf16_f32 v151, v230, v231
  buffer_store_dwordx4 v[148:151], v241, s[60:63], s79 offen offset:3072 sc1
  v_cvt_pk_bf16_f32 v152, v232, v233
  v_cvt_pk_bf16_f32 v153, v234, v235
  v_cvt_pk_bf16_f32 v154, v236, v237
  v_cvt_pk_bf16_f32 v155, v238, v239
  buffer_store_dwordx4 v[152:155], v242, s[60:63], s79 offen offset:0 sc1
  s_waitcnt lgkmcnt(12)
  v_mfma_f32_16x16x32_bf16 v[0:3], a[0:3], a[64:67], v[0:3]
  s_waitcnt lgkmcnt(10)
  ds_read_b64_tr_b16 a[28:29], v204 offset:192
  ds_read_b64_tr_b16 a[30:31], v204 offset:5312
  v_mfma_f32_16x16x32_bf16 v[4:7], a[4:7], a[64:67], v[4:7]
  s_waitcnt lgkmcnt(10)
  ds_read_b64_tr_b16 a[32:33], v203 offset:256
  ds_read_b64_tr_b16 a[34:35], v203 offset:5376
  v_mfma_f32_16x16x32_bf16 v[8:11], a[8:11], a[64:67], v[8:11]
  s_waitcnt lgkmcnt(10)
  ds_read_b64_tr_b16 a[36:37], v204 offset:256
  ds_read_b64_tr_b16 a[38:39], v204 offset:5376
  v_mfma_f32_16x16x32_bf16 v[12:15], a[12:15], a[64:67], v[12:15]
  s_waitcnt lgkmcnt(10)
  ds_read_b64_tr_b16 a[40:41], v203 offset:10240
  ds_read_b64_tr_b16 a[42:43], v203 offset:15360
  v_mfma_f32_16x16x32_bf16 v[16:19], a[16:19], a[64:67], v[16:19]
  s_waitcnt lgkmcnt(10)
  ds_read_b64_tr_b16 a[44:45], v204 offset:10240
  ds_read_b64_tr_b16 a[46:47], v204 offset:15360
  v_mfma_f32_16x16x32_bf16 v[20:23], a[20:23], a[64:67], v[20:23]
  s_waitcnt lgkmcnt(10)
  ds_read_b64_tr_b16 a[48:49], v203 offset:10304
  ds_read_b64_tr_b16 a[50:51], v203 offset:15424
  v_mfma_f32_16x16x32_bf16 v[24:27], a[24:27], a[64:67], v[24:27]
  s_waitcnt lgkmcnt(10)
  ds_read_b64_tr_b16 a[52:53], v204 offset:10304
  ds_read_b64_tr_b16 a[54:55], v204 offset:15424
  v_mfma_f32_16x16x32_bf16 v[28:31], a[28:31], a[64:67], v[28:31]
  s_waitcnt lgkmcnt(10)
  ds_read_b64_tr_b16 a[56:57], v203 offset:10368
  ds_read_b64_tr_b16 a[58:59], v203 offset:15488
  v_mfma_f32_16x16x32_bf16 v[32:35], a[32:35], a[64:67], v[32:35]
  s_waitcnt lgkmcnt(10)
  ds_read_b64_tr_b16 a[60:61], v204 offset:10368
  ds_read_b64_tr_b16 a[62:63], v204 offset:15488
  v_mfma_f32_16x16x32_bf16 v[36:39], a[36:39], a[64:67], v[36:39]
  s_waitcnt lgkmcnt(10)
  ds_read_b64_tr_b16 a[0:1], v203 offset:10432
  ds_read_b64_tr_b16 a[2:3], v203 offset:15552
  v_mfma_f32_16x16x32_bf16 v[0:3], a[40:43], a[68:71], v[0:3]
  s_waitcnt lgkmcnt(10)
  ds_read_b64_tr_b16 a[4:5], v204 offset:10432
  ds_read_b64_tr_b16 a[6:7], v204 offset:15552
  v_mfma_f32_16x16x32_bf16 v[4:7], a[44:47], a[68:71], v[4:7]
  s_waitcnt lgkmcnt(10)
  ds_read_b64_tr_b16 a[8:9], v203 offset:10496
  ds_read_b64_tr_b16 a[10:11], v203 offset:15616
  v_mfma_f32_16x16x32_bf16 v[8:11], a[48:51], a[68:71], v[8:11]
  s_waitcnt lgkmcnt(10)
  ds_read_b64_tr_b16 a[12:13], v204 offset:10496
  ds_read_b64_tr_b16 a[14:15], v204 offset:15616
  v_mfma_f32_16x16x32_bf16 v[12:15], a[52:55], a[68:71], v[12:15]
  s_waitcnt lgkmcnt(10)
  ds_read_b64_tr_b16 a[16:17], v205 offset:0
  ds_read_b64_tr_b16 a[18:19], v205 offset:5120
  v_mfma_f32_16x16x32_bf16 v[16:19], a[56:59], a[68:71], v[16:19]
  s_waitcnt lgkmcnt(10)
  ds_read_b64_tr_b16 a[20:21], v206 offset:0
  ds_read_b64_tr_b16 a[22:23], v206 offset:5120
  v_mfma_f32_16x16x32_bf16 v[20:23], a[60:63], a[68:71], v[20:23]
  s_waitcnt lgkmcnt(10)
  ds_read_b64_tr_b16 a[24:25], v205 offset:64
  ds_read_b64_tr_b16 a[26:27], v205 offset:5184
  v_mfma_f32_16x16x32_bf16 v[24:27], a[0:3], a[68:71], v[24:27]
  s_waitcnt lgkmcnt(10)
  ds_read_b64_tr_b16 a[28:29], v206 offset:64
  ds_read_b64_tr_b16 a[30:31], v206 offset:5184
  v_mfma_f32_16x16x32_bf16 v[28:31], a[4:7], a[68:71], v[28:31]
  s_waitcnt lgkmcnt(10)
  ds_read_b64_tr_b16 a[32:33], v205 offset:128
  ds_read_b64_tr_b16 a[34:35], v205 offset:5248
  v_mfma_f32_16x16x32_bf16 v[32:35], a[8:11], a[68:71], v[32:35]
  s_waitcnt lgkmcnt(10)
  ds_read_b64_tr_b16 a[36:37], v206 offset:128
  ds_read_b64_tr_b16 a[38:39], v206 offset:5248
  v_mfma_f32_16x16x32_bf16 v[36:39], a[12:15], a[68:71], v[36:39]
  s_waitcnt lgkmcnt(10)
  ds_read_b64_tr_b16 a[40:41], v205 offset:192
  ds_read_b64_tr_b16 a[42:43], v205 offset:5312
  v_mfma_f32_16x16x32_bf16 v[0:3], a[16:19], a[72:75], v[0:3]
  s_waitcnt lgkmcnt(10)
  ds_read_b64_tr_b16 a[44:45], v206 offset:192
  ds_read_b64_tr_b16 a[46:47], v206 offset:5312
  v_mfma_f32_16x16x32_bf16 v[4:7], a[20:23], a[72:75], v[4:7]
  s_waitcnt lgkmcnt(10)
  ds_read_b64_tr_b16 a[48:49], v205 offset:256
  ds_read_b64_tr_b16 a[50:51], v205 offset:5376
  v_mfma_f32_16x16x32_bf16 v[8:11], a[24:27], a[72:75], v[8:11]
  s_waitcnt lgkmcnt(10)
  ds_read_b64_tr_b16 a[52:53], v206 offset:256
  ds_read_b64_tr_b16 a[54:55], v206 offset:5376
  v_mfma_f32_16x16x32_bf16 v[12:15], a[28:31], a[72:75], v[12:15]
  s_waitcnt lgkmcnt(10)
  ds_read_b64_tr_b16 a[56:57], v205 offset:10240
  ds_read_b64_tr_b16 a[58:59], v205 offset:15360
  v_mfma_f32_16x16x32_bf16 v[16:19], a[32:35], a[72:75], v[16:19]
  s_waitcnt lgkmcnt(10)
  ds_read_b64_tr_b16 a[60:61], v206 offset:10240
  ds_read_b64_tr_b16 a[62:63], v206 offset:15360
  v_mfma_f32_16x16x32_bf16 v[20:23], a[36:39], a[72:75], v[20:23]
  s_waitcnt lgkmcnt(10)
  ds_read_b64_tr_b16 a[0:1], v205 offset:10304
  ds_read_b64_tr_b16 a[2:3], v205 offset:15424
  v_mfma_f32_16x16x32_bf16 v[24:27], a[40:43], a[72:75], v[24:27]
  s_waitcnt lgkmcnt(10)
  ds_read_b64_tr_b16 a[4:5], v206 offset:10304
  ds_read_b64_tr_b16 a[6:7], v206 offset:15424
  v_mfma_f32_16x16x32_bf16 v[28:31], a[44:47], a[72:75], v[28:31]
  s_waitcnt lgkmcnt(10)
  ds_read_b64_tr_b16 a[8:9], v205 offset:10368
  ds_read_b64_tr_b16 a[10:11], v205 offset:15488
  v_mfma_f32_16x16x32_bf16 v[32:35], a[48:51], a[72:75], v[32:35]
  s_waitcnt lgkmcnt(10)
  ds_read_b64_tr_b16 a[12:13], v206 offset:10368
  ds_read_b64_tr_b16 a[14:15], v206 offset:15488
  v_mfma_f32_16x16x32_bf16 v[36:39], a[52:55], a[72:75], v[36:39]
  s_waitcnt lgkmcnt(10)
  ds_read_b64_tr_b16 a[16:17], v205 offset:10432
  ds_read_b64_tr_b16 a[18:19], v205 offset:15552
  v_mfma_f32_16x16x32_bf16 v[0:3], a[56:59], a[76:79], v[0:3]
  s_waitcnt lgkmcnt(10)
  ds_read_b64_tr_b16 a[20:21], v206 offset:10432
  ds_read_b64_tr_b16 a[22:23], v206 offset:15552
  v_mfma_f32_16x16x32_bf16 v[4:7], a[60:63], a[76:79], v[4:7]
  s_waitcnt lgkmcnt(10)
  ds_read_b64_tr_b16 a[24:25], v205 offset:10496
  ds_read_b64_tr_b16 a[26:27], v205 offset:15616
  v_mfma_f32_16x16x32_bf16 v[8:11], a[0:3], a[76:79], v[8:11]
  s_waitcnt lgkmcnt(10)
  ds_read_b64_tr_b16 a[28:29], v206 offset:10496
  ds_read_b64_tr_b16 a[30:31], v206 offset:15616
  v_mfma_f32_16x16x32_bf16 v[12:15], a[4:7], a[76:79], v[12:15]
  s_waitcnt lgkmcnt(10)
  ds_read_b64_tr_b16 a[32:33], v205 offset:20480
  ds_read_b64_tr_b16 a[34:35], v205 offset:25600
  v_mfma_f32_16x16x32_bf16 v[16:19], a[8:11], a[76:79], v[16:19]
  s_waitcnt lgkmcnt(10)
  ds_read_b64_tr_b16 a[36:37], v206 offset:20480
  ds_read_b64_tr_b16 a[38:39], v206 offset:25600
  v_mfma_f32_16x16x32_bf16 v[20:23], a[12:15], a[76:79], v[20:23]
  s_waitcnt lgkmcnt(10)
  ds_read_b64_tr_b16 a[40:41], v205 offset:20544
  ds_read_b64_tr_b16 a[42:43], v205 offset:25664
  v_mfma_f32_16x16x32_bf16 v[24:27], a[16:19], a[76:79], v[24:27]
  s_waitcnt lgkmcnt(10)
  ds_read_b64_tr_b16 a[44:45], v206 offset:20544
  ds_read_b64_tr_b16 a[46:47], v206 offset:25664
  v_mfma_f32_16x16x32_bf16 v[28:31], a[20:23], a[76:79], v[28:31]
  s_waitcnt lgkmcnt(10)
  ds_read_b64_tr_b16 a[48:49], v205 offset:20608
  ds_read_b64_tr_b16 a[50:51], v205 offset:25728
  v_mfma_f32_16x16x32_bf16 v[32:35], a[24:27], a[76:79], v[32:35]
  s_waitcnt lgkmcnt(10)
  ds_read_b64_tr_b16 a[52:53], v206 offset:20608
  ds_read_b64_tr_b16 a[54:55], v206 offset:25728
  v_mfma_f32_16x16x32_bf16 v[36:39], a[28:31], a[76:79], v[36:39]
  s_waitcnt lgkmcnt(10)
  ds_read_b64_tr_b16 a[56:57], v205 offset:20672
  ds_read_b64_tr_b16 a[58:59], v205 offset:25792
  v_mfma_f32_16x16x32_bf16 v[0:3], a[32:35], v[128:131], v[0:3]
  s_waitcnt lgkmcnt(10)
  s_lshl_b32 s3, s24, 2
  ds_read_b64_tr_b16 a[60:61], v206 offset:20672
  ds_read_b64_tr_b16 a[62:63], v206 offset:25792
  v_mfma_f32_16x16x32_bf16 v[4:7], a[36:39], v[128:131], v[4:7]
  s_waitcnt lgkmcnt(10)
  s_add_u32 s3, s3, s82
  ds_read_b64_tr_b16 a[0:1], v205 offset:20736
  ds_read_b64_tr_b16 a[2:3], v205 offset:25856
  v_mfma_f32_16x16x32_bf16 v[8:11], a[40:43], v[128:131], v[8:11]
  s_waitcnt lgkmcnt(10)
  s_mul_i32 s3, s3, 20480
  ds_read_b64_tr_b16 a[4:5], v206 offset:20736
  ds_read_b64_tr_b16 a[6:7], v206 offset:25856
  v_mfma_f32_16x16x32_bf16 v[12:15], a[44:47], v[128:131], v[12:15]
  s_waitcnt lgkmcnt(10)
  s_add_u32 s55, s55, 15360
  ds_read_b64_tr_b16 a[8:9], v205 offset:30720
  ds_read_b64_tr_b16 a[10:11], v205 offset:35840
  v_mfma_f32_16x16x32_bf16 v[16:19], a[48:51], v[128:131], v[16:19]
  s_waitcnt lgkmcnt(10)
  s_lshl_b32 s76, s82, 16
  ds_read_b64_tr_b16 a[12:13], v206 offset:30720
  ds_read_b64_tr_b16 a[14:15], v206 offset:35840
  v_mfma_f32_16x16x32_bf16 v[20:23], a[52:55], v[128:131], v[20:23]
  s_waitcnt lgkmcnt(10)
  s_add_u32 s76, s76, 0
  ds_read_b64_tr_b16 a[16:17], v205 offset:30784
  ds_read_b64_tr_b16 a[18:19], v205 offset:35904
  v_mfma_f32_16x16x32_bf16 v[24:27], a[56:59], v[128:131], v[24:27]
  s_waitcnt lgkmcnt(10)
  s_lshl_b32 s77, s82, 16
  ds_read_b64_tr_b16 a[20:21], v206 offset:30784
  ds_read_b64_tr_b16 a[22:23], v206 offset:35904
  v_mfma_f32_16x16x32_bf16 v[28:31], a[60:63], v[128:131], v[28:31]
  s_waitcnt lgkmcnt(10)
  s_add_u32 s77, s77, 5120
  ds_read_b64_tr_b16 a[24:25], v205 offset:30848
  ds_read_b64_tr_b16 a[26:27], v205 offset:35968
  v_mfma_f32_16x16x32_bf16 v[32:35], a[0:3], v[128:131], v[32:35]
  s_waitcnt lgkmcnt(10)
  s_lshl_b32 s78, s82, 16
  ds_read_b64_tr_b16 a[28:29], v206 offset:30848
  ds_read_b64_tr_b16 a[30:31], v206 offset:35968
  v_mfma_f32_16x16x32_bf16 v[36:39], a[4:7], v[128:131], v[36:39]
  s_waitcnt lgkmcnt(10)
  s_add_u32 s78, s78, 10240
  ds_read_b64_tr_b16 a[32:33], v205 offset:30912
  ds_read_b64_tr_b16 a[34:35], v205 offset:36032
  v_mfma_f32_16x16x32_bf16 v[0:3], a[8:11], v[132:135], v[0:3]
  s_waitcnt lgkmcnt(10)
  ds_read_b64_tr_b16 a[36:37], v206 offset:30912
  ds_read_b64_tr_b16 a[38:39], v206 offset:36032
  v_mfma_f32_16x16x32_bf16 v[4:7], a[12:15], v[132:135], v[4:7]
  s_waitcnt lgkmcnt(10)
  ds_read_b64_tr_b16 a[40:41], v205 offset:30976
  ds_read_b64_tr_b16 a[42:43], v205 offset:36096
  v_mfma_f32_16x16x32_bf16 v[8:11], a[16:19], v[132:135], v[8:11]
  s_waitcnt lgkmcnt(10)
  ds_read_b64_tr_b16 a[44:45], v206 offset:30976
  ds_read_b64_tr_b16 a[46:47], v206 offset:36096
  v_mfma_f32_16x16x32_bf16 v[12:15], a[20:23], v[132:135], v[12:15]
  s_waitcnt lgkmcnt(10)
  ds_read_b64_tr_b16 a[48:49], v205 offset:40960
  ds_read_b64_tr_b16 a[50:51], v205 offset:46080
  v_mfma_f32_16x16x32_bf16 v[16:19], a[24:27], v[132:135], v[16:19]
  s_waitcnt lgkmcnt(10)
  ds_read_b64_tr_b16 a[52:53], v206 offset:40960
  ds_read_b64_tr_b16 a[54:55], v206 offset:46080
  v_mfma_f32_16x16x32_bf16 v[20:23], a[28:31], v[132:135], v[20:23]
  s_waitcnt lgkmcnt(10)
  ds_read_b64_tr_b16 a[56:57], v205 offset:41024
  ds_read_b64_tr_b16 a[58:59], v205 offset:46144
  v_mfma_f32_16x16x32_bf16 v[24:27], a[32:35], v[132:135], v[24:27]
  s_waitcnt lgkmcnt(10)
  ds_read_b64_tr_b16 a[60:61], v206 offset:41024
  ds_read_b64_tr_b16 a[62:63], v206 offset:46144
  v_mfma_f32_16x16x32_bf16 v[28:31], a[36:39], v[132:135], v[28:31]
  s_waitcnt lgkmcnt(10)
  ds_read_b64_tr_b16 a[0:1], v205 offset:41088
  ds_read_b64_tr_b16 a[2:3], v205 offset:46208
  v_mfma_f32_16x16x32_bf16 v[32:35], a[40:43], v[132:135], v[32:35]
  s_waitcnt lgkmcnt(10)
  ds_read_b64_tr_b16 a[4:5], v206 offset:41088
  ds_read_b64_tr_b16 a[6:7], v206 offset:46208
  v_mfma_f32_16x16x32_bf16 v[36:39], a[44:47], v[132:135], v[36:39]
  s_waitcnt lgkmcnt(10)
  ds_read_b64_tr_b16 a[8:9], v205 offset:41152
  ds_read_b64_tr_b16 a[10:11], v205 offset:46272
  v_mfma_f32_16x16x32_bf16 v[0:3], a[48:51], v[136:139], v[0:3]
  s_waitcnt lgkmcnt(10)
  ds_read_b64_tr_b16 a[12:13], v206 offset:41152
  ds_read_b64_tr_b16 a[14:15], v206 offset:46272
  v_mfma_f32_16x16x32_bf16 v[4:7], a[52:55], v[136:139], v[4:7]
  s_waitcnt lgkmcnt(10)
  ds_read_b64_tr_b16 a[16:17], v205 offset:41216
  ds_read_b64_tr_b16 a[18:19], v205 offset:46336
  v_mfma_f32_16x16x32_bf16 v[8:11], a[56:59], v[136:139], v[8:11]
  s_waitcnt lgkmcnt(10)
  ds_read_b64_tr_b16 a[20:21], v206 offset:41216
  ds_read_b64_tr_b16 a[22:23], v206 offset:46336
  v_mfma_f32_16x16x32_bf16 v[12:15], a[60:63], v[136:139], v[12:15]
  s_waitcnt lgkmcnt(10)
  ds_read_b64_tr_b16 a[24:25], v205 offset:51200
  ds_read_b64_tr_b16 a[26:27], v205 offset:56320
  v_mfma_f32_16x16x32_bf16 v[16:19], a[0:3], v[136:139], v[16:19]
  s_waitcnt lgkmcnt(10)
  ds_read_b64_tr_b16 a[28:29], v206 offset:51200
  ds_read_b64_tr_b16 a[30:31], v206 offset:56320
  v_mfma_f32_16x16x32_bf16 v[20:23], a[4:7], v[136:139], v[20:23]
  s_waitcnt lgkmcnt(10)
  ds_read_b64_tr_b16 a[32:33], v205 offset:51264
  ds_read_b64_tr_b16 a[34:35], v205 offset:56384
  v_mfma_f32_16x16x32_bf16 v[24:27], a[8:11], v[136:139], v[24:27]
  s_waitcnt lgkmcnt(10)
  ds_read_b64_tr_b16 a[36:37], v206 offset:51264
  ds_read_b64_tr_b16 a[38:39], v206 offset:56384
  v_mfma_f32_16x16x32_bf16 v[28:31], a[12:15], v[136:139], v[28:31]
  s_waitcnt lgkmcnt(10)
  ds_read_b64_tr_b16 a[40:41], v205 offset:51328
  ds_read_b64_tr_b16 a[42:43], v205 offset:56448
  v_mfma_f32_16x16x32_bf16 v[32:35], a[16:19], v[136:139], v[32:35]
  s_waitcnt lgkmcnt(10)
  ds_read_b64_tr_b16 a[44:45], v206 offset:51328
  ds_read_b64_tr_b16 a[46:47], v206 offset:56448
  v_mfma_f32_16x16x32_bf16 v[36:39], a[20:23], v[136:139], v[36:39]
  s_waitcnt lgkmcnt(10)
  ds_read_b64_tr_b16 a[48:49], v205 offset:51392
  ds_read_b64_tr_b16 a[50:51], v205 offset:56512
  v_mfma_f32_16x16x32_bf16 v[0:3], a[24:27], v[140:143], v[0:3]
  s_waitcnt lgkmcnt(10)
  ds_read_b64_tr_b16 a[52:53], v206 offset:51392
  ds_read_b64_tr_b16 a[54:55], v206 offset:56512
  v_mfma_f32_16x16x32_bf16 v[4:7], a[28:31], v[140:143], v[4:7]
  s_waitcnt lgkmcnt(10)
  ds_read_b64_tr_b16 a[56:57], v205 offset:51456
  ds_read_b64_tr_b16 a[58:59], v205 offset:56576
  v_mfma_f32_16x16x32_bf16 v[8:11], a[32:35], v[140:143], v[8:11]
  s_waitcnt lgkmcnt(10)
  ds_read_b64_tr_b16 a[60:61], v206 offset:51456
  ds_read_b64_tr_b16 a[62:63], v206 offset:56576
  v_mfma_f32_16x16x32_bf16 v[12:15], a[36:39], v[140:143], v[12:15]
  s_waitcnt lgkmcnt(10)
  v_and_b32 v245, 15, v240
  v_mul_u32_u24 v245, 1280, v245
  v_mfma_f32_16x16x32_bf16 v[16:19], a[40:43], v[140:143], v[16:19]
  s_waitcnt lgkmcnt(8)
  v_and_b32 v246, 16, v240
  v_lshl_add_u32 v245, v246, 1, v245
  v_mfma_f32_16x16x32_bf16 v[20:23], a[44:47], v[140:143], v[20:23]
  s_waitcnt lgkmcnt(6)
  v_lshrrev_b32 v246, 5, v240
  v_lshl_add_u32 v245, v246, 4, v245
  v_mfma_f32_16x16x32_bf16 v[24:27], a[48:51], v[140:143], v[24:27]
  s_waitcnt lgkmcnt(4)
  v_add_u32 v245, s3, v245
  v_mov_b32 v244, 1
  v_mfma_f32_16x16x32_bf16 v[28:31], a[52:55], v[140:143], v[28:31]
  s_waitcnt lgkmcnt(2)
  v_xor_b32 v243, s82, v240
  v_lshlrev_b32 v243, 16, v243
  v_mfma_f32_16x16x32_bf16 v[32:35], a[56:59], v[140:143], v[32:35]
  s_waitcnt lgkmcnt(0)
  v_lshl_add_u32 v243, v240, 2, v243
  v_mfma_f32_16x16x32_bf16 v[36:39], a[60:63], v[140:143], v[36:39]
  s_waitcnt vmcnt(0)
  s_mov_b64 exec, 14
  buffer_store_dword v244, v243, s[60:63], s55 offen sc1
  s_mov_b64 exec, -1
  s_and_b32 s3, s24, s82
  s_cmp_eq_u32 s3, 3
  s_cbranch_scc1 L_done
  s_mov_b32 s83, 0x40000
L_xw:
  buffer_load_dwordx4 v[192:195], off, s[60:63], s1 sc1
  s_waitcnt vmcnt(0)
  v_and_b32 v193, v193, v194
  v_and_b32 v193, v193, v195
  s_nop 0
  v_readfirstlane_b32 s3, v193
  s_nop 3
  s_cmp_eq_u32 s3, 1
  s_cbranch_scc1 L_xok
  s_sleep 2
  s_sub_u32 s83, s83, 1
  s_cmp_lg_u32 s83, 0
  s_cbranch_scc1 L_xw
L_xok:
  buffer_load_dwordx4 v[40:43], v241, s[60:63], s76 offen offset:0 sc1
  buffer_load_dwordx4 v[60:63], v241, s[60:63], s77 offen offset:0 sc1
  buffer_load_dwordx4 v[80:83], v241, s[60:63], s78 offen offset:0 sc1
  buffer_load_dwordx4 v[44:47], v241, s[60:63], s76 offen offset:1024 sc1
  buffer_load_dwordx4 v[64:67], v241, s[60:63], s77 offen offset:1024 sc1
  buffer_load_dwordx4 v[84:87], v241, s[60:63], s78 offen offset:1024 sc1
  buffer_load_dwordx4 v[48:51], v241, s[60:63], s76 offen offset:2048 sc1
  buffer_load_dwordx4 v[68:71], v241, s[60:63], s77 offen offset:2048 sc1
  buffer_load_dwordx4 v[88:91], v241, s[60:63], s78 offen offset:2048 sc1
  buffer_load_dwordx4 v[52:55], v241, s[60:63], s76 offen offset:3072 sc1
  buffer_load_dwordx4 v[72:75], v241, s[60:63], s77 offen offset:3072 sc1
  buffer_load_dwordx4 v[92:95], v241, s[60:63], s78 offen offset:3072 sc1
  buffer_load_dwordx4 v[56:59], v242, s[60:63], s76 offen offset:0 sc1
  buffer_load_dwordx4 v[76:79], v242, s[60:63], s77 offen offset:0 sc1
  buffer_load_dwordx4 v[96:99], v242, s[60:63], s78 offen offset:0 sc1
  v_lshrrev_b32 v198, 4, v240
  v_bfe_u32 v199, v240, 2, 2
  v_cmp_eq_u32 vcc, v198, v199
  v_and_b32 v198, 1, v240
  v_lshlrev_b32 v198, 4, v198
  v_mov_b32 v199, 0x3f80
  v_lshlrev_b32 v198, v198, v199
  v_cndmask_b32 v198, 0, v198, vcc
  v_and_b32 v199, 2, v240
  v_cmp_eq_u32 vcc, 0, v199
  v_mov_b32 v192, 0
  v_mov_b32 v193, 0
  v_mov_b32 v196, 0
  v_mov_b32 v197, 0
  v_cndmask_b32 v194, 0, v198, vcc
  v_sub_u32 v195, v198, v194
  s_waitcnt vmcnt(12)
  s_nop 0
  v_mfma_f32_16x16x32_bf16 v[0:3], v[194:197], v[40:43], v[0:3]
  v_mfma_f32_16x16x32_bf16 v[4:7], v[192:195], v[40:43], v[4:7]
  v_mfma_f32_16x16x32_bf16 v[0:3], v[194:197], v[60:63], v[0:3]
  v_mfma_f32_16x16x32_bf16 v[4:7], v[192:195], v[60:63], v[4:7]
  v_mfma_f32_16x16x32_bf16 v[0:3], v[194:197], v[80:83], v[0:3]
  v_mfma_f32_16x16x32_bf16 v[4:7], v[192:195], v[80:83], v[4:7]
  s_waitcnt vmcnt(9)
  s_nop 0
  v_mfma_f32_16x16x32_bf16 v[8:11], v[194:197], v[44:47], v[8:11]
  v_mfma_f32_16x16x32_bf16 v[12:15], v[192:195], v[44:47], v[12:15]
  v_mfma_f32_16x16x32_bf16 v[8:11], v[194:197], v[64:67], v[8:11]
  v_mfma_f32_16x16x32_bf16 v[12:15], v[192:195], v[64:67], v[12:15]
  v_mfma_f32_16x16x32_bf16 v[8:11], v[194:197], v[84:87], v[8:11]
  v_mfma_f32_16x16x32_bf16 v[12:15], v[192:195], v[84:87], v[12:15]
  v_cvt_pk_bf16_f32 v200, v0, v1
  v_cvt_pk_bf16_f32 v201, v2, v3
  v_cvt_pk_bf16_f32 v202, v4, v5
  v_cvt_pk_bf16_f32 v203, v6, v7
  s_nop 1
  v_permlane16_swap_b32 v200, v202
  v_permlane16_swap_b32 v201, v203
  buffer_store_dwordx4 v[200:203], v245, s[68:71], 0 offen offset:0
  s_waitcnt vmcnt(7)
  s_nop 0
  v_mfma_f32_16x16x32_bf16 v[16:19], v[194:197], v[48:51], v[16:19]
  v_mfma_f32_16x16x32_bf16 v[20:23], v[192:195], v[48:51], v[20:23]
  v_mfma_f32_16x16x32_bf16 v[16:19], v[194:197], v[68:71], v[16:19]
  v_mfma_f32_16x16x32_bf16 v[20:23], v[192:195], v[68:71], v[20:23]
  v_mfma_f32_16x16x32_bf16 v[16:19], v[194:197], v[88:91], v[16:19]
  v_mfma_f32_16x16x32_bf16 v[20:23], v[192:195], v[88:91], v[20:23]
  v_cvt_pk_bf16_f32 v204, v8, v9
  v_cvt_pk_bf16_f32 v205, v10, v11
  v_cvt_pk_bf16_f32 v206, v12, v13
  v_cvt_pk_bf16_f32 v207, v14, v15
  s_nop 1
  v_permlane16_swap_b32 v204, v206
  v_permlane16_swap_b32 v205, v207
  buffer_store_dwordx4 v[204:207], v245, s[68:71], 0 offen offset:64
  s_waitcnt vmcnt(5)
  s_nop 0
  v_mfma_f32_16x16x32_bf16 v[24:27], v[194:197], v[52:55], v[24:27]
  v_mfma_f32_16x16x32_bf16 v[28:31], v[192:195], v[52:55], v[28:31]
  v_mfma_f32_16x16x32_bf16 v[24:27], v[194:197], v[72:75], v[24:27]
  v_mfma_f32_16x16x32_bf16 v[28:31], v[192:195], v[72:75], v[28:31]
  v_mfma_f32_16x16x32_bf16 v[24:27], v[194:197], v[92:95], v[24:27]
  v_mfma_f32_16x16x32_bf16 v[28:31], v[192:195], v[92:95], v[28:31]
  v_cvt_pk_bf16_f32 v200, v16, v17
  v_cvt_pk_bf16_f32 v201, v18, v19
  v_cvt_pk_bf16_f32 v202, v20, v21
  v_cvt_pk_bf16_f32 v203, v22, v23
  s_nop 1
  v_permlane16_swap_b32 v200, v202
  v_permlane16_swap_b32 v201, v203
  buffer_store_dwordx4 v[200:203], v245, s[68:71], 0 offen offset:128
  s_waitcnt vmcnt(3)
  s_nop 0
  v_mfma_f32_16x16x32_bf16 v[32:35], v[194:197], v[56:59], v[32:35]
  v_mfma_f32_16x16x32_bf16 v[36:39], v[192:195], v[56:59], v[36:39]
  v_mfma_f32_16x16x32_bf16 v[32:35], v[194:197], v[76:79], v[32:35]
  v_mfma_f32_16x16x32_bf16 v[36:39], v[192:195], v[76:79], v[36:39]
  v_mfma_f32_16x16x32_bf16 v[32:35], v[194:197], v[96:99], v[32:35]
  v_mfma_f32_16x16x32_bf16 v[36:39], v[192:195], v[96:99], v[36:39]
  v_cvt_pk_bf16_f32 v204, v24, v25
  v_cvt_pk_bf16_f32 v205, v26, v27
  v_cvt_pk_bf16_f32 v206, v28, v29
  v_cvt_pk_bf16_f32 v207, v30, v31
  s_nop 1
  v_permlane16_swap_b32 v204, v206
  v_permlane16_swap_b32 v205, v207
  buffer_store_dwordx4 v[204:207], v245, s[68:71], 0 offen offset:192
  v_cvt_pk_bf16_f32 v200, v32, v33
  v_cvt_pk_bf16_f32 v201, v34, v35
  v_cvt_pk_bf16_f32 v202, v36, v37
  v_cvt_pk_bf16_f32 v203, v38, v39
  s_nop 1
  v_permlane16_swap_b32 v200, v202
  v_permlane16_swap_b32 v201, v203
  buffer_store_dwordx4 v[200:203], v245, s[68:71], 0 offen offset:256
L_done:
L_end:
  s_endpgm
L_sigB:
  s_mov_b32 s11, 1
  s_cmp_lg_u32 s24, 0
  s_cbranch_scc1 L_sigB_ret
  s_mov_b64 exec, 1
  v_mov_b32 v247, 1
  buffer_store_dword v247, off, s[36:39], s80 offset:64 sc1
  s_mov_b64 exec, -1
  s_branch L_sigB_ret
L_frch:
  buffer_store_dwordx4 v[128:131], v197, s[20:23], s53 offen offset:0 sc1
  buffer_store_dwordx4 v[132:135], v197, s[20:23], s53 offen offset:1024 sc1
  buffer_store_dwordx4 v[136:139], v197, s[20:23], s53 offen offset:2048 sc1
  buffer_store_dwordx4 v[140:143], v197, s[20:23], s53 offen offset:3072 sc1
  buffer_store_dwordx4 v[144:147], v198, s[20:23], s53 offen offset:0 sc1
  buffer_store_dwordx4 v[148:151], v198, s[20:23], s53 offen offset:1024 sc1
  buffer_store_dwordx4 v[152:155], v198, s[20:23], s53 offen offset:2048 sc1
  buffer_store_dwordx4 v[156:159], v198, s[20:23], s53 offen offset:3072 sc1
  buffer_store_dwordx4 v[160:163], v199, s[20:23], s53 offen offset:0 sc1
  buffer_store_dwordx4 v[164:167], v199, s[20:23], s53 offen offset:1024 sc1
  buffer_store_dwordx4 v[168:171], v199, s[20:23], s53 offen offset:2048 sc1
  buffer_store_dwordx4 v[172:175], v199, s[20:23], s53 offen offset:3072 sc1
  buffer_store_dwordx4 v[176:179], v200, s[20:23], s53 offen offset:0 sc1
  buffer_store_dwordx4 v[180:183], v200, s[20:23], s53 offen offset:1024 sc1
  buffer_store_dwordx4 v[184:187], v200, s[20:23], s53 offen offset:2048 sc1
  buffer_store_dwordx4 v[188:191], v200, s[20:23], s53 offen offset:3072 sc1
  s_waitcnt vmcnt(0)
  s_barrier
  s_mov_b32 s11, 1
  s_cmp_lg_u32 s24, 0
  s_cbranch_scc1 L_frch_ret
  s_mov_b64 exec, 1
  v_mov_b32 v247, 1
  buffer_store_dword v247, off, s[36:39], s80 offset:64 sc1
  s_mov_b64 exec, -1
  s_branch L_frch_ret
L_frc0:
  buffer_store_dwordx4 v[128:131], v197, s[20:23], s53 offen offset:0 sc1
  buffer_store_dwordx4 v[132:135], v197, s[20:23], s53 offen offset:1024 sc1
  buffer_store_dwordx4 v[136:139], v197, s[20:23], s53 offen offset:2048 sc1
  buffer_store_dwordx4 v[140:143], v197, s[20:23], s53 offen offset:3072 sc1
  buffer_store_dwordx4 v[144:147], v198, s[20:23], s53 offen offset:0 sc1
  buffer_store_dwordx4 v[148:151], v198, s[20:23], s53 offen offset:1024 sc1
  buffer_store_dwordx4 v[152:155], v198, s[20:23], s53 offen offset:2048 sc1
  buffer_store_dwordx4 v[156:159], v198, s[20:23], s53 offen offset:3072 sc1
  buffer_store_dwordx4 v[160:163], v199, s[20:23], s53 offen offset:0 sc1
  buffer_store_dwordx4 v[164:167], v199, s[20:23], s53 offen offset:1024 sc1
  buffer_store_dwordx4 v[168:171], v199, s[20:23], s53 offen offset:2048 sc1
  buffer_store_dwordx4 v[172:175], v199, s[20:23], s53 offen offset:3072 sc1
  buffer_store_dwordx4 v[176:179], v200, s[20:23], s53 offen offset:0 sc1
  buffer_store_dwordx4 v[180:183], v200, s[20:23], s53 offen offset:1024 sc1
  buffer_store_dwordx4 v[184:187], v200, s[20:23], s53 offen offset:2048 sc1
  buffer_store_dwordx4 v[188:191], v200, s[20:23], s53 offen offset:3072 sc1
  s_waitcnt vmcnt(0)
  s_barrier
  s_mov_b32 s11, 1
  s_cmp_lg_u32 s24, 0
  s_cbranch_scc1 L_frc0_ret
  s_mov_b64 exec, 1
  v_mov_b32 v247, 1
  buffer_store_dword v247, off, s[36:39], s80 offset:64 sc1
  s_mov_b64 exec, -1
  s_branch L_frc0_ret
L_frcx:
  buffer_store_dwordx4 v[128:131], v197, s[20:23], s53 offen offset:0 sc1
  buffer_store_dwordx4 v[132:135], v197, s[20:23], s53 offen offset:1024 sc1
  buffer_store_dwordx4 v[136:139], v197, s[20:23], s53 offen offset:2048 sc1
  buffer_store_dwordx4 v[140:143], v197, s[20:23], s53 offen offset:3072 sc1
  buffer_store_dwordx4 v[144:147], v198, s[20:23], s53 offen offset:0 sc1
  buffer_store_dwordx4 v[148:151], v198, s[20:23], s53 offen offset:1024 sc1
  buffer_store_dwordx4 v[152:155], v198, s[20:23], s53 offen offset:2048 sc1
  buffer_store_dwordx4 v[156:159], v198, s[20:23], s53 offen offset:3072 sc1
  buffer_store_dwordx4 v[160:163], v199, s[20:23], s53 offen offset:0 sc1
  buffer_store_dwordx4 v[164:167], v199, s[20:23], s53 offen offset:1024 sc1
  buffer_store_dwordx4 v[168:171], v199, s[20:23], s53 offen offset:2048 sc1
  buffer_store_dwordx4 v[172:175], v199, s[20:23], s53 offen offset:3072 sc1
  buffer_store_dwordx4 v[176:179], v200, s[20:23], s53 offen offset:0 sc1
  buffer_store_dwordx4 v[180:183], v200, s[20:23], s53 offen offset:1024 sc1
  buffer_store_dwordx4 v[184:187], v200, s[20:23], s53 offen offset:2048 sc1
  buffer_store_dwordx4 v[188:191], v200, s[20:23], s53 offen offset:3072 sc1
  s_waitcnt vmcnt(0)
  s_barrier
  s_mov_b32 s11, 1
  s_cmp_lg_u32 s24, 0
  s_cbranch_scc1 L_frcx_ret
  s_mov_b64 exec, 1
  v_mov_b32 v247, 1
  buffer_store_dword v247, off, s[36:39], s80 offset:64 sc1
  s_mov_b64 exec, -1
  s_branch L_frcx_ret
L_spinh:
  s_mov_b32 s83, 0x40000
L_spinh_l:
  buffer_load_dword v252, v207, s[36:39], 0 offen sc1
  s_waitcnt vmcnt(0)
  v_readlane_b32 s55, v252, s9
  s_nop 3
  s_or_b32 s55, s55, s10
  s_cbranch_scc1 L_spinh_ret
  s_sleep 8
  s_sub_u32 s83, s83, 1
  s_cmp_lg_u32 s83, 0
  s_cbranch_scc1 L_spinh_l
  s_branch L_spinh_ret
L_spin0:
  s_mov_b32 s83, 0x40000
L_spin0_l:
  buffer_load_dword v252, v207, s[36:39], 0 offen sc1
  s_waitcnt vmcnt(0)
  v_readlane_b32 s55, v252, s9
  s_nop 3
  s_or_b32 s55, s55, s10
  s_cbranch_scc1 L_spin0_ret
  s_sleep 8
  s_sub_u32 s83, s83, 1
  s_cmp_lg_u32 s83, 0
  s_cbranch_scc1 L_spin0_l
  s_branch L_spin0_ret
L_spin1:
  s_mov_b32 s83, 0x40000
L_spin1_l:
  buffer_load_dword v252, v207, s[36:39], 0 offen sc1
  s_waitcnt vmcnt(0)
  v_readlane_b32 s55, v252, s9
  s_nop 3
  s_or_b32 s55, s55, s10
  s_cbranch_scc1 L_spin1_ret
  s_sleep 8
  s_sub_u32 s83, s83, 1
  s_cmp_lg_u32 s83, 0
  s_cbranch_scc1 L_spin1_l
  s_branch L_spin1_ret
L_spin2:
  s_mov_b32 s83, 0x40000
L_spin2_l:
  buffer_load_dword v252, v207, s[36:39], 0 offen sc1
  s_waitcnt vmcnt(0)
  v_readlane_b32 s55, v252, s9
  s_nop 3
  s_or_b32 s55, s55, s10
  s_cbranch_scc1 L_spin2_ret
  s_sleep 8
  s_sub_u32 s83, s83, 1
  s_cmp_lg_u32 s83, 0
  s_cbranch_scc1 L_spin2_l
  s_branch L_spin2_ret
L_spinR:
  s_mov_b32 s83, 0x40000
L_spinR_l:
  buffer_load_dword v235, off, s[72:75], s81 sc1
  s_waitcnt vmcnt(0)
  v_readfirstlane_b32 s55, v235
  s_nop 3
  s_cmp_ge_u32 s55, 16
  s_cbranch_scc1 L_spinR_ret
  s_sleep 8
  s_sub_u32 s83, s83, 1
  s_cmp_lg_u32 s83, 0
  s_cbranch_scc1 L_spinR_l
  s_branch L_spinR_ret
L_fallback:
  s_waitcnt vmcnt(0) lgkmcnt(0)
  s_barrier
  s_lshl_b32 s56, s29, 18
  s_lshl_b32 s55, s24, 10
  s_add_u32 s56, s56, s55
  s_mov_b32 s30, s56
  s_mov_b32 s28, 16
  v_mov_b32 v232, 0xff800000
  v_mov_b32 v233, 0xff800000
  v_mov_b32 v234, 0xff800000
  v_mov_b32 v235, 0xff800000
L_fbloop:
  s_add_u32 m0, s55, 0
  s_nop 0
  buffer_load_dwordx4 v224, s[12:15], s30 offen offset:0 nt lds
  s_addk_i32 s30, 0x1000
  s_add_u32 m0, s55, 4096
  s_nop 0
  buffer_load_dwordx4 v224, s[12:15], s30 offen offset:0 nt lds
  s_addk_i32 s30, 0x1000
  s_add_u32 m0, s55, 8192
  s_nop 0
  buffer_load_dwordx4 v224, s[12:15], s30 offen offset:0 nt lds
  s_addk_i32 s30, 0x1000
  s_add_u32 m0, s55, 12288
  s_nop 0
  buffer_load_dwordx4 v224, s[12:15], s30 offen offset:0 nt lds
  s_addk_i32 s30, 0x1000
  s_waitcnt vmcnt(0)
  s_barrier
  ds_read_b128 a[0:3], v212 offset:0
  ds_read_b128 a[4:7], v213 offset:0
  ds_read_b128 a[8:11], v214 offset:0
  ds_read_b128 a[12:15], v215 offset:0
  ds_read_b128 a[16:19], v212 offset:4096
  ds_read_b128 a[20:23], v213 offset:4096
  ds_read_b128 a[24:27], v214 offset:4096
  ds_read_b128 a[28:31], v215 offset:4096
  s_waitcnt lgkmcnt(0)
  v_mfma_f32_16x16x32_bf16 v[128:131], a[0:3], a[128:131], 0
  v_mfma_f32_16x16x32_bf16 v[136:139], a[0:3], a[144:147], 0
  v_mfma_f32_16x16x32_bf16 v[144:147], a[0:3], a[160:163], 0
  v_mfma_f32_16x16x32_bf16 v[152:155], a[0:3], a[176:179], 0
  v_mfma_f32_16x16x32_bf16 v[128:131], a[4:7], a[132:135], v[128:131]
  v_mfma_f32_16x16x32_bf16 v[136:139], a[4:7], a[148:151], v[136:139]
  v_mfma_f32_16x16x32_bf16 v[144:147], a[4:7], a[164:167], v[144:147]
  v_mfma_f32_16x16x32_bf16 v[152:155], a[4:7], a[180:183], v[152:155]
  v_mfma_f32_16x16x32_bf16 v[128:131], a[8:11], a[136:139], v[128:131]
  v_mfma_f32_16x16x32_bf16 v[136:139], a[8:11], a[152:155], v[136:139]
  v_mfma_f32_16x16x32_bf16 v[144:147], a[8:11], a[168:171], v[144:147]
  v_mfma_f32_16x16x32_bf16 v[152:155], a[8:11], a[184:187], v[152:155]
  v_mfma_f32_16x16x32_bf16 v[128:131], a[12:15], a[140:143], v[128:131]
  v_mfma_f32_16x16x32_bf16 v[136:139], a[12:15], a[156:159], v[136:139]
  v_mfma_f32_16x16x32_bf16 v[144:147], a[12:15], a[172:175], v[144:147]
  v_mfma_f32_16x16x32_bf16 v[152:155], a[12:15], a[188:191], v[152:155]
  v_mfma_f32_16x16x32_bf16 v[132:135], a[16:19], a[128:131], 0
  v_mfma_f32_16x16x32_bf16 v[140:143], a[16:19], a[144:147], 0
  v_mfma_f32_16x16x32_bf16 v[148:151], a[16:19], a[160:163], 0
  v_mfma_f32_16x16x32_bf16 v[156:159], a[16:19], a[176:179], 0
  v_mfma_f32_16x16x32_bf16 v[132:135], a[20:23], a[132:135], v[132:135]
  v_mfma_f32_16x16x32_bf16 v[140:143], a[20:23], a[148:151], v[140:143]
  v_mfma_f32_16x16x32_bf16 v[148:151], a[20:23], a[164:167], v[148:151]
  v_mfma_f32_16x16x32_bf16 v[156:159], a[20:23], a[180:183], v[156:159]
  v_mfma_f32_16x16x32_bf16 v[132:135], a[24:27], a[136:139], v[132:135]
  v_mfma_f32_16x16x32_bf16 v[140:143], a[24:27], a[152:155], v[140:143]
  v_mfma_f32_16x16x32_bf16 v[148:151], a[24:27], a[168:171], v[148:151]
  v_mfma_f32_16x16x32_bf16 v[156:159], a[24:27], a[184:187], v[156:159]
  v_mfma_f32_16x16x32_bf16 v[132:135], a[28:31], a[140:143], v[132:135]
  v_mfma_f32_16x16x32_bf16 v[140:143], a[28:31], a[156:159], v[140:143]
  v_mfma_f32_16x16x32_bf16 v[148:151], a[28:31], a[172:175], v[148:151]
  v_mfma_f32_16x16x32_bf16 v[156:159], a[28:31], a[188:191], v[156:159]
  s_nop 7
  s_nop 1
  v_max3_f32 v232, v232, v128, v129
  v_max3_f32 v232, v232, v130, v131
  v_max3_f32 v232, v232, v132, v133
  v_max3_f32 v232, v232, v134, v135
  v_max3_f32 v233, v233, v136, v137
  v_max3_f32 v233, v233, v138, v139
  v_max3_f32 v233, v233, v140, v141
  v_max3_f32 v233, v233, v142, v143
  v_max3_f32 v234, v234, v144, v145
  v_max3_f32 v234, v234, v146, v147
  v_max3_f32 v234, v234, v148, v149
  v_max3_f32 v234, v234, v150, v151
  v_max3_f32 v235, v235, v152, v153
  v_max3_f32 v235, v235, v154, v155
  v_max3_f32 v235, v235, v156, v157
  v_max3_f32 v235, v235, v158, v159
  ds_read_b128 a[0:3], v212 offset:8192
  ds_read_b128 a[4:7], v213 offset:8192
  ds_read_b128 a[8:11], v214 offset:8192
  ds_read_b128 a[12:15], v215 offset:8192
  ds_read_b128 a[16:19], v212 offset:12288
  ds_read_b128 a[20:23], v213 offset:12288
  ds_read_b128 a[24:27], v214 offset:12288
  ds_read_b128 a[28:31], v215 offset:12288
  s_waitcnt lgkmcnt(0)
  v_mfma_f32_16x16x32_bf16 v[160:163], a[0:3], a[128:131], 0
  v_mfma_f32_16x16x32_bf16 v[168:171], a[0:3], a[144:147], 0
  v_mfma_f32_16x16x32_bf16 v[176:179], a[0:3], a[160:163], 0
  v_mfma_f32_16x16x32_bf16 v[184:187], a[0:3], a[176:179], 0
  v_mfma_f32_16x16x32_bf16 v[160:163], a[4:7], a[132:135], v[160:163]
  v_mfma_f32_16x16x32_bf16 v[168:171], a[4:7], a[148:151], v[168:171]
  v_mfma_f32_16x16x32_bf16 v[176:179], a[4:7], a[164:167], v[176:179]
  v_mfma_f32_16x16x32_bf16 v[184:187], a[4:7], a[180:183], v[184:187]
  v_mfma_f32_16x16x32_bf16 v[160:163], a[8:11], a[136:139], v[160:163]
  v_mfma_f32_16x16x32_bf16 v[168:171], a[8:11], a[152:155], v[168:171]
  v_mfma_f32_16x16x32_bf16 v[176:179], a[8:11], a[168:171], v[176:179]
  v_mfma_f32_16x16x32_bf16 v[184:187], a[8:11], a[184:187], v[184:187]
  v_mfma_f32_16x16x32_bf16 v[160:163], a[12:15], a[140:143], v[160:163]
  v_mfma_f32_16x16x32_bf16 v[168:171], a[12:15], a[156:159], v[168:171]
  v_mfma_f32_16x16x32_bf16 v[176:179], a[12:15], a[172:175], v[176:179]
  v_mfma_f32_16x16x32_bf16 v[184:187], a[12:15], a[188:191], v[184:187]
  v_mfma_f32_16x16x32_bf16 v[164:167], a[16:19], a[128:131], 0
  v_mfma_f32_16x16x32_bf16 v[172:175], a[16:19], a[144:147], 0
  v_mfma_f32_16x16x32_bf16 v[180:183], a[16:19], a[160:163], 0
  v_mfma_f32_16x16x32_bf16 v[188:191], a[16:19], a[176:179], 0
  v_mfma_f32_16x16x32_bf16 v[164:167], a[20:23], a[132:135], v[164:167]
  v_mfma_f32_16x16x32_bf16 v[172:175], a[20:23], a[148:151], v[172:175]
  v_mfma_f32_16x16x32_bf16 v[180:183], a[20:23], a[164:167], v[180:183]
  v_mfma_f32_16x16x32_bf16 v[188:191], a[20:23], a[180:183], v[188:191]
  v_mfma_f32_16x16x32_bf16 v[164:167], a[24:27], a[136:139], v[164:167]
  v_mfma_f32_16x16x32_bf16 v[172:175], a[24:27], a[152:155], v[172:175]
  v_mfma_f32_16x16x32_bf16 v[180:183], a[24:27], a[168:171], v[180:183]
  v_mfma_f32_16x16x32_bf16 v[188:191], a[24:27], a[184:187], v[188:191]
  v_mfma_f32_16x16x32_bf16 v[164:167], a[28:31], a[140:143], v[164:167]
  v_mfma_f32_16x16x32_bf16 v[172:175], a[28:31], a[156:159], v[172:175]
  v_mfma_f32_16x16x32_bf16 v[180:183], a[28:31], a[172:175], v[180:183]
  v_mfma_f32_16x16x32_bf16 v[188:191], a[28:31], a[188:191], v[188:191]
  s_nop 7
  s_nop 1
  v_max3_f32 v232, v232, v160, v161
  v_max3_f32 v232, v232, v162, v163
  v_max3_f32 v232, v232, v164, v165
  v_max3_f32 v232, v232, v166, v167
  v_max3_f32 v233, v233, v168, v169
  v_max3_f32 v233, v233, v170, v171
  v_max3_f32 v233, v233, v172, v173
  v_max3_f32 v233, v233, v174, v175
  v_max3_f32 v234, v234, v176, v177
  v_max3_f32 v234, v234, v178, v179
  v_max3_f32 v234, v234, v180, v181
  v_max3_f32 v234, v234, v182, v183
  v_max3_f32 v235, v235, v184, v185
  v_max3_f32 v235, v235, v186, v187
  v_max3_f32 v235, v235, v188, v189
  v_max3_f32 v235, v235, v190, v191
  s_barrier
  s_sub_u32 s28, s28, 1
  s_cmp_lg_u32 s28, 0
  s_cbranch_scc1 L_fbloop
  v_mov_b32 v236, v232
  v_mov_b32 v237, v233
  v_mov_b32 v238, v234
  v_mov_b32 v239, v235
  v_permlane32_swap_b32 v236, v232
  v_permlane32_swap_b32 v237, v233
  v_permlane32_swap_b32 v238, v234
  v_permlane32_swap_b32 v239, v235
  v_max_f32 v232, v232, v236
  v_max_f32 v233, v233, v237
  v_max_f32 v234, v234, v238
  v_max_f32 v235, v235, v239
  v_mov_b32 v236, v232
  v_mov_b32 v237, v233
  v_mov_b32 v238, v234
  v_mov_b32 v239, v235
  v_permlane16_swap_b32 v236, v232
  v_permlane16_swap_b32 v237, v233
  v_permlane16_swap_b32 v238, v234
  v_permlane16_swap_b32 v239, v235
  v_max_f32 v232, v232, v236
  v_max_f32 v233, v233, v237
  v_max_f32 v234, v234, v238
  v_max_f32 v235, v235, v239
  v_mov_b32 v236, 0x7149f2ca
  s_lshl_b32 s55, s24, 2
  s_or_b32 s55, s55, s82
  s_cmp_eq_u32 s55, 15
  s_cselect_b64 vcc, -1, 0
  v_cndmask_b32 v232, v232, v236, vcc
  s_cmp_eq_u32 s55, 14
  s_cselect_b64 vcc, -1, 0
  v_cndmask_b32 v233, v233, v236, vcc
  s_cmp_eq_u32 s55, 13
  s_cselect_b64 vcc, -1, 0
  v_cndmask_b32 v234, v234, v236, vcc
  s_cmp_eq_u32 s55, 12
  s_cselect_b64 vcc, -1, 0
  v_cndmask_b32 v235, v235, v236, vcc
  v_sub_f32 v192, 0, v232
  v_sub_f32 v193, 0, v232
  v_sub_f32 v194, 0, v232
  v_sub_f32 v195, 0, v232
  v_sub_f32 v196, 0, v233
  v_sub_f32 v197, 0, v233
  v_sub_f32 v198, 0, v233
  v_sub_f32 v199, 0, v233
  v_sub_f32 v200, 0, v234
  v_sub_f32 v201, 0, v234
  v_sub_f32 v202, 0, v234
  v_sub_f32 v203, 0, v234
  v_sub_f32 v204, 0, v235
  v_sub_f32 v205, 0, v235
  v_sub_f32 v206, 0, v235
  v_sub_f32 v207, 0, v235
  s_mov_b32 s54, 1
  s_mov_b32 s30, s56
  s_add_u32 s31, s56, 16384
  s_pack_ll_b32_b16 m0, s30, 0
  s_nop 0
  buffer_load_dwordx4 v224, s[12:15], s30 offen offset:0 nt lds
  s_addk_i32 s30, 0x1000
  s_pack_ll_b32_b16 m0, s31, 1
  s_nop 0
  buffer_load_dwordx4 v225, s[16:19], s31 offen offset:0 nt lds
  s_addk_i32 s31, 0x1000
  s_pack_ll_b32_b16 m0, s31, 1
  s_nop 0
  buffer_load_dwordx4 v225, s[16:19], s31 offen offset:0 nt lds
  s_addk_i32 s31, 0x1000
  s_pack_ll_b32_b16 m0, s31, 1
  s_nop 0
  buffer_load_dwordx4 v225, s[16:19], s31 offen offset:0 nt lds
  s_addk_i32 s31, 0x1000
  s_pack_ll_b32_b16 m0, s30, 0
  s_nop 0
  buffer_load_dwordx4 v224, s[12:15], s30 offen offset:0 nt lds
  s_addk_i32 s30, 0x1000
  s_pack_ll_b32_b16 m0, s31, 1
  s_nop 0
  buffer_load_dwordx4 v225, s[16:19], s31 offen offset:0 nt lds
  s_addk_i32 s31, 0x1000
  s_pack_ll_b32_b16 m0, s31, 1
  s_nop 0
  buffer_load_dwordx4 v225, s[16:19], s31 offen offset:0 nt lds
  s_addk_i32 s31, 0x1000
  s_pack_ll_b32_b16 m0, s31, 1
  s_nop 0
  buffer_load_dwordx4 v225, s[16:19], s31 offen offset:0 nt lds
  s_addk_i32 s31, 0x1000
  s_pack_ll_b32_b16 m0, s30, 0
  s_nop 0
  buffer_load_dwordx4 v224, s[12:15], s30 offen offset:0 nt lds
  s_addk_i32 s30, 0x1000
  s_pack_ll_b32_b16 m0, s31, 1
  s_nop 0
  buffer_load_dwordx4 v225, s[16:19], s31 offen offset:0 nt lds
  s_addk_i32 s31, 0x1000
  s_pack_ll_b32_b16 m0, s31, 1
  s_nop 0
  buffer_load_dwordx4 v225, s[16:19], s31 offen offset:0 nt lds
  s_addk_i32 s31, 0x1000
  s_pack_ll_b32_b16 m0, s31, 1
  s_nop 0
  buffer_load_dwordx4 v225, s[16:19], s31 offen offset:0 nt lds
  s_addk_i32 s31, 0x1000
  s_pack_ll_b32_b16 m0, s30, 0
  s_nop 0
  buffer_load_dwordx4 v224, s[12:15], s30 offen offset:0 nt lds
  s_addk_i32 s30, 0x1000
  s_pack_ll_b32_b16 m0, s31, 1
  s_nop 0
  buffer_load_dwordx4 v225, s[16:19], s31 offen offset:0 nt lds
  s_addk_i32 s31, 0x1000
  s_pack_ll_b32_b16 m0, s31, 1
  s_nop 0
  buffer_load_dwordx4 v225, s[16:19], s31 offen offset:0 nt lds
  s_addk_i32 s31, 0x1000
  s_pack_ll_b32_b16 m0, s31, 1
  s_nop 0
  buffer_load_dwordx4 v225, s[16:19], s31 offen offset:0 nt lds
  s_addk_i32 s31, 0x1000
  s_pack_ll_b32_b16 m0, s30, 0
  s_nop 0
  buffer_load_dwordx4 v224, s[12:15], s30 offen offset:0 nt lds
  s_addk_i32 s30, 0x1000
  s_pack_ll_b32_b16 m0, s30, 0
  s_nop 0
  buffer_load_dwordx4 v224, s[12:15], s30 offen offset:0 nt lds
  s_addk_i32 s30, 0x1000
  s_pack_ll_b32_b16 m0, s30, 0
  s_nop 0
  buffer_load_dwordx4 v224, s[12:15], s30 offen offset:0 nt lds
  s_addk_i32 s30, 0x1000
  s_pack_ll_b32_b16 m0, s30, 0
  s_nop 0
  buffer_load_dwordx4 v224, s[12:15], s30 offen offset:0 nt lds
  s_addk_i32 s30, 0x1000
  s_pack_ll_b32_b16 m0, s30, 0
  s_nop 0
  buffer_load_dwordx4 v224, s[12:15], s30 offen offset:0 nt lds
  s_addk_i32 s30, 0x1000
  s_pack_ll_b32_b16 m0, s30, 0
  s_nop 0
  buffer_load_dwordx4 v224, s[12:15], s30 offen offset:0 nt lds
  s_addk_i32 s30, 0x1000
  s_pack_ll_b32_b16 m0, s30, 0
  s_nop 0
  buffer_load_dwordx4 v224, s[12:15], s30 offen offset:0 nt lds
  s_addk_i32 s30, 0x1000
  s_pack_ll_b32_b16 m0, s30, 0
  s_nop 0
  buffer_load_dwordx4 v224, s[12:15], s30 offen offset:0 nt lds
  s_addk_i32 s30, 0x1000
  s_pack_ll_b32_b16 m0, s30, 0
  s_nop 0
  buffer_load_dwordx4 v224, s[12:15], s30 offen offset:0 nt lds
  s_addk_i32 s30, 0x1000
  s_pack_ll_b32_b16 m0, s30, 0
  s_nop 0
  buffer_load_dwordx4 v224, s[12:15], s30 offen offset:0 nt lds
  s_addk_i32 s30, 0x1000
  s_pack_ll_b32_b16 m0, s30, 0
  s_nop 0
  buffer_load_dwordx4 v224, s[12:15], s30 offen offset:0 nt lds
  s_addk_i32 s30, 0x1000
  s_pack_ll_b32_b16 m0, s30, 0
  s_nop 0
  buffer_load_dwordx4 v224, s[12:15], s30 offen offset:0 nt lds
  s_addk_i32 s30, 0x1000
  s_pack_ll_b32_b16 m0, s31, 1
  s_nop 0
  buffer_load_dwordx4 v225, s[16:19], s31 offen offset:0 nt lds
  s_addk_i32 s31, 0x1000
  s_pack_ll_b32_b16 m0, s31, 1
  s_nop 0
  buffer_load_dwordx4 v225, s[16:19], s31 offen offset:0 nt lds
  s_addk_i32 s31, 0x1000
  s_pack_ll_b32_b16 m0, s31, 1
  s_nop 0
  buffer_load_dwordx4 v225, s[16:19], s31 offen offset:0 nt lds
  s_addk_i32 s31, 0x1000
  s_pack_ll_b32_b16 m0, s31, 1
  s_nop 0
  buffer_load_dwordx4 v225, s[16:19], s31 offen offset:0 nt lds
  s_addk_i32 s31, 0x1000
  s_waitcnt vmcnt(0)
  s_barrier
  ds_read_b128 a[0:3], v212 offset:0
  ds_read_b128 a[4:7], v213 offset:0
  ds_read_b128 a[8:11], v214 offset:0
  ds_read_b128 a[12:15], v215 offset:0
  ds_read_b128 a[16:19], v212 offset:4096
  ds_read_b128 a[20:23], v213 offset:4096
  ds_read_b128 a[24:27], v214 offset:4096
  ds_read_b128 a[28:31], v215 offset:4096
  s_branch L_head
.section .rodata,"a"
.p2align 6
.amdhsa_kernel standalone__gqa_block_cached__near_ridge_kernel
  .amdhsa_next_free_vgpr 512
  .amdhsa_next_free_sgpr 102
  .amdhsa_accum_offset 256
  .amdhsa_group_segment_fixed_size 0
  .amdhsa_kernarg_size 64
  .amdhsa_user_sgpr_count 2
  .amdhsa_user_sgpr_kernarg_segment_ptr 1
  .amdhsa_system_sgpr_workgroup_id_x 1
  .amdhsa_float_denorm_mode_32 3
.end_amdhsa_kernel
```
